```python
import torch

def _softmax(x, axis=-1):
    return torch.softmax(x, dim=axis)
def _gelu(x):
    return torch.nn.functional.gelu(x, approximate="tanh")
def _silu(x):
    return torch.nn.functional.silu(x)
def _sigmoid(x):
    return torch.sigmoid(x)
def _layernorm(x, axis=-1, eps=1e-5):
    m = x.mean(dim=axis, keepdim=True)
    v = x.var(dim=axis, keepdim=True, unbiased=False)
    return (x - m) / torch.sqrt(v + eps)
def _scatter_add(tgt, idx, src, axis=0):
    return tgt.clone().index_add_(axis, idx, src)
def _segment_sum(src, seg, n):
    out = torch.zeros((n,) + src.shape[1:], dtype=src.dtype)
    return out.index_add_(0, seg, src)
def _pad(x, pw):
    flat = tuple(v for pair in reversed(pw) for v in pair)
    return torch.nn.functional.pad(x, flat)

kernel_name = 'sequential_preLN__ssm_conv_h3__glu_gated_reglu__prompt'

def setup_inputs():

    _w = (lambda a: (lambda t: t.to(torch.bfloat16) if t.is_floating_point() else t)(torch.as_tensor(a)))
    def _A_setup():
        B, S, D = 1, 2048, 576
        ks = 4
        return {
            "q": _w((lambda *s: torch.randn(*s, dtype=torch.bfloat16) * 0.05)(B, S, D)),
            "k": _w((lambda *s: torch.randn(*s, dtype=torch.bfloat16) * 0.2)(B, S, D)),
            "v": _w((lambda *s: torch.randn(*s, dtype=torch.bfloat16) * 0.2)(B, S, D)),
            "shift_k": _w((lambda *s: torch.randn(*s, dtype=torch.bfloat16) * 0.2)(D, ks) * 0.5),
            "ssm_k": _w((lambda *s: torch.randn(*s, dtype=torch.bfloat16) * 0.4)(D, S) * (1.0 / S ** 0.5)),
            "ssm_D": _w((lambda *s: torch.randn(*s, dtype=torch.bfloat16) * 0.2)(D)),
        }
    _A_in = _A_setup()

    def _B_setup():
        B, S, D, F = 1, 2048, 576, 4608
        return {
            "x": _w((lambda *s: torch.randn(*s, dtype=torch.bfloat16) * 0.05)(B, S, D)),
            "W_gate": _w((lambda *s: torch.randn(*s, dtype=torch.bfloat16) * 0.2)(D, F) * (2.0 / D) ** 0.5),
            "W_up": _w((lambda *s: torch.randn(*s, dtype=torch.bfloat16) * 0.2)(D, F) * (2.0 / D) ** 0.5),
            "W_down": _w((lambda *s: torch.randn(*s, dtype=torch.bfloat16) * 0.2)(F, D) * (1.0 / F) ** 0.5),
        }
    _B_in = _B_setup()

    return {
        "A_q": _A_in["q"],
        "A_k": _A_in["k"],
        "A_v": _A_in["v"],
        "A_shift_k": _A_in["shift_k"],
        "A_ssm_k": _A_in["ssm_k"],
        "A_ssm_D": _A_in["ssm_D"],
        "B_x": _B_in["x"],
        "B_W_gate": _B_in["W_gate"],
        "B_W_up": _B_in["W_up"],
        "B_W_down": _B_in["W_down"],
    }

def reference(A_q, A_k, A_v, A_shift_k, A_ssm_k, A_ssm_D, B_x, B_W_gate, B_W_up, B_W_down):
    def _A_ref(q, k, v, shift_k, ssm_k, ssm_D):
        B, S, D = q.shape
        ks = shift_k.shape[-1]
        k_pad = _pad(k, ((0, 0), (ks - 1, 0), (0, 0)))
        k_shift = torch.zeros_like(k)
        for t in range(ks):
            k_shift = k_shift + k_pad[:, t:t + S, :] * shift_k[:, ks - 1 - t][None, None, :]
        kv = k_shift * v
        L = 2 * S
        kv_pad = _pad(kv, ((0, 0), (0, S), (0, 0)))
        kf_pad = _pad(ssm_k, ((0, 0), (0, S)))
        kv_f = (lambda x, axes=(-2,-1): torch.fft.rfft2(x.float(), dim=axes))(kv_pad[:, None, :, :], axes=(1, 2))
        kf_f = (lambda x, axes=(-2,-1): torch.fft.rfft2(x.float(), dim=axes))(kf_pad[:, None, :], axes=(1, 2))
        kf_f = (lambda x, *d: x.permute(*d))(kf_f, 1, 2, 0)
        y_f = kv_f * kf_f[None, :, :, :]
        y = (lambda x, s, axes=(-2,-1): torch.fft.irfft2(x, s=s, dim=axes).to(torch.bfloat16))(y_f, (1, L), axes=(1, 2))[:, 0, :S, :]
        y = y + kv * ssm_D[None, None, :]
        return q * y

    def _B_ref(x, W_gate, W_up, W_down):
        gate = torch.einsum("bsd,df->bsf", x, W_gate)
        up = torch.einsum("bsd,df->bsf", x, W_up)
        gate = gate * (lambda x, dt: x.to(dt))(gate > 0, gate.dtype)
        h = gate * up
        return torch.einsum("bsf,fd->bsd", h, W_down)

    x = A_q
    h = x + _A_ref(_layernorm(x, axis=-1), A_k, A_v, A_shift_k, A_ssm_k, A_ssm_D)
    h2 = h + _B_ref(_layernorm(h, axis=-1), B_W_gate, B_W_up, B_W_down)
    return h2
```

```asm
; @launch grid=(256,1,1) block=(256,1,1) lds=163840
.amdgcn_target "amdgcn-amd-amdhsa--gfx950"
.text
.globl sequential_preLN__ssm_conv_h3__glu_gated_reglu__prompt_kernel
.p2align 8
.type sequential_preLN__ssm_conv_h3__glu_gated_reglu__prompt_kernel,@function
sequential_preLN__ssm_conv_h3__glu_gated_reglu__prompt_kernel:
    s_cmp_ge_u32 s2, 256
    s_cbranch_scc1 END
    s_load_dwordx16 s[40:55], s[0:1], 0
    s_load_dwordx8 s[56:63], s[0:1], 64
    s_load_dwordx2 s[64:65], s[0:1], 96
    s_getpc_b64 s[92:93]
CPF0:
    s_lshr_b32 s6, s2, 3
    s_lshl_b32 s6, s6, 11
    v_lshl_add_u32 v254, v0, 3, s6
    v_min_u32 v254, CODE_END-CPF0-8, v254
    global_load_dwordx2 v[254:255], v254, s[92:93]
    v_lshrrev_b32 v1, 6, v0
    v_and_b32 v2, 63, v0
    v_readfirstlane_b32 s36, v1
    v_lshlrev_b32 v3, 4, v2
    v_mov_b32 v4, 0
    s_mov_b32 s7, s2
    s_mov_b32 s69, 0xffff0000
    s_cmp_ge_u32 s2, 192
    s_cbranch_scc1 NOP0
    s_lshr_b32 s29, s2, 3
    s_and_b32 s5, s29, 3
    s_and_b32 s28, s2, 7
    s_lshl_b32 s28, s28, 2
    s_add_u32 s5, s5, s28
    s_lshr_b32 s29, s29, 2
    s_and_b32 s70, s36, 1
    s_lshr_b32 s71, s36, 1
    v_mul_u32_u24 v5, 43, v2
    v_lshrrev_b32 v5, 9, v5
    v_mul_u32_u24 v6, 12, v5
    v_sub_u32 v6, v2, v6
    s_mul_i32 s33, s5, 73728
    s_mul_i32 s37, s29, 192
    s_add_u32 s33, s33, s37
    s_mul_i32 s37, s70, 40320
    s_add_u32 s33, s33, s37
    s_sub_u32 s33, s33, 4608
    v_mul_u32_u24 v5, 1152, v5
    v_lshl_add_u32 v5, v6, 4, v5
    v_cmp_le_u32 vcc, 60, v2
    v_mov_b32 v6, 0x40000000
    s_mul_i32 s38, s36, 7280
    v_cndmask_b32 v5, v5, v6, vcc
    v_add_u32 v64, s33, v5
    v_add_u32 v65, 5760, v64
    v_add_u32 v66, 11520, v64
    v_add_u32 v67, 17280, v64
    v_add_u32 v68, 23040, v64
    v_add_u32 v69, 28800, v64
    v_add_u32 v70, 34560, v64
    s_add_u32 s38, s38, 114688
    s_lshl_b32 s28, s29, 2
    s_add_u32 s28, s28, s36
    s_mul_i32 s37, s28, 24
    v_and_b32 v7, 7, v2
    v_add_u32 v71, s37, v7
    v_lshlrev_b32 v6, 3, v71
    s_cmp_eq_u32 s71, 0
    s_mov_b32 s10, 2359296
    s_mov_b32 s11, 0x00020000
    s_mov_b32 m0, s38
    s_waitcnt lgkmcnt(0)
    s_cselect_b32 s8, s42, s44
    s_cselect_b32 s9, s43, s45
    buffer_load_dwordx4 v64, s[8:11], 0 offen nt lds
    s_add_u32 m0, s38, 1040
    s_mov_b32 s24, s64
    s_mov_b32 s25, s65
    s_mov_b32 s26, 268435456
    s_mov_b32 s27, 0x00020000
    s_mov_b32 s6, 7733248
    buffer_load_dword v62, v4, s[24:27], s6 offen sc1
    buffer_load_dwordx4 v65, s[8:11], 0 offen nt lds
    s_add_u32 m0, s38, 2080
    s_mov_b32 s20, s46
    s_mov_b32 s21, s47
    s_mov_b32 s22, 4608
    s_mov_b32 s23, 0x00020000
    buffer_load_dwordx4 v66, s[8:11], 0 offen nt lds
    s_add_u32 m0, s38, 3120
    buffer_load_dwordx2 v[76:77], v6, s[20:23], 0 offen offset:0
    buffer_load_dwordx4 v67, s[8:11], 0 offen nt lds
    s_add_u32 m0, s38, 4160
    buffer_load_dwordx2 v[78:79], v6, s[20:23], 0 offen offset:64
    buffer_load_dwordx4 v68, s[8:11], 0 offen nt lds
    s_add_u32 m0, s38, 5200
    buffer_load_dwordx2 v[80:81], v6, s[20:23], 0 offen offset:128
    buffer_load_dwordx4 v69, s[8:11], 0 offen nt lds
    s_add_u32 m0, s38, 6240
    s_nop 0
    buffer_load_dwordx4 v70, s[8:11], 0 offen nt lds
    s_mul_i32 s37, s71, 23040
    v_add_u32 v156, s37, v64
    v_add_u32 v157, s37, v65
    v_add_u32 v158, s37, v66
    v_add_u32 v159, s37, v67
    s_mul_i32 s38, s70, 7280
    s_mul_i32 s37, s71, 4160
    s_add_u32 s38, s38, s37
    s_mov_b32 s8, s40
    s_mov_b32 s9, s41
    s_add_u32 m0, s38, 143808
    s_nop 0
    buffer_load_dwordx4 v156, s[8:11], 0 offen nt lds
    s_add_u32 m0, s38, 144848
    s_nop 0
    buffer_load_dwordx4 v157, s[8:11], 0 offen nt lds
    s_add_u32 m0, s38, 145888
    s_nop 0
    buffer_load_dwordx4 v158, s[8:11], 0 offen nt lds
    s_add_u32 m0, s38, 146928
    s_nop 0
    buffer_load_dwordx4 v159, s[8:11], 0 offen nt lds
    s_cmp_lt_u32 s2, 144
    s_cbranch_scc1 P0_k
    s_cmp_lg_u32 s36, 3
    s_cbranch_scc1 RI_1
    s_getreg_b32 s4, hwreg(HW_REG_XCC_ID, 0, 3)
    s_mov_b32 s72, s62
    s_mov_b32 s73, s63
    s_mov_b32 s74, 256
    s_mov_b32 s75, 0x00020000
    s_lshl_b32 s6, s4, 5
    s_mov_b64 exec, 1
    v_mov_b32 v58, 1
    buffer_atomic_add v58, v4, s[72:75], s6 offen sc0 sc1
    s_mov_b64 exec, -1
RI_1:
    v_mov_b32 v11, 0
    v_mov_b32 v250, 0
    v_mov_b32 v251, 0
    v_mov_b32 v10, 0
    s_branch P0_j1
P0_k:
    s_lshl_b32 s34, s2, 2
    s_add_u32 s34, s34, s36
    s_lshl_b32 s35, s34, 12
    s_mul_i32 s30, s36, 16640
    s_mov_b32 s12, s48
    s_mov_b32 s13, s49
    s_mov_b32 s14, 2359296
    s_mov_b32 s15, 0x00020000
    buffer_load_dwordx2 v[60:61], v4, s[12:15], s35 offen
    s_add_u32 m0, s30, 32
    s_nop 0
    buffer_load_dwordx4 v3, s[12:15], s35 offen offset:0 nt lds
    buffer_load_dwordx4 v3, s[12:15], s35 offen offset:1024 nt lds
    buffer_load_dwordx4 v3, s[12:15], s35 offen offset:2048 nt lds
    buffer_load_dwordx4 v3, s[12:15], s35 offen offset:3072 nt lds
    s_cmp_lg_u32 s36, 3
    s_cbranch_scc1 RI_2
    s_getreg_b32 s4, hwreg(HW_REG_XCC_ID, 0, 3)
    s_mov_b32 s72, s62
    s_mov_b32 s73, s63
    s_mov_b32 s74, 256
    s_mov_b32 s75, 0x00020000
    s_lshl_b32 s6, s4, 5
    s_mov_b64 exec, 1
    v_mov_b32 v58, 1
    buffer_atomic_add v58, v4, s[72:75], s6 offen sc0 sc1
    s_mov_b64 exec, -1
RI_2:
    s_lshl_b32 s37, s34, 1
    s_and_b32 s38, s37, 0xfffffffc
    s_load_dword s39, s[50:51], s38
    s_mul_i32 s32, s36, 4608
    s_add_u32 s32, s32, 66560
    v_and_b32 v5, 15, v2
    v_lshrrev_b32 v6, 4, v2
    v_lshlrev_b32 v7, 5, v5
    v_lshl_add_u32 v7, v6, 3, v7
    v_mov_b32 v12, 0
    v_mov_b32 v13, 0
    v_mov_b32 v14, 0
    v_mov_b32 v15, 0
    v_and_b32 v9, 31, v2
    v_lshl_add_u32 v9, v9, 4, s32
    ds_write_b128 v9, v[12:15]
    v_add_u32 v9, 1, v5
    v_and_b32 v9, 3, v9
    v_lshlrev_b32 v32, 3, v6
    v_sub_u32 v32, v5, v32
    v_sub_u32 v32, v32, v9
    v_add_u32 v32, 25, v32
    v_lshlrev_b32 v32, 1, v32
    v_mul_u32_u24 v9, 4160, v9
    v_add3_u32 v248, v32, v9, s30
    v_and_b32 v9, 1, v6
    v_mul_u32_u24 v249, 504, v9
    v_lshlrev_b32 v33, 5, v5
    v_lshl_add_u32 v33, v6, 4, v33
    v_add3_u32 v33, v33, s32, 32
    v_lshlrev_b32 v34, 3, v6
    v_sub_u32 v34, v34, v5
    v_subrev_u32 v34, 9, v34
    v_add_u32 v35, 84992, v3
    v_lshlrev_b32 v10, 2, v7
    v_add_u32 v7, v249, v7
    v_lshrrev_b32 v36, 2, v5
    v_and_b32 v37, 3, v5
    v_lshlrev_b32 v38, 4, v36
    v_sub_u32 v38, 64, v38
    v_mul_u32_u24 v39, 4160, v36
    v_lshl_add_u32 v39, v37, 3, v39
    v_add_u32 v39, s30, v39
    v_cmp_eq_u32 vcc, 3, v37
    v_cmp_ne_u32 s[16:17], 0, v36
    s_and_b64 s[16:17], vcc, s[16:17]
    s_mul_hi_u32 s67, s34, 0xAAAAAAB
    s_mul_i32 s67, s67, -292864
    s_mul_i32 s18, s2, 49152
    s_add_u32 s67, s67, s18
    s_add_u32 s67, s67, 50462720
    s_and_b32 s66, s2, 15
    s_mul_i32 s66, s66, 4096
    s_add_u32 s66, s66, 50329600
    v_mul_u32_u24 v11, 64, v5
    v_mul_u32_u24 v249, 64, v2
    v_add_u32 v11, s67, v11
    v_add_u32 v249, s66, v249
    v_cmp_gt_u32 vcc, 32, v2
    v_add_u32 v250, 1024, v11
    v_add_u32 v251, 2048, v249
    v_cndmask_b32 v250, v251, v250, vcc
    v_cndmask_b32 v11, v249, v11, vcc
    s_and_b32 s18, s37, 2
    s_lshl_b32 s18, s18, 3
P0_j1:
    v_lshrrev_b32 v8, 4, v2
    v_bfe_u32 v9, v2, 1, 1
    v_lshlrev_b32 v8, 4, v8
    v_lshl_add_u32 v8, v9, 3, v8
    v_bfe_u32 v9, v2, 2, 2
    v_add_u32 v8, v8, v9
    v_and_b32 v9, 1, v2
    s_mul_i32 s37, s36, 48
    s_add_u32 s37, s37, 114688
    v_lshl_add_u32 v9, v9, 3, s37
    v_mul_u32_u24 v128, 205, v8
    v_lshrrev_b32 v128, 10, v128
    v_mul_u32_u24 v128, 80, v128
    v_mul_u32_u24 v72, 192, v8
    v_add3_u32 v72, v72, v128, v9
    v_add_u32 v8, 4, v8
    v_mul_u32_u24 v128, 205, v8
    v_lshrrev_b32 v128, 10, v128
    v_mul_u32_u24 v128, 80, v128
    v_mul_u32_u24 v73, 192, v8
    v_add3_u32 v73, v73, v128, v9
    v_add_u32 v8, 4, v8
    v_mul_u32_u24 v128, 205, v8
    v_lshrrev_b32 v128, 10, v128
    v_mul_u32_u24 v128, 80, v128
    v_mul_u32_u24 v74, 192, v8
    v_add3_u32 v74, v74, v128, v9
    v_lshrrev_b32 v9, 3, v2
    s_lshl_b32 s33, s5, 7
    v_lshl_add_u32 v75, v9, 4, s33
    v_lshl_add_u32 v75, v71, 12, v75
    s_lshl_b32 s33, s28, 5
    s_add_u32 s33, s33, s5
    s_mul_i32 s33, s33, 64
    s_add_u32 s33, s33, 50462720
    s_mov_b32 s70, 0x0000ffff
    s_waitcnt vmcnt(9) lgkmcnt(0)
    s_cmp_lt_u32 s2, 144
    s_cbranch_scc1 P0w_3
    s_cmp_eq_u32 s36, 3
    s_waitcnt vmcnt(5)
    s_cbranch_scc1 P0w_3
    s_waitcnt vmcnt(4)
P0w_3:
    s_barrier
    ds_read_b64_tr_b16 v[98:99], v72 offset:0
    ds_read_b64_tr_b16 v[100:101], v73 offset:0
    ds_read_b64_tr_b16 v[102:103], v74 offset:0
    ds_read_b64_tr_b16 v[116:117], v73 offset:14560
    ds_read_b64_tr_b16 v[118:119], v74 offset:14560
    ds_read_b64_tr_b16 v[104:105], v72 offset:16
    ds_read_b64_tr_b16 v[106:107], v73 offset:16
    ds_read_b64_tr_b16 v[108:109], v74 offset:16
    ds_read_b64_tr_b16 v[120:121], v73 offset:14576
    ds_read_b64_tr_b16 v[122:123], v74 offset:14576
    ds_read_b64_tr_b16 v[110:111], v72 offset:32
    ds_read_b64_tr_b16 v[112:113], v73 offset:32
    ds_read_b64_tr_b16 v[114:115], v74 offset:32
    ds_read_b64_tr_b16 v[124:125], v73 offset:14592
    ds_read_b64_tr_b16 v[126:127], v74 offset:14592
    v_alignbit_b32 v82, v77, v77, 16
    v_alignbit_b32 v83, v76, v76, 16
    v_and_b32 v84, s69, v77
    v_bfi_b32 v85, s70, v77, v76
    v_and_b32 v86, s70, v76
    v_alignbit_b32 v87, v79, v79, 16
    v_alignbit_b32 v88, v78, v78, 16
    v_and_b32 v89, s69, v79
    v_bfi_b32 v90, s70, v79, v78
    v_and_b32 v91, s70, v78
    v_alignbit_b32 v92, v81, v81, 16
    v_alignbit_b32 v93, v80, v80, 16
    v_and_b32 v94, s69, v81
    v_bfi_b32 v95, s70, v81, v80
    v_and_b32 v96, s70, v80
    v_readfirstlane_b32 s3, v62
    s_add_u32 s3, s3, 1
    s_sub_u32 s37, s3, 1
    s_lshl_b32 s38, s2, 2
    s_add_u32 s38, s38, s36
    s_lshl_b32 s38, s38, 8
    s_add_u32 s38, s38, 51379712
    s_sub_u32 s38, s38, s33
    v_mov_b32 v50, s37
    v_mov_b32 v51, s37
    v_mov_b32 v52, s37
    v_mov_b32 v53, s37
    v_lshrrev_b32 v54, 2, v2
    v_mul_u32_u24 v54, 49088, v54
    v_mov_b32 v55, s38
    v_cmp_gt_u32 vcc, 32, v2
    s_mov_b32 exec_lo, 0xffffff
    s_mov_b32 exec_hi, 0xffff
    v_cndmask_b32 v54, v55, v54, vcc
    v_add_u32 v54, v54, v3
    buffer_store_dwordx4 v[50:53], v54, s[24:27], s33 offen sc1
    s_mov_b64 exec, -1
    s_waitcnt lgkmcnt(10)
    v_dot2_f32_bf16 v136, v98, v84, 0
    v_dot2_f32_bf16 v137, v99, v82, 0
    v_dot2_f32_bf16 v138, v99, v84, 0
    v_dot2_f32_bf16 v139, v100, v82, 0
    v_dot2_f32_bf16 v140, v100, v84, 0
    v_dot2_f32_bf16 v141, v101, v82, 0
    v_dot2_f32_bf16 v142, v101, v84, 0
    v_dot2_f32_bf16 v143, v102, v82, 0
    v_dot2_f32_bf16 v136, v99, v85, v136
    v_dot2_f32_bf16 v137, v100, v83, v137
    v_dot2_f32_bf16 v138, v100, v85, v138
    v_dot2_f32_bf16 v139, v101, v83, v139
    v_dot2_f32_bf16 v140, v101, v85, v140
    v_dot2_f32_bf16 v141, v102, v83, v141
    v_dot2_f32_bf16 v142, v102, v85, v142
    v_dot2_f32_bf16 v143, v103, v83, v143
    v_dot2_f32_bf16 v136, v100, v86, v136
    v_dot2_f32_bf16 v138, v101, v86, v138
    v_dot2_f32_bf16 v140, v102, v86, v140
    v_dot2_f32_bf16 v142, v103, v86, v142
    v_lshlrev_b32 v128, 16, v116
    v_and_b32 v129, s69, v116
    v_lshlrev_b32 v130, 16, v117
    v_and_b32 v131, s69, v117
    v_lshlrev_b32 v132, 16, v118
    v_and_b32 v133, s69, v118
    v_lshlrev_b32 v134, 16, v119
    v_and_b32 v135, s69, v119
    v_mul_f32 v135, v135, v143
    v_mul_f32 v134, v134, v142
    v_mul_f32 v133, v133, v141
    v_mul_f32 v132, v132, v140
    v_mul_f32 v131, v131, v139
    v_mul_f32 v130, v130, v138
    v_mul_f32 v129, v129, v137
    v_mul_f32 v128, v128, v136
    s_mov_b32 s37, 0
    v_cvt_pk_bf16_f32 v144, v135, v134
    v_cvt_pk_bf16_f32 v145, v133, v132
    v_cvt_pk_bf16_f32 v146, v131, v130
    v_cvt_pk_bf16_f32 v147, v129, v128
    buffer_store_dwordx4 v[144:147], v75, s[24:27], s37 offen sc1
    s_waitcnt lgkmcnt(5)
    v_dot2_f32_bf16 v136, v104, v89, 0
    v_dot2_f32_bf16 v137, v105, v87, 0
    v_dot2_f32_bf16 v138, v105, v89, 0
    v_dot2_f32_bf16 v139, v106, v87, 0
    v_dot2_f32_bf16 v140, v106, v89, 0
    v_dot2_f32_bf16 v141, v107, v87, 0
    v_dot2_f32_bf16 v142, v107, v89, 0
    v_dot2_f32_bf16 v143, v108, v87, 0
    v_dot2_f32_bf16 v136, v105, v90, v136
    v_dot2_f32_bf16 v137, v106, v88, v137
    v_dot2_f32_bf16 v138, v106, v90, v138
    v_dot2_f32_bf16 v139, v107, v88, v139
    v_dot2_f32_bf16 v140, v107, v90, v140
    v_dot2_f32_bf16 v141, v108, v88, v141
    v_dot2_f32_bf16 v142, v108, v90, v142
    v_dot2_f32_bf16 v143, v109, v88, v143
    v_dot2_f32_bf16 v136, v106, v91, v136
    v_dot2_f32_bf16 v138, v107, v91, v138
    v_dot2_f32_bf16 v140, v108, v91, v140
    v_dot2_f32_bf16 v142, v109, v91, v142
    v_lshlrev_b32 v128, 16, v120
    v_and_b32 v129, s69, v120
    v_lshlrev_b32 v130, 16, v121
    v_and_b32 v131, s69, v121
    v_lshlrev_b32 v132, 16, v122
    v_and_b32 v133, s69, v122
    v_lshlrev_b32 v134, 16, v123
    v_and_b32 v135, s69, v123
    v_mul_f32 v135, v135, v143
    v_mul_f32 v134, v134, v142
    v_mul_f32 v133, v133, v141
    v_mul_f32 v132, v132, v140
    v_mul_f32 v131, v131, v139
    v_mul_f32 v130, v130, v138
    v_mul_f32 v129, v129, v137
    v_mul_f32 v128, v128, v136
    s_mov_b32 s37, 32768
    v_cvt_pk_bf16_f32 v148, v135, v134
    v_cvt_pk_bf16_f32 v149, v133, v132
    v_cvt_pk_bf16_f32 v150, v131, v130
    v_cvt_pk_bf16_f32 v151, v129, v128
    buffer_store_dwordx4 v[148:151], v75, s[24:27], s37 offen sc1
    s_waitcnt lgkmcnt(0)
    v_dot2_f32_bf16 v136, v110, v94, 0
    v_dot2_f32_bf16 v137, v111, v92, 0
    v_dot2_f32_bf16 v138, v111, v94, 0
    v_dot2_f32_bf16 v139, v112, v92, 0
    v_dot2_f32_bf16 v140, v112, v94, 0
    v_dot2_f32_bf16 v141, v113, v92, 0
    v_dot2_f32_bf16 v142, v113, v94, 0
    v_dot2_f32_bf16 v143, v114, v92, 0
    v_dot2_f32_bf16 v136, v111, v95, v136
    v_dot2_f32_bf16 v137, v112, v93, v137
    v_dot2_f32_bf16 v138, v112, v95, v138
    v_dot2_f32_bf16 v139, v113, v93, v139
    v_dot2_f32_bf16 v140, v113, v95, v140
    v_dot2_f32_bf16 v141, v114, v93, v141
    v_dot2_f32_bf16 v142, v114, v95, v142
    v_dot2_f32_bf16 v143, v115, v93, v143
    v_dot2_f32_bf16 v136, v112, v96, v136
    v_dot2_f32_bf16 v138, v113, v96, v138
    v_dot2_f32_bf16 v140, v114, v96, v140
    v_dot2_f32_bf16 v142, v115, v96, v142
    v_lshlrev_b32 v128, 16, v124
    v_and_b32 v129, s69, v124
    v_lshlrev_b32 v130, 16, v125
    v_and_b32 v131, s69, v125
    v_lshlrev_b32 v132, 16, v126
    v_and_b32 v133, s69, v126
    v_lshlrev_b32 v134, 16, v127
    v_and_b32 v135, s69, v127
    v_mul_f32 v135, v135, v143
    v_mul_f32 v134, v134, v142
    v_mul_f32 v133, v133, v141
    v_mul_f32 v132, v132, v140
    v_mul_f32 v131, v131, v139
    v_mul_f32 v130, v130, v138
    v_mul_f32 v129, v129, v137
    v_mul_f32 v128, v128, v136
    s_mov_b32 s37, 65536
    v_cvt_pk_bf16_f32 v152, v135, v134
    v_cvt_pk_bf16_f32 v153, v133, v132
    v_cvt_pk_bf16_f32 v154, v131, v130
    v_cvt_pk_bf16_f32 v155, v129, v128
    buffer_store_dwordx4 v[152:155], v75, s[24:27], s37 offen sc1
    s_waitcnt vmcnt(9) lgkmcnt(0)
    s_cmp_lt_u32 s2, 144
    s_cbranch_scc1 P0w_4
    s_cmp_eq_u32 s36, 3
    s_waitcnt vmcnt(5)
    s_cbranch_scc1 P0w_4
    s_waitcnt vmcnt(4)
P0w_4:
    s_barrier
    ds_read_b64_tr_b16 v[156:157], v73 offset:29120
    ds_read_b64_tr_b16 v[158:159], v74 offset:29120
    ds_read_b64_tr_b16 v[160:161], v73 offset:29136
    ds_read_b64_tr_b16 v[162:163], v74 offset:29136
    ds_read_b64_tr_b16 v[164:165], v73 offset:29152
    ds_read_b64_tr_b16 v[166:167], v74 offset:29152
    s_mov_b32 s37, 2359296
    s_waitcnt lgkmcnt(4)
    buffer_store_dwordx4 v[156:159], v75, s[24:27], s37 offen sc1
    s_mov_b32 s37, 2392064
    s_waitcnt lgkmcnt(2)
    buffer_store_dwordx4 v[160:163], v75, s[24:27], s37 offen sc1
    s_mov_b32 s37, 2424832
    s_waitcnt lgkmcnt(0)
    buffer_store_dwordx4 v[164:167], v75, s[24:27], s37 offen sc1
    s_cmp_ge_u32 s2, 144
    s_cbranch_scc1 P0_j5
    s_waitcnt vmcnt(6)
    v_lshlrev_b64 v[60:61], v38, v[60:61]
    v_cndmask_b32 v60, 0, v60, s[16:17]
    v_cndmask_b32 v61, 0, v61, s[16:17]
    ds_write_b64 v39, v[60:61]
    v_add_u32 v9, s30, v3
    ds_read_b128 v[168:171], v9 offset:32
    ds_read_b64 v[172:173], v9 offset:48
    ds_read_b128 v[174:177], v9 offset:1056
    ds_read_b64 v[178:179], v9 offset:1072
    ds_read_b128 v[180:183], v9 offset:2080
    ds_read_b64 v[184:185], v9 offset:2096
    ds_read_b128 v[186:189], v9 offset:3104
    ds_read_b64 v[190:191], v9 offset:3120
    s_waitcnt lgkmcnt(6)
    v_alignbit_b32 v192, v169, v168, 16
    v_alignbit_b32 v193, v170, v169, 16
    v_alignbit_b32 v194, v171, v170, 16
    v_alignbit_b32 v195, v172, v171, 16
    ds_write_b128 v9, v[192:195] offset:4192
    v_mov_b32 v196, v169
    v_mov_b32 v197, v170
    v_mov_b32 v198, v171
    v_mov_b32 v199, v172
    ds_write_b128 v9, v[196:199] offset:8352
    v_alignbit_b32 v200, v170, v169, 16
    v_alignbit_b32 v201, v171, v170, 16
    v_alignbit_b32 v202, v172, v171, 16
    v_alignbit_b32 v203, v173, v172, 16
    ds_write_b128 v9, v[200:203] offset:12512
    s_waitcnt lgkmcnt(7)
    v_alignbit_b32 v204, v175, v174, 16
    v_alignbit_b32 v205, v176, v175, 16
    v_alignbit_b32 v206, v177, v176, 16
    v_alignbit_b32 v207, v178, v177, 16
    ds_write_b128 v9, v[204:207] offset:5216
    v_mov_b32 v208, v175
    v_mov_b32 v209, v176
    v_mov_b32 v210, v177
    v_mov_b32 v211, v178
    ds_write_b128 v9, v[208:211] offset:9376
    v_alignbit_b32 v212, v176, v175, 16
    v_alignbit_b32 v213, v177, v176, 16
    v_alignbit_b32 v214, v178, v177, 16
    v_alignbit_b32 v215, v179, v178, 16
    ds_write_b128 v9, v[212:215] offset:13536
    s_waitcnt lgkmcnt(8)
    v_alignbit_b32 v216, v181, v180, 16
    v_alignbit_b32 v217, v182, v181, 16
    v_alignbit_b32 v218, v183, v182, 16
    v_alignbit_b32 v219, v184, v183, 16
    ds_write_b128 v9, v[216:219] offset:6240
    v_mov_b32 v220, v181
    v_mov_b32 v221, v182
    v_mov_b32 v222, v183
    v_mov_b32 v223, v184
    ds_write_b128 v9, v[220:223] offset:10400
    v_alignbit_b32 v224, v182, v181, 16
    v_alignbit_b32 v225, v183, v182, 16
    v_alignbit_b32 v226, v184, v183, 16
    v_alignbit_b32 v227, v185, v184, 16
    ds_write_b128 v9, v[224:227] offset:14560
    s_waitcnt lgkmcnt(9)
    v_alignbit_b32 v228, v187, v186, 16
    v_alignbit_b32 v229, v188, v187, 16
    v_alignbit_b32 v230, v189, v188, 16
    v_alignbit_b32 v231, v190, v189, 16
    ds_write_b128 v9, v[228:231] offset:7264
    v_mov_b32 v232, v187
    v_mov_b32 v233, v188
    v_mov_b32 v234, v189
    v_mov_b32 v235, v190
    ds_write_b128 v9, v[232:235] offset:11424
    v_alignbit_b32 v236, v188, v187, 16
    v_alignbit_b32 v237, v189, v188, 16
    v_alignbit_b32 v238, v190, v189, 16
    v_alignbit_b32 v239, v191, v190, 16
    ds_write_b128 v9, v[236:239] offset:15584
P0_j5:
    s_waitcnt vmcnt(0)
P0_j4:
    s_mov_b64 exec, 63
    v_mov_b32 v50, s3
    v_mul_u32_u24 v51, 49152, v2
    buffer_store_dword v50, v51, s[24:27], s33 offen sc1
    s_mov_b64 exec, -1
    s_cmp_ge_u32 s2, 144
    s_cbranch_scc1 PACK
    s_cmp_lg_u32 s36, 0
    s_cbranch_scc1 CV_n1
CV_n1:
    s_mul_i32 s75, s2, 64
    s_add_u32 s75, s75, 8126464
    s_cmp_lg_u32 s36, 1
    s_cbranch_scc1 CV_n3
    s_sub_u32 s37, s3, 1
    v_mov_b32 v50, s37
    v_mov_b32 v51, s37
    v_mov_b32 v52, s37
    v_mov_b32 v53, s37
    v_lshrrev_b32 v54, 2, v2
    v_mul_u32_u24 v54, 16320, v54
    v_add_u32 v54, v54, v3
    buffer_store_dwordx4 v[50:53], v54, s[24:27], s75 offen sc1
    s_sub_u32 s74, s75, 262144
    buffer_store_dwordx4 v[50:53], v54, s[24:27], s74 offen sc1
CV_n3:
    s_cmp_lg_u32 s36, 3
    s_cbranch_scc1 RP_5
    v_readfirstlane_b32 s6, v58
    v_mov_b32 v59, 112640
    s_cmp_lt_u32 s6, 32
    s_cbranch_scc0 RPs_7
RPok_6:
    s_lshl_b32 s6, s6, 3
    s_add_u32 s6, s6, s4
    v_mov_b32 v58, s6
    ds_write_b32 v59, v58
    s_waitcnt lgkmcnt(0)
RP_5:
    s_lshr_b32 s39, s39, s18
    s_and_b32 s39, s39, 0xffff
    s_add_u32 s68, s35, 0
    s_add_u32 s70, s35, 2359296
    s_add_u32 s71, s35, 4718592
    s_lshl_b32 s72, s36, 11
    s_add_u32 s73, s72, 84992
    s_add_u32 s72, s72, 7077888
    s_add_u32 s32, s32, 512
    s_mov_b32 m0, s32
    v_and_b32 v9, 1, v34
    v_lshlrev_b32 v9, 4, v9
    v_lshlrev_b32 v9, v9, s39
    v_ashrrev_i32 v34, 1, v34
    v_cmp_eq_u32 vcc, 0, v34
    s_nop 1
    v_cndmask_b32 v36, 0, v9, vcc
    v_cmp_eq_u32 vcc, 1, v34
    s_nop 1
    v_cndmask_b32 v37, 0, v9, vcc
    v_cmp_eq_u32 vcc, 2, v34
    s_nop 1
    v_cndmask_b32 v38, 0, v9, vcc
    v_cmp_eq_u32 vcc, 3, v34
    s_nop 1
    v_cndmask_b32 v39, 0, v9, vcc
    s_waitcnt lgkmcnt(0)
    ds_read_b64 v[72:73], v248 offset:0
    ds_read_b64 v[74:75], v248 offset:8
    ds_read_b64 v[76:77], v248 offset:64
    ds_read_b64 v[78:79], v248 offset:72
    ds_read_b64 v[80:81], v248 offset:128
    ds_read_b64 v[82:83], v248 offset:136
    ds_read_b64 v[84:85], v248 offset:192
    ds_read_b64 v[86:87], v248 offset:200
    ds_read_b64 v[88:89], v248 offset:256
    ds_read_b64 v[90:91], v248 offset:264
    ds_read_b64 v[92:93], v248 offset:320
    ds_read_b64 v[94:95], v248 offset:328
    ds_read_b64 v[96:97], v248 offset:384
    ds_read_b64 v[98:99], v248 offset:392
    ds_read_b64 v[100:101], v248 offset:448
    ds_read_b64 v[102:103], v248 offset:456
    ds_read_b64 v[104:105], v248 offset:512
    ds_read_b64 v[106:107], v248 offset:520
    ds_read_b64 v[108:109], v248 offset:576
    ds_read_b64 v[110:111], v248 offset:584
    ds_read_b64 v[112:113], v248 offset:640
    ds_read_b64 v[114:115], v248 offset:648
    ds_read_b64 v[116:117], v248 offset:704
    ds_read_b64 v[118:119], v248 offset:712
    ds_read_b64 v[120:121], v248 offset:768
    ds_read_b64 v[122:123], v248 offset:776
    ds_read_b64 v[124:125], v248 offset:832
    ds_read_b64 v[126:127], v248 offset:840
    ds_read_b64 v[128:129], v248 offset:896
    ds_read_b64 v[130:131], v248 offset:904
    ds_read_b64 v[132:133], v248 offset:960
    ds_read_b64 v[134:135], v248 offset:968
    ds_read_b64 v[136:137], v248 offset:1024
    ds_read_b64 v[138:139], v248 offset:1032
    ds_read_b64 v[140:141], v248 offset:1088
    ds_read_b64 v[142:143], v248 offset:1096
    ds_read_b64 v[144:145], v248 offset:1152
    ds_read_b64 v[146:147], v248 offset:1160
    ds_read_b64 v[148:149], v248 offset:1216
    ds_read_b64 v[150:151], v248 offset:1224
    ds_read_b64 v[152:153], v248 offset:1280
    ds_read_b64 v[154:155], v248 offset:1288
    ds_read_b64 v[156:157], v248 offset:1344
    ds_read_b64 v[158:159], v248 offset:1352
    ds_read_b64 v[160:161], v248 offset:1408
    ds_read_b64 v[162:163], v248 offset:1416
    ds_read_b64 v[164:165], v248 offset:1472
    ds_read_b64 v[166:167], v248 offset:1480
    ds_read_b64 v[168:169], v248 offset:1536
    ds_read_b64 v[170:171], v248 offset:1544
    ds_read_b64 v[172:173], v248 offset:1600
    ds_read_b64 v[174:175], v248 offset:1608
    ds_read_b64 v[176:177], v248 offset:1664
    ds_read_b64 v[178:179], v248 offset:1672
    ds_read_b64 v[180:181], v248 offset:1728
    ds_read_b64 v[182:183], v248 offset:1736
    ds_read_b64 v[184:185], v248 offset:1792
    ds_read_b64 v[186:187], v248 offset:1800
    ds_read_b64 v[188:189], v248 offset:1856
    ds_read_b64 v[190:191], v248 offset:1864
    ds_read_b64 v[192:193], v248 offset:1920
    ds_read_b64 v[194:195], v248 offset:1928
    ds_read_b64 v[196:197], v248 offset:1984
    ds_read_b64 v[198:199], v248 offset:1992
    s_mov_b32 s97, 40000
    s_cmp_lg_u32 s36, 0
    s_cbranch_scc1 CV_go
    buffer_load_dword v12, v11, s[24:27], 0 offen sc1
    s_waitcnt vmcnt(0)
CV_chk:
    v_cmp_ne_u32 vcc, s3, v12
    s_cbranch_vccnz CV_again
CV_g2:
CV_go:
    s_barrier
    buffer_load_dwordx4 v3, s[24:27], s68 offen offset:0 sc1 lds
    buffer_load_dwordx4 v3, s[24:27], s68 offen offset:1024 sc1 lds
    buffer_load_dwordx4 v[16:19], v7, s[24:27], s70 offen offset:0 sc1
    buffer_load_dwordx4 v[20:23], v7, s[24:27], s70 offen offset:1024 sc1
    s_add_u32 m0, s73, 0
    s_add_u32 s74, s72, 0
    buffer_load_dwordx4 v10, s[24:27], s74 offen offset:0 sc1 lds
    s_add_u32 s74, s72, 4294966288
    buffer_load_dwordx4 v10, s[24:27], s74 offen offset:1024 sc1 lds
    v_mov_b32 v59, 112640
    ds_read_b32 v58, v59
    s_waitcnt lgkmcnt(0)
    v_readfirstlane_b32 s6, v58
    s_and_b32 s28, s6, 7
    s_lshr_b32 s29, s6, 3
    s_lshr_b32 s43, s28, 1
    s_and_b32 s44, s29, 3
    s_and_b32 s45, s28, 1
    s_lshl_b32 s45, s45, 3
    s_lshr_b32 s5, s29, 2
    s_add_u32 s45, s45, s5
    s_and_b32 s46, s29, 1
    s_lshl_b32 s5, s43, 2
    s_add_u32 s5, s5, s44
    s_mul_i32 s5, s5, 288
    s_and_b32 s47, s5, 0xffffffc0
    s_and_b32 s5, s36, 1
    s_mul_i32 s5, s5, 442368
    s_lshl_b32 s6, s46, 6
    s_add_u32 s6, s6, s47
    s_lshl_b32 s41, s6, 1
    s_add_u32 s41, s41, s5
    s_cmp_eq_u32 s46, 0
    s_cselect_b32 s6, 256, 32
    s_add_u32 s6, s6, s47
    s_add_u32 s6, s6, s5
    s_lshl_b32 s42, s6, 1
    s_mul_i32 s40, s36, 6144
    s_add_u32 s40, s40, 16384
    s_cmp_lt_u32 s36, 2
    s_cselect_b32 s8, s54, s56
    s_cselect_b32 s9, s55, s57
    s_mov_b32 s10, 5308416
    s_mov_b32 s11, 0x00020000
    v_bfe_u32 v5, v2, 4, 1
    v_bfe_u32 v6, v2, 1, 1
    v_xor_b32 v6, v6, v5
    v_lshrrev_b32 v5, 2, v2
    v_mul_u32_u24 v5, 9216, v5
    v_lshl_add_u32 v5, v6, 5, v5
    v_and_b32 v6, 1, v2
    v_lshl_add_u32 v252, v6, 4, v5
    v_add_u32 v253, 146432, v252
    v_add_u32 v254, 292864, v252
    ds_read_b64 a[240:241], v248 offset:4032
    ds_read_b64 a[242:243], v248 offset:4040
    ds_read_b64 a[208:209], v248 offset:3968
    ds_read_b64 a[210:211], v248 offset:3976
    ds_read_b64 a[176:177], v248 offset:3904
    ds_read_b64 a[178:179], v248 offset:3912
    ds_read_b64 a[144:145], v248 offset:3840
    ds_read_b64 a[146:147], v248 offset:3848
    s_waitcnt vmcnt(4)
    ds_read_b128 a[0:3], v33 offset:448
    ds_read_b128 a[4:7], v33 offset:960
    ds_read_b128 a[8:11], v33 offset:1472
    ds_read_b128 a[12:15], v33 offset:1984
    ds_read_b128 a[32:35], v33 offset:384
    ds_read_b128 a[36:39], v33 offset:896
    ds_read_b128 a[40:43], v33 offset:1408
    ds_read_b128 a[44:47], v33 offset:1920
    s_waitcnt lgkmcnt(4)
    v_mfma_f32_16x16x32_bf16 v[40:43], v[72:75], a[0:3], 0
    ds_read_b128 a[64:67], v33 offset:320
    ds_read_b64 a[112:113], v248 offset:3776
    v_mfma_f32_16x16x32_bf16 v[44:47], v[72:75], a[4:7], 0
    ds_read_b128 a[68:71], v33 offset:832
    ds_read_b64 a[114:115], v248 offset:3784
    v_mfma_f32_16x16x32_bf16 v[48:51], v[72:75], a[8:11], 0
    ds_read_b128 a[72:75], v33 offset:1344
    ds_read_b64 a[80:81], v248 offset:3712
    v_mfma_f32_16x16x32_bf16 v[52:55], v[72:75], a[12:15], 0
    ds_read_b128 a[76:79], v33 offset:1856
    ds_read_b64 a[82:83], v248 offset:3720
    v_mfma_f32_16x16x32_bf16 v[40:43], v[36:39], a[0:3], v[40:43]
    ds_read_b128 a[96:99], v33 offset:256
    ds_read_b64 a[48:49], v248 offset:3648
    v_mfma_f32_16x16x32_bf16 v[44:47], v[36:39], a[4:7], v[44:47]
    ds_read_b128 a[100:103], v33 offset:768
    ds_read_b64 a[50:51], v248 offset:3656
    v_mfma_f32_16x16x32_bf16 v[48:51], v[36:39], a[8:11], v[48:51]
    ds_read_b128 a[104:107], v33 offset:1280
    ds_read_b64 a[16:17], v248 offset:3584
    v_mfma_f32_16x16x32_bf16 v[52:55], v[36:39], a[12:15], v[52:55]
    ds_read_b128 a[108:111], v33 offset:1792
    ds_read_b64 a[18:19], v248 offset:3592
    s_waitcnt lgkmcnt(15)
    v_mfma_f32_16x16x32_bf16 v[40:43], v[76:79], a[32:35], v[40:43]
    ds_read_b128 a[128:131], v33 offset:192
    ds_read_b64 a[244:245], v248 offset:3520
    v_mfma_f32_16x16x32_bf16 v[44:47], v[76:79], a[36:39], v[44:47]
    ds_read_b128 a[132:135], v33 offset:704
    ds_read_b64 a[246:247], v248 offset:3528
    v_mfma_f32_16x16x32_bf16 v[48:51], v[76:79], a[40:43], v[48:51]
    ds_read_b128 a[136:139], v33 offset:1216
    ds_read_b64 a[212:213], v248 offset:3456
    v_mfma_f32_16x16x32_bf16 v[52:55], v[76:79], a[44:47], v[52:55]
    ds_read_b128 a[140:143], v33 offset:1728
    ds_read_b64 a[214:215], v248 offset:3464
    v_mfma_f32_16x16x32_bf16 v[40:43], v[80:83], a[64:67], v[40:43]
    ds_read_b128 a[160:163], v33 offset:128
    ds_read_b64 a[180:181], v248 offset:3392
    s_waitcnt lgkmcnt(15)
    v_mfma_f32_16x16x32_bf16 v[44:47], v[80:83], a[68:71], v[44:47]
    ds_read_b128 a[164:167], v33 offset:640
    ds_read_b64 a[182:183], v248 offset:3400
    v_mfma_f32_16x16x32_bf16 v[48:51], v[80:83], a[72:75], v[48:51]
    ds_read_b128 a[168:171], v33 offset:1152
    ds_read_b64 a[148:149], v248 offset:3328
    v_mfma_f32_16x16x32_bf16 v[52:55], v[80:83], a[76:79], v[52:55]
    ds_read_b128 a[172:175], v33 offset:1664
    ds_read_b64 a[150:151], v248 offset:3336
    v_mfma_f32_16x16x32_bf16 v[40:43], v[84:87], a[96:99], v[40:43]
    ds_read_b128 a[192:195], v33 offset:64
    ds_read_b64 a[116:117], v248 offset:3264
    v_mfma_f32_16x16x32_bf16 v[44:47], v[84:87], a[100:103], v[44:47]
    ds_read_b128 a[196:199], v33 offset:576
    ds_read_b64 a[118:119], v248 offset:3272
    s_waitcnt lgkmcnt(15)
    v_mfma_f32_16x16x32_bf16 v[48:51], v[84:87], a[104:107], v[48:51]
    ds_read_b128 a[200:203], v33 offset:1088
    ds_read_b64 a[84:85], v248 offset:3200
    v_mfma_f32_16x16x32_bf16 v[52:55], v[84:87], a[108:111], v[52:55]
    ds_read_b128 a[204:207], v33 offset:1600
    ds_read_b64 a[86:87], v248 offset:3208
    v_mfma_f32_16x16x32_bf16 v[40:43], v[88:91], a[128:131], v[40:43]
    ds_read_b128 a[224:227], v33 offset:0
    ds_read_b64 a[52:53], v248 offset:3136
    v_mfma_f32_16x16x32_bf16 v[44:47], v[88:91], a[132:135], v[44:47]
    ds_read_b128 a[228:231], v33 offset:512
    ds_read_b64 a[54:55], v248 offset:3144
    v_mfma_f32_16x16x32_bf16 v[48:51], v[88:91], a[136:139], v[48:51]
    ds_read_b128 a[232:235], v33 offset:1024
    ds_read_b64 a[20:21], v248 offset:3072
    s_waitcnt lgkmcnt(15)
    v_mfma_f32_16x16x32_bf16 v[52:55], v[88:91], a[140:143], v[52:55]
    ds_read_b128 a[236:239], v33 offset:1536
    ds_read_b64 a[22:23], v248 offset:3080
    v_mfma_f32_16x16x32_bf16 v[40:43], v[92:95], a[160:163], v[40:43]
    ds_read_b64 a[248:249], v248 offset:3008
    ds_read_b64 a[250:251], v248 offset:3016
    v_mfma_f32_16x16x32_bf16 v[44:47], v[92:95], a[164:167], v[44:47]
    ds_read_b64 a[216:217], v248 offset:2944
    ds_read_b64 a[218:219], v248 offset:2952
    v_mfma_f32_16x16x32_bf16 v[48:51], v[92:95], a[168:171], v[48:51]
    ds_read_b64 a[184:185], v248 offset:2880
    ds_read_b64 a[186:187], v248 offset:2888
    v_mfma_f32_16x16x32_bf16 v[52:55], v[92:95], a[172:175], v[52:55]
    ds_read_b64 a[152:153], v248 offset:2816
    ds_read_b64 a[154:155], v248 offset:2824
    s_waitcnt lgkmcnt(15)
    v_mfma_f32_16x16x32_bf16 v[40:43], v[96:99], a[192:195], v[40:43]
    ds_read_b64 a[120:121], v248 offset:2752
    ds_read_b64 a[122:123], v248 offset:2760
    v_mfma_f32_16x16x32_bf16 v[44:47], v[96:99], a[196:199], v[44:47]
    buffer_load_dword v12, v250, s[24:27], 0 offen sc1
    ds_read_b64 a[88:89], v248 offset:2688
    v_mfma_f32_16x16x32_bf16 v[48:51], v[96:99], a[200:203], v[48:51]
    ds_read_b64 a[90:91], v248 offset:2696
    ds_read_b64 a[56:57], v248 offset:2624
    v_mfma_f32_16x16x32_bf16 v[52:55], v[96:99], a[204:207], v[52:55]
    ds_read_b64 a[58:59], v248 offset:2632
    ds_read_b64 a[24:25], v248 offset:2560
    v_mfma_f32_16x16x32_bf16 v[40:43], v[100:103], a[224:227], v[40:43]
    ds_read_b64 a[26:27], v248 offset:2568
    ds_read_b64 a[252:253], v248 offset:2496
    s_waitcnt lgkmcnt(15)
    v_mfma_f32_16x16x32_bf16 v[44:47], v[100:103], a[228:231], v[44:47]
    ds_read_b64 a[254:255], v248 offset:2504
    ds_read_b64 a[220:221], v248 offset:2432
    v_mfma_f32_16x16x32_bf16 v[48:51], v[100:103], a[232:235], v[48:51]
    ds_read_b64 a[222:223], v248 offset:2440
    ds_read_b64 a[188:189], v248 offset:2368
    v_mfma_f32_16x16x32_bf16 v[52:55], v[100:103], a[236:239], v[52:55]
    ds_read_b64 a[190:191], v248 offset:2376
    ds_read_b64 a[156:157], v248 offset:2304
    v_mfma_f32_16x16x32_bf16 v[44:47], v[104:107], a[0:3], v[44:47]
    ds_read_b64 a[158:159], v248 offset:2312
    ds_read_b64 a[124:125], v248 offset:2240
    v_mfma_f32_16x16x32_bf16 v[48:51], v[104:107], a[4:7], v[48:51]
    ds_read_b64 a[126:127], v248 offset:2248
    ds_read_b64 a[92:93], v248 offset:2176
    v_mfma_f32_16x16x32_bf16 v[52:55], v[104:107], a[8:11], v[52:55]
    ds_read_b64 a[94:95], v248 offset:2184
    ds_read_b64 a[60:61], v248 offset:2112
    v_mfma_f32_16x16x32_bf16 v[44:47], v[108:111], a[32:35], v[44:47]
    ds_read_b64 a[62:63], v248 offset:2120
    ds_read_b64 a[28:29], v248 offset:2048
    v_mfma_f32_16x16x32_bf16 v[48:51], v[108:111], a[36:39], v[48:51]
    ds_read_b64 a[30:31], v248 offset:2056
    v_mfma_f32_16x16x32_bf16 v[52:55], v[108:111], a[40:43], v[52:55]
    v_mfma_f32_16x16x32_bf16 v[44:47], v[112:115], a[64:67], v[44:47]
    v_mfma_f32_16x16x32_bf16 v[48:51], v[112:115], a[68:71], v[48:51]
    v_mfma_f32_16x16x32_bf16 v[52:55], v[112:115], a[72:75], v[52:55]
    s_waitcnt vmcnt(1)
    s_barrier
    ds_read_b128 v[200:203], v35 offset:0
    ds_read_b128 v[204:207], v35 offset:1024
    v_mfma_f32_16x16x32_bf16 v[44:47], v[116:119], a[96:99], v[44:47]
    ds_read_b128 v[212:215], v35 offset:2048
    ds_read_b128 v[216:219], v35 offset:3072
    v_mfma_f32_16x16x32_bf16 v[48:51], v[116:119], a[100:103], v[48:51]
    ds_read_b128 v[224:227], v35 offset:4096
    ds_read_b128 v[228:231], v35 offset:5120
    v_mfma_f32_16x16x32_bf16 v[52:55], v[116:119], a[104:107], v[52:55]
    ds_read_b128 v[236:239], v35 offset:6144
    ds_read_b128 v[240:243], v35 offset:7168
    v_mfma_f32_16x16x32_bf16 v[44:47], v[120:123], a[128:131], v[44:47]
    v_mfma_f32_16x16x32_bf16 v[48:51], v[120:123], a[132:135], v[48:51]
    v_permlane16_swap_b32 v16, v18
    v_permlane16_swap_b32 v17, v19
    v_mfma_f32_16x16x32_bf16 v[52:55], v[120:123], a[136:139], v[52:55]
    v_lshlrev_b32 v208, 16, v16
    v_and_b32 v209, s69, v16
    v_mfma_f32_16x16x32_bf16 v[44:47], v[124:127], a[160:163], v[44:47]
    v_lshlrev_b32 v210, 16, v17
    v_and_b32 v211, s69, v17
    v_mfma_f32_16x16x32_bf16 v[48:51], v[124:127], a[164:167], v[48:51]
    s_waitcnt lgkmcnt(6)
    v_fmac_f32 v201, v208, v200
    v_mfma_f32_16x16x32_bf16 v[52:55], v[124:127], a[168:171], v[52:55]
    v_fmac_f32 v203, v209, v202
    v_fmac_f32 v205, v210, v204
    v_mfma_f32_16x16x32_bf16 v[44:47], v[128:131], a[192:195], v[44:47]
    v_fmac_f32 v207, v211, v206
    v_fmac_f32 v208, v201, v40
    v_mfma_f32_16x16x32_bf16 v[48:51], v[128:131], a[196:199], v[48:51]
    v_fmac_f32 v209, v203, v41
    v_fmac_f32 v210, v205, v42
    v_mfma_f32_16x16x32_bf16 v[52:55], v[128:131], a[200:203], v[52:55]
    v_fmac_f32 v211, v207, v43
    v_cvt_pk_bf16_f32 v16, v208, v209
    v_mfma_f32_16x16x32_bf16 v[44:47], v[132:135], a[224:227], v[44:47]
    v_cvt_pk_bf16_f32 v17, v210, v211
    v_lshlrev_b32 v220, 16, v18
    v_mfma_f32_16x16x32_bf16 v[48:51], v[132:135], a[228:231], v[48:51]
    v_and_b32 v221, s69, v18
    v_lshlrev_b32 v222, 16, v19
    v_mfma_f32_16x16x32_bf16 v[52:55], v[132:135], a[232:235], v[52:55]
    v_and_b32 v223, s69, v19
    s_waitcnt lgkmcnt(4)
    v_fmac_f32 v213, v220, v212
    v_mfma_f32_16x16x32_bf16 v[48:51], v[136:139], a[0:3], v[48:51]
    v_fmac_f32 v215, v221, v214
    v_fmac_f32 v217, v222, v216
    v_mfma_f32_16x16x32_bf16 v[52:55], v[136:139], a[4:7], v[52:55]
    v_fmac_f32 v219, v223, v218
    v_mfma_f32_16x16x32_bf16 v[48:51], v[140:143], a[32:35], v[48:51]
    v_mfma_f32_16x16x32_bf16 v[52:55], v[140:143], a[36:39], v[52:55]
    v_mfma_f32_16x16x32_bf16 v[48:51], v[144:147], a[64:67], v[48:51]
    v_mfma_f32_16x16x32_bf16 v[52:55], v[144:147], a[68:71], v[52:55]
    v_fmac_f32 v220, v213, v44
    v_fmac_f32 v221, v215, v45
    v_mfma_f32_16x16x32_bf16 v[48:51], v[148:151], a[96:99], v[48:51]
    v_fmac_f32 v222, v217, v46
    v_fmac_f32 v223, v219, v47
    v_mfma_f32_16x16x32_bf16 v[52:55], v[148:151], a[100:103], v[52:55]
    v_cvt_pk_bf16_f32 v18, v220, v221
    v_cvt_pk_bf16_f32 v19, v222, v223
    v_mfma_f32_16x16x32_bf16 v[48:51], v[152:155], a[128:131], v[48:51]
    s_nop 0
    v_permlane16_swap_b32 v16, v18
    v_mfma_f32_16x16x32_bf16 v[52:55], v[152:155], a[132:135], v[52:55]
    v_permlane16_swap_b32 v17, v19
    buffer_store_dwordx4 v[16:19], v7, s[24:27], s71 offen offset:0 sc1
    v_mfma_f32_16x16x32_bf16 v[48:51], v[156:159], a[160:163], v[48:51]
    v_permlane16_swap_b32 v20, v22
    v_permlane16_swap_b32 v21, v23
    v_mfma_f32_16x16x32_bf16 v[52:55], v[156:159], a[164:167], v[52:55]
    v_lshlrev_b32 v232, 16, v20
    v_and_b32 v233, s69, v20
    v_mfma_f32_16x16x32_bf16 v[48:51], v[160:163], a[192:195], v[48:51]
    v_lshlrev_b32 v234, 16, v21
    v_and_b32 v235, s69, v21
    v_mfma_f32_16x16x32_bf16 v[52:55], v[160:163], a[196:199], v[52:55]
    s_waitcnt lgkmcnt(2)
    v_fmac_f32 v225, v232, v224
    v_mfma_f32_16x16x32_bf16 v[48:51], v[164:167], a[224:227], v[48:51]
    v_fmac_f32 v227, v233, v226
    v_fmac_f32 v229, v234, v228
    v_mfma_f32_16x16x32_bf16 v[52:55], v[164:167], a[228:231], v[52:55]
    v_fmac_f32 v231, v235, v230
    v_mfma_f32_16x16x32_bf16 v[52:55], v[168:171], a[0:3], v[52:55]
    v_mfma_f32_16x16x32_bf16 v[52:55], v[172:175], a[32:35], v[52:55]
    v_mfma_f32_16x16x32_bf16 v[52:55], v[176:179], a[64:67], v[52:55]
    v_mfma_f32_16x16x32_bf16 v[52:55], v[180:183], a[96:99], v[52:55]
    v_mfma_f32_16x16x32_bf16 v[52:55], v[184:187], a[128:131], v[52:55]
    v_mfma_f32_16x16x32_bf16 v[52:55], v[188:191], a[160:163], v[52:55]
    v_mfma_f32_16x16x32_bf16 v[52:55], v[192:195], a[192:195], v[52:55]
    v_fmac_f32 v232, v225, v48
    v_fmac_f32 v233, v227, v49
    v_mfma_f32_16x16x32_bf16 v[52:55], v[196:199], a[224:227], v[52:55]
    v_fmac_f32 v234, v229, v50
    v_fmac_f32 v235, v231, v51
    v_mfma_f32_16x16x32_bf16 v[68:71], a[240:243], a[224:227], 0
    v_cvt_pk_bf16_f32 v20, v232, v233
    v_cvt_pk_bf16_f32 v21, v234, v235
    v_mfma_f32_16x16x32_bf16 v[68:71], a[208:211], a[192:195], v[68:71]
    v_lshlrev_b32 v244, 16, v22
    v_and_b32 v245, s69, v22
    v_mfma_f32_16x16x32_bf16 v[68:71], a[176:179], a[160:163], v[68:71]
    v_lshlrev_b32 v246, 16, v23
    v_and_b32 v247, s69, v23
    v_mfma_f32_16x16x32_bf16 v[68:71], a[144:147], a[128:131], v[68:71]
    s_waitcnt vmcnt(1)
    v_cmp_ne_u32 vcc, s3, v12
    s_cbranch_vccnz CV_fs250
CV_fb250:
    v_mfma_f32_16x16x32_bf16 v[68:71], a[112:115], a[96:99], v[68:71]
    s_mov_b32 m0, s32
    s_nop 0
    buffer_load_dwordx4 v3, s[24:27], s68 offen offset:2048 sc1 lds
    v_mfma_f32_16x16x32_bf16 v[68:71], a[80:83], a[64:67], v[68:71]
    s_waitcnt lgkmcnt(0)
    v_fmac_f32 v237, v244, v236
    v_mfma_f32_16x16x32_bf16 v[68:71], a[48:51], a[32:35], v[68:71]
    buffer_load_dwordx4 v3, s[24:27], s68 offen offset:3072 sc1 lds
    v_fmac_f32 v239, v245, v238
    v_mfma_f32_16x16x32_bf16 v[68:71], a[16:19], a[0:3], v[68:71]
    v_fmac_f32 v241, v246, v240
    v_fmac_f32 v243, v247, v242
    v_mfma_f32_16x16x32_bf16 v[64:67], a[244:247], a[224:227], 0
    s_add_u32 m0, s73, 8192
    s_add_u32 s74, s72, 8192
    buffer_load_dwordx4 v10, s[24:27], s74 offen offset:0 sc1 lds
    v_mfma_f32_16x16x32_bf16 v[68:71], a[244:247], a[228:231], v[68:71]
    v_fmac_f32 v244, v237, v52
    v_fmac_f32 v245, v239, v53
    v_mfma_f32_16x16x32_bf16 v[64:67], a[212:215], a[192:195], v[64:67]
    s_add_u32 s74, s72, 7184
    buffer_load_dwordx4 v10, s[24:27], s74 offen offset:1024 sc1 lds
    v_mfma_f32_16x16x32_bf16 v[68:71], a[212:215], a[196:199], v[68:71]
    v_fmac_f32 v246, v241, v54
    v_fmac_f32 v247, v243, v55
    v_mfma_f32_16x16x32_bf16 v[64:67], a[180:183], a[160:163], v[64:67]
    buffer_load_dwordx4 v[24:27], v7, s[24:27], s70 offen offset:2048 sc1
    v_cvt_pk_bf16_f32 v22, v244, v245
    v_mfma_f32_16x16x32_bf16 v[68:71], a[180:183], a[164:167], v[68:71]
    v_cvt_pk_bf16_f32 v23, v246, v247
    s_nop 0
    v_permlane16_swap_b32 v20, v22
    v_mfma_f32_16x16x32_bf16 v[64:67], a[148:151], a[128:131], v[64:67]
    buffer_load_dwordx4 v[28:31], v7, s[24:27], s70 offen offset:3072 sc1
    v_permlane16_swap_b32 v21, v23
    v_mfma_f32_16x16x32_bf16 v[68:71], a[148:151], a[132:135], v[68:71]
    buffer_store_dwordx4 v[20:23], v7, s[24:27], s71 offen offset:1024 sc1
    v_mfma_f32_16x16x32_bf16 v[64:67], a[116:119], a[96:99], v[64:67]
    v_mfma_f32_16x16x32_bf16 v[68:71], a[116:119], a[100:103], v[68:71]
    v_mfma_f32_16x16x32_bf16 v[64:67], a[84:87], a[64:67], v[64:67]
    v_mfma_f32_16x16x32_bf16 v[68:71], a[84:87], a[68:71], v[68:71]
    v_mfma_f32_16x16x32_bf16 v[64:67], a[52:55], a[32:35], v[64:67]
    v_mfma_f32_16x16x32_bf16 v[68:71], a[52:55], a[36:39], v[68:71]
    v_mfma_f32_16x16x32_bf16 v[64:67], a[20:23], a[0:3], v[64:67]
    v_mfma_f32_16x16x32_bf16 v[68:71], a[20:23], a[4:7], v[68:71]
    v_mfma_f32_16x16x32_bf16 v[60:63], a[248:251], a[224:227], 0
    v_mfma_f32_16x16x32_bf16 v[64:67], a[248:251], a[228:231], v[64:67]
    v_mfma_f32_16x16x32_bf16 v[68:71], a[248:251], a[232:235], v[68:71]
    v_mfma_f32_16x16x32_bf16 v[60:63], a[216:219], a[192:195], v[60:63]
    v_mfma_f32_16x16x32_bf16 v[64:67], a[216:219], a[196:199], v[64:67]
    v_mfma_f32_16x16x32_bf16 v[68:71], a[216:219], a[200:203], v[68:71]
    v_mfma_f32_16x16x32_bf16 v[60:63], a[184:187], a[160:163], v[60:63]
    v_mfma_f32_16x16x32_bf16 v[64:67], a[184:187], a[164:167], v[64:67]
    v_mfma_f32_16x16x32_bf16 v[68:71], a[184:187], a[168:171], v[68:71]
    v_mfma_f32_16x16x32_bf16 v[60:63], a[152:155], a[128:131], v[60:63]
    v_mfma_f32_16x16x32_bf16 v[64:67], a[152:155], a[132:135], v[64:67]
    v_mfma_f32_16x16x32_bf16 v[68:71], a[152:155], a[136:139], v[68:71]
    v_mfma_f32_16x16x32_bf16 v[60:63], a[120:123], a[96:99], v[60:63]
    v_mfma_f32_16x16x32_bf16 v[64:67], a[120:123], a[100:103], v[64:67]
    v_mfma_f32_16x16x32_bf16 v[68:71], a[120:123], a[104:107], v[68:71]
    v_mfma_f32_16x16x32_bf16 v[60:63], a[88:91], a[64:67], v[60:63]
    v_mfma_f32_16x16x32_bf16 v[64:67], a[88:91], a[68:71], v[64:67]
    v_mfma_f32_16x16x32_bf16 v[68:71], a[88:91], a[72:75], v[68:71]
    v_mfma_f32_16x16x32_bf16 v[60:63], a[56:59], a[32:35], v[60:63]
    v_mfma_f32_16x16x32_bf16 v[64:67], a[56:59], a[36:39], v[64:67]
    v_mfma_f32_16x16x32_bf16 v[68:71], a[56:59], a[40:43], v[68:71]
    v_mfma_f32_16x16x32_bf16 v[60:63], a[24:27], a[0:3], v[60:63]
    v_mfma_f32_16x16x32_bf16 v[64:67], a[24:27], a[4:7], v[64:67]
    v_mfma_f32_16x16x32_bf16 v[68:71], a[24:27], a[8:11], v[68:71]
    v_mfma_f32_16x16x32_bf16 v[56:59], a[252:255], a[224:227], 0
    v_mfma_f32_16x16x32_bf16 v[60:63], a[252:255], a[228:231], v[60:63]
    v_mfma_f32_16x16x32_bf16 v[64:67], a[252:255], a[232:235], v[64:67]
    v_mfma_f32_16x16x32_bf16 v[68:71], a[252:255], a[236:239], v[68:71]
    v_mfma_f32_16x16x32_bf16 v[56:59], a[220:223], a[192:195], v[56:59]
    v_mfma_f32_16x16x32_bf16 v[60:63], a[220:223], a[196:199], v[60:63]
    v_mfma_f32_16x16x32_bf16 v[64:67], a[220:223], a[200:203], v[64:67]
    v_mfma_f32_16x16x32_bf16 v[68:71], a[220:223], a[204:207], v[68:71]
    v_mfma_f32_16x16x32_bf16 v[56:59], a[188:191], a[160:163], v[56:59]
    v_mfma_f32_16x16x32_bf16 v[60:63], a[188:191], a[164:167], v[60:63]
    v_mfma_f32_16x16x32_bf16 v[64:67], a[188:191], a[168:171], v[64:67]
    v_mfma_f32_16x16x32_bf16 v[68:71], a[188:191], a[172:175], v[68:71]
    v_mfma_f32_16x16x32_bf16 v[56:59], a[156:159], a[128:131], v[56:59]
    v_mfma_f32_16x16x32_bf16 v[60:63], a[156:159], a[132:135], v[60:63]
    v_mfma_f32_16x16x32_bf16 v[64:67], a[156:159], a[136:139], v[64:67]
    v_mfma_f32_16x16x32_bf16 v[68:71], a[156:159], a[140:143], v[68:71]
    v_mfma_f32_16x16x32_bf16 v[56:59], a[124:127], a[96:99], v[56:59]
    v_mfma_f32_16x16x32_bf16 v[60:63], a[124:127], a[100:103], v[60:63]
    v_mfma_f32_16x16x32_bf16 v[64:67], a[124:127], a[104:107], v[64:67]
    v_mfma_f32_16x16x32_bf16 v[68:71], a[124:127], a[108:111], v[68:71]
    v_mfma_f32_16x16x32_bf16 v[56:59], a[92:95], a[64:67], v[56:59]
    v_mfma_f32_16x16x32_bf16 v[60:63], a[92:95], a[68:71], v[60:63]
    v_mfma_f32_16x16x32_bf16 v[64:67], a[92:95], a[72:75], v[64:67]
    v_mfma_f32_16x16x32_bf16 v[68:71], a[92:95], a[76:79], v[68:71]
    v_mfma_f32_16x16x32_bf16 v[56:59], a[60:63], a[32:35], v[56:59]
    v_mfma_f32_16x16x32_bf16 v[60:63], a[60:63], a[36:39], v[60:63]
    v_mfma_f32_16x16x32_bf16 v[64:67], a[60:63], a[40:43], v[64:67]
    v_mfma_f32_16x16x32_bf16 v[68:71], a[60:63], a[44:47], v[68:71]
    v_mfma_f32_16x16x32_bf16 v[56:59], a[28:31], a[0:3], v[56:59]
    v_mfma_f32_16x16x32_bf16 v[60:63], a[28:31], a[4:7], v[60:63]
    v_mfma_f32_16x16x32_bf16 v[64:67], a[28:31], a[8:11], v[64:67]
    v_mfma_f32_16x16x32_bf16 v[68:71], a[28:31], a[12:15], v[68:71]
    v_mfma_f32_16x16x32_bf16 v[56:59], v[196:199], a[228:231], v[56:59]
    v_mfma_f32_16x16x32_bf16 v[56:59], v[192:195], a[196:199], v[56:59]
    v_mfma_f32_16x16x32_bf16 v[56:59], v[188:191], a[164:167], v[56:59]
    v_mfma_f32_16x16x32_bf16 v[56:59], v[184:187], a[132:135], v[56:59]
    v_mfma_f32_16x16x32_bf16 v[56:59], v[180:183], a[100:103], v[56:59]
    v_mfma_f32_16x16x32_bf16 v[56:59], v[176:179], a[68:71], v[56:59]
    v_mfma_f32_16x16x32_bf16 v[56:59], v[172:175], a[36:39], v[56:59]
    v_mfma_f32_16x16x32_bf16 v[56:59], v[168:171], a[4:7], v[56:59]
    v_mfma_f32_16x16x32_bf16 v[56:59], v[164:167], a[232:235], v[56:59]
    v_mfma_f32_16x16x32_bf16 v[56:59], v[160:163], a[200:203], v[56:59]
    v_mfma_f32_16x16x32_bf16 v[56:59], v[156:159], a[168:171], v[56:59]
    v_mfma_f32_16x16x32_bf16 v[56:59], v[152:155], a[136:139], v[56:59]
    v_mfma_f32_16x16x32_bf16 v[56:59], v[148:151], a[104:107], v[56:59]
    v_mfma_f32_16x16x32_bf16 v[56:59], v[144:147], a[72:75], v[56:59]
    v_mfma_f32_16x16x32_bf16 v[56:59], v[140:143], a[40:43], v[56:59]
    v_mfma_f32_16x16x32_bf16 v[56:59], v[136:139], a[8:11], v[56:59]
    s_waitcnt vmcnt(0)
    s_barrier
    s_cmp_lg_u32 s36, 0
    s_cbranch_scc1 CV_n2
    s_mov_b64 exec, 65535
    v_mov_b32 v8, s3
    v_mul_u32_u24 v9, 16384, v2
    buffer_store_dword v8, v9, s[24:27], s75 offen sc1
    s_mov_b64 exec, -1
CV_n2:
    ds_read_b128 v[200:203], v35 offset:8192
    ds_read_b128 v[204:207], v35 offset:9216
    v_mfma_f32_16x16x32_bf16 v[56:59], v[132:135], a[236:239], v[56:59]
    ds_read_b128 v[212:215], v35 offset:10240
    ds_read_b128 v[216:219], v35 offset:11264
    v_mfma_f32_16x16x32_bf16 v[56:59], v[128:131], a[204:207], v[56:59]
    ds_read_b128 v[224:227], v35 offset:12288
    ds_read_b128 v[228:231], v35 offset:13312
    v_mfma_f32_16x16x32_bf16 v[56:59], v[124:127], a[172:175], v[56:59]
    ds_read_b128 v[236:239], v35 offset:14336
    ds_read_b128 v[240:243], v35 offset:15360
    v_mfma_f32_16x16x32_bf16 v[56:59], v[120:123], a[140:143], v[56:59]
    v_mfma_f32_16x16x32_bf16 v[56:59], v[116:119], a[108:111], v[56:59]
    v_permlane16_swap_b32 v24, v26
    v_permlane16_swap_b32 v25, v27
    v_mfma_f32_16x16x32_bf16 v[56:59], v[112:115], a[76:79], v[56:59]
    v_lshlrev_b32 v208, 16, v24
    v_and_b32 v209, s69, v24
    v_mfma_f32_16x16x32_bf16 v[56:59], v[108:111], a[44:47], v[56:59]
    v_lshlrev_b32 v210, 16, v25
    v_and_b32 v211, s69, v25
    v_mfma_f32_16x16x32_bf16 v[56:59], v[104:107], a[12:15], v[56:59]
    s_waitcnt lgkmcnt(6)
    v_fmac_f32 v201, v208, v200
    v_mfma_f32_16x16x32_bf16 v[60:63], v[196:199], a[232:235], v[60:63]
    v_fmac_f32 v203, v209, v202
    v_fmac_f32 v205, v210, v204
    v_mfma_f32_16x16x32_bf16 v[60:63], v[192:195], a[200:203], v[60:63]
    v_fmac_f32 v207, v211, v206
    v_lshlrev_b32 v220, 16, v26
    v_mfma_f32_16x16x32_bf16 v[60:63], v[188:191], a[168:171], v[60:63]
    v_and_b32 v221, s69, v26
    v_lshlrev_b32 v222, 16, v27
    v_mfma_f32_16x16x32_bf16 v[60:63], v[184:187], a[136:139], v[60:63]
    v_and_b32 v223, s69, v27
    s_waitcnt lgkmcnt(4)
    v_fmac_f32 v213, v220, v212
    v_mfma_f32_16x16x32_bf16 v[60:63], v[180:183], a[104:107], v[60:63]
    v_fmac_f32 v215, v221, v214
    v_fmac_f32 v217, v222, v216
    v_mfma_f32_16x16x32_bf16 v[60:63], v[176:179], a[72:75], v[60:63]
    v_fmac_f32 v219, v223, v218
    v_permlane16_swap_b32 v28, v30
    v_mfma_f32_16x16x32_bf16 v[60:63], v[172:175], a[40:43], v[60:63]
    v_permlane16_swap_b32 v29, v31
    v_lshlrev_b32 v232, 16, v28
    v_mfma_f32_16x16x32_bf16 v[60:63], v[168:171], a[8:11], v[60:63]
    v_and_b32 v233, s69, v28
    v_lshlrev_b32 v234, 16, v29
    v_mfma_f32_16x16x32_bf16 v[60:63], v[164:167], a[236:239], v[60:63]
    v_and_b32 v235, s69, v29
    s_waitcnt lgkmcnt(2)
    v_fmac_f32 v225, v232, v224
    v_mfma_f32_16x16x32_bf16 v[60:63], v[160:163], a[204:207], v[60:63]
    ds_read_b128 a[240:243], v33 offset:2048
    v_fmac_f32 v227, v233, v226
    v_mfma_f32_16x16x32_bf16 v[60:63], v[156:159], a[172:175], v[60:63]
    ds_read_b128 a[208:211], v33 offset:2112
    v_fmac_f32 v229, v234, v228
    v_mfma_f32_16x16x32_bf16 v[60:63], v[152:155], a[140:143], v[60:63]
    ds_read_b128 a[176:179], v33 offset:2176
    v_fmac_f32 v231, v235, v230
    v_mfma_f32_16x16x32_bf16 v[60:63], v[148:151], a[108:111], v[60:63]
    ds_read_b128 a[144:147], v33 offset:2240
    v_lshlrev_b32 v244, 16, v30
    v_mfma_f32_16x16x32_bf16 v[60:63], v[144:147], a[76:79], v[60:63]
    ds_read_b128 a[112:115], v33 offset:2304
    v_and_b32 v245, s69, v30
    v_mfma_f32_16x16x32_bf16 v[60:63], v[140:143], a[44:47], v[60:63]
    ds_read_b128 a[80:83], v33 offset:2368
    v_lshlrev_b32 v246, 16, v31
    v_mfma_f32_16x16x32_bf16 v[60:63], v[136:139], a[12:15], v[60:63]
    ds_read_b128 a[48:51], v33 offset:2432
    v_and_b32 v247, s69, v31
    v_mfma_f32_16x16x32_bf16 v[64:67], v[196:199], a[236:239], v[64:67]
    ds_read_b128 a[16:19], v33 offset:2496
    s_waitcnt lgkmcnt(8)
    v_fmac_f32 v237, v244, v236
    v_mfma_f32_16x16x32_bf16 v[64:67], v[192:195], a[204:207], v[64:67]
    ds_read_b128 a[244:247], v33 offset:2560
    v_fmac_f32 v239, v245, v238
    v_mfma_f32_16x16x32_bf16 v[64:67], v[188:191], a[172:175], v[64:67]
    ds_read_b128 a[212:215], v33 offset:2624
    v_fmac_f32 v241, v246, v240
    v_mfma_f32_16x16x32_bf16 v[64:67], v[184:187], a[140:143], v[64:67]
    ds_read_b128 a[180:183], v33 offset:2688
    v_fmac_f32 v243, v247, v242
    v_mfma_f32_16x16x32_bf16 v[64:67], v[180:183], a[108:111], v[64:67]
    ds_read_b128 a[148:151], v33 offset:2752
    v_mfma_f32_16x16x32_bf16 v[64:67], v[176:179], a[76:79], v[64:67]
    ds_read_b128 a[116:119], v33 offset:2816
    v_mfma_f32_16x16x32_bf16 v[64:67], v[172:175], a[44:47], v[64:67]
    ds_read_b128 a[84:87], v33 offset:2880
    v_mfma_f32_16x16x32_bf16 v[64:67], v[168:171], a[12:15], v[64:67]
    ds_read_b128 a[52:55], v33 offset:2944
    s_waitcnt lgkmcnt(11)
    v_mfma_f32_16x16x32_bf16 v[56:59], v[100:103], a[240:243], v[56:59]
    ds_read_b128 a[20:23], v33 offset:3008
    v_mfma_f32_16x16x32_bf16 v[56:59], v[96:99], a[208:211], v[56:59]
    ds_read_b128 a[248:251], v33 offset:3072
    v_mfma_f32_16x16x32_bf16 v[56:59], v[92:95], a[176:179], v[56:59]
    ds_read_b128 a[216:219], v33 offset:3136
    v_mfma_f32_16x16x32_bf16 v[56:59], v[88:91], a[144:147], v[56:59]
    ds_read_b128 a[184:187], v33 offset:3200
    s_waitcnt lgkmcnt(11)
    v_mfma_f32_16x16x32_bf16 v[56:59], v[84:87], a[112:115], v[56:59]
    ds_read_b128 a[152:155], v33 offset:3264
    v_mfma_f32_16x16x32_bf16 v[56:59], v[80:83], a[80:83], v[56:59]
    ds_read_b128 a[120:123], v33 offset:3328
    v_mfma_f32_16x16x32_bf16 v[56:59], v[76:79], a[48:51], v[56:59]
    ds_read_b128 a[88:91], v33 offset:3392
    v_mfma_f32_16x16x32_bf16 v[56:59], v[36:39], a[16:19], v[56:59]
    ds_read_b128 a[56:59], v33 offset:3456
    v_mfma_f32_16x16x32_bf16 v[56:59], v[72:75], a[16:19], v[56:59]
    ds_read_b128 a[24:27], v33 offset:3520
    v_mfma_f32_16x16x32_bf16 v[60:63], v[132:135], a[240:243], v[60:63]
    ds_read_b128 a[252:255], v33 offset:3584
    v_mfma_f32_16x16x32_bf16 v[60:63], v[128:131], a[208:211], v[60:63]
    ds_read_b128 a[220:223], v33 offset:3648
    v_mfma_f32_16x16x32_bf16 v[60:63], v[124:127], a[176:179], v[60:63]
    ds_read_b128 a[188:191], v33 offset:3712
    v_mfma_f32_16x16x32_bf16 v[60:63], v[120:123], a[144:147], v[60:63]
    ds_read_b128 a[156:159], v33 offset:3776
    v_mfma_f32_16x16x32_bf16 v[60:63], v[116:119], a[112:115], v[60:63]
    ds_read_b128 a[124:127], v33 offset:3840
    v_mfma_f32_16x16x32_bf16 v[60:63], v[112:115], a[80:83], v[60:63]
    ds_read_b128 a[92:95], v33 offset:3904
    v_mfma_f32_16x16x32_bf16 v[60:63], v[108:111], a[48:51], v[60:63]
    ds_read_b128 a[60:63], v33 offset:3968
    v_mfma_f32_16x16x32_bf16 v[60:63], v[104:107], a[16:19], v[60:63]
    ds_read_b128 a[28:31], v33 offset:4032
    v_fmac_f32 v208, v201, v56
    s_waitcnt lgkmcnt(15)
    v_mfma_f32_16x16x32_bf16 v[60:63], v[100:103], a[244:247], v[60:63]
    v_fmac_f32 v209, v203, v57
    v_fmac_f32 v210, v205, v58
    v_mfma_f32_16x16x32_bf16 v[60:63], v[96:99], a[212:215], v[60:63]
    v_fmac_f32 v211, v207, v59
    v_cvt_pk_bf16_f32 v24, v208, v209
    v_mfma_f32_16x16x32_bf16 v[60:63], v[92:95], a[180:183], v[60:63]
    v_cvt_pk_bf16_f32 v25, v210, v211
    v_mfma_f32_16x16x32_bf16 v[60:63], v[88:91], a[148:151], v[60:63]
    v_mfma_f32_16x16x32_bf16 v[60:63], v[84:87], a[116:119], v[60:63]
    v_mfma_f32_16x16x32_bf16 v[60:63], v[80:83], a[84:87], v[60:63]
    v_mfma_f32_16x16x32_bf16 v[60:63], v[76:79], a[52:55], v[60:63]
    v_mfma_f32_16x16x32_bf16 v[60:63], v[36:39], a[20:23], v[60:63]
    v_mfma_f32_16x16x32_bf16 v[60:63], v[72:75], a[20:23], v[60:63]
    v_mfma_f32_16x16x32_bf16 v[64:67], v[164:167], a[240:243], v[64:67]
    v_mfma_f32_16x16x32_bf16 v[64:67], v[160:163], a[208:211], v[64:67]
    v_mfma_f32_16x16x32_bf16 v[64:67], v[156:159], a[176:179], v[64:67]
    v_mfma_f32_16x16x32_bf16 v[64:67], v[152:155], a[144:147], v[64:67]
    v_mfma_f32_16x16x32_bf16 v[64:67], v[148:151], a[112:115], v[64:67]
    v_mfma_f32_16x16x32_bf16 v[64:67], v[144:147], a[80:83], v[64:67]
    v_mfma_f32_16x16x32_bf16 v[64:67], v[140:143], a[48:51], v[64:67]
    v_mfma_f32_16x16x32_bf16 v[64:67], v[136:139], a[16:19], v[64:67]
    v_fmac_f32 v220, v213, v60
    v_fmac_f32 v221, v215, v61
    v_mfma_f32_16x16x32_bf16 v[64:67], v[132:135], a[244:247], v[64:67]
    v_fmac_f32 v222, v217, v62
    v_fmac_f32 v223, v219, v63
    v_mfma_f32_16x16x32_bf16 v[64:67], v[128:131], a[212:215], v[64:67]
    v_cvt_pk_bf16_f32 v26, v220, v221
    v_cvt_pk_bf16_f32 v27, v222, v223
    v_mfma_f32_16x16x32_bf16 v[64:67], v[124:127], a[180:183], v[64:67]
    s_nop 0
    v_permlane16_swap_b32 v24, v26
    v_mfma_f32_16x16x32_bf16 v[64:67], v[120:123], a[148:151], v[64:67]
    v_permlane16_swap_b32 v25, v27
    buffer_store_dwordx4 v[24:27], v7, s[24:27], s71 offen offset:2048 sc1
    v_mfma_f32_16x16x32_bf16 v[64:67], v[116:119], a[116:119], v[64:67]
    v_mfma_f32_16x16x32_bf16 v[64:67], v[112:115], a[84:87], v[64:67]
    v_mfma_f32_16x16x32_bf16 v[64:67], v[108:111], a[52:55], v[64:67]
    v_mfma_f32_16x16x32_bf16 v[64:67], v[104:107], a[20:23], v[64:67]
    v_mfma_f32_16x16x32_bf16 v[64:67], v[100:103], a[248:251], v[64:67]
    s_waitcnt lgkmcnt(11)
    v_mfma_f32_16x16x32_bf16 v[64:67], v[96:99], a[216:219], v[64:67]
    v_mfma_f32_16x16x32_bf16 v[64:67], v[92:95], a[184:187], v[64:67]
    v_mfma_f32_16x16x32_bf16 v[64:67], v[88:91], a[152:155], v[64:67]
    v_mfma_f32_16x16x32_bf16 v[64:67], v[84:87], a[120:123], v[64:67]
    s_waitcnt lgkmcnt(8)
    v_mfma_f32_16x16x32_bf16 v[64:67], v[80:83], a[88:91], v[64:67]
    v_mfma_f32_16x16x32_bf16 v[64:67], v[76:79], a[56:59], v[64:67]
    v_mfma_f32_16x16x32_bf16 v[64:67], v[36:39], a[24:27], v[64:67]
    v_mfma_f32_16x16x32_bf16 v[64:67], v[72:75], a[24:27], v[64:67]
    v_mfma_f32_16x16x32_bf16 v[68:71], v[196:199], a[240:243], v[68:71]
    v_mfma_f32_16x16x32_bf16 v[68:71], v[192:195], a[208:211], v[68:71]
    v_mfma_f32_16x16x32_bf16 v[68:71], v[188:191], a[176:179], v[68:71]
    v_mfma_f32_16x16x32_bf16 v[68:71], v[184:187], a[144:147], v[68:71]
    v_mfma_f32_16x16x32_bf16 v[68:71], v[180:183], a[112:115], v[68:71]
    v_mfma_f32_16x16x32_bf16 v[68:71], v[176:179], a[80:83], v[68:71]
    v_mfma_f32_16x16x32_bf16 v[68:71], v[172:175], a[48:51], v[68:71]
    v_mfma_f32_16x16x32_bf16 v[68:71], v[168:171], a[16:19], v[68:71]
    v_fmac_f32 v232, v225, v64
    v_fmac_f32 v233, v227, v65
    v_mfma_f32_16x16x32_bf16 v[68:71], v[164:167], a[244:247], v[68:71]
    v_fmac_f32 v234, v229, v66
    v_fmac_f32 v235, v231, v67
    v_mfma_f32_16x16x32_bf16 v[68:71], v[160:163], a[212:215], v[68:71]
    v_cvt_pk_bf16_f32 v28, v232, v233
    v_cvt_pk_bf16_f32 v29, v234, v235
    v_mfma_f32_16x16x32_bf16 v[68:71], v[156:159], a[180:183], v[68:71]
    v_mfma_f32_16x16x32_bf16 v[68:71], v[152:155], a[148:151], v[68:71]
    v_mfma_f32_16x16x32_bf16 v[68:71], v[148:151], a[116:119], v[68:71]
    v_mfma_f32_16x16x32_bf16 v[68:71], v[144:147], a[84:87], v[68:71]
    v_mfma_f32_16x16x32_bf16 v[68:71], v[140:143], a[52:55], v[68:71]
    v_mfma_f32_16x16x32_bf16 v[68:71], v[136:139], a[20:23], v[68:71]
    v_mfma_f32_16x16x32_bf16 v[68:71], v[132:135], a[248:251], v[68:71]
    v_mfma_f32_16x16x32_bf16 v[68:71], v[128:131], a[216:219], v[68:71]
    v_mfma_f32_16x16x32_bf16 v[68:71], v[124:127], a[184:187], v[68:71]
    v_mfma_f32_16x16x32_bf16 v[68:71], v[120:123], a[152:155], v[68:71]
    v_mfma_f32_16x16x32_bf16 v[68:71], v[116:119], a[120:123], v[68:71]
    v_mfma_f32_16x16x32_bf16 v[68:71], v[112:115], a[88:91], v[68:71]
    v_mfma_f32_16x16x32_bf16 v[68:71], v[108:111], a[56:59], v[68:71]
    v_mfma_f32_16x16x32_bf16 v[68:71], v[104:107], a[24:27], v[68:71]
    s_waitcnt lgkmcnt(4)
    v_mfma_f32_16x16x32_bf16 v[68:71], v[100:103], a[252:255], v[68:71]
    v_mfma_f32_16x16x32_bf16 v[68:71], v[96:99], a[220:223], v[68:71]
    v_mfma_f32_16x16x32_bf16 v[68:71], v[92:95], a[188:191], v[68:71]
    v_mfma_f32_16x16x32_bf16 v[68:71], v[88:91], a[156:159], v[68:71]
    s_waitcnt lgkmcnt(3)
    v_mfma_f32_16x16x32_bf16 v[68:71], v[84:87], a[124:127], v[68:71]
    s_waitcnt lgkmcnt(2)
    v_mfma_f32_16x16x32_bf16 v[68:71], v[80:83], a[92:95], v[68:71]
    s_waitcnt lgkmcnt(1)
    v_mfma_f32_16x16x32_bf16 v[68:71], v[76:79], a[60:63], v[68:71]
    s_waitcnt lgkmcnt(0)
    v_mfma_f32_16x16x32_bf16 v[68:71], v[36:39], a[28:31], v[68:71]
    v_mfma_f32_16x16x32_bf16 v[68:71], v[72:75], a[28:31], v[68:71]
    s_nop 7
    v_fmac_f32 v244, v237, v68
    v_fmac_f32 v245, v239, v69
    v_fmac_f32 v246, v241, v70
    v_fmac_f32 v247, v243, v71
    v_cvt_pk_bf16_f32 v30, v244, v245
    v_cvt_pk_bf16_f32 v31, v246, v247
    s_nop 0
    v_permlane16_swap_b32 v28, v30
    v_permlane16_swap_b32 v29, v31
    buffer_store_dwordx4 v[28:31], v7, s[24:27], s71 offen offset:3072 sc1
    s_branch JOIN
NOP0:
    s_and_b32 s34, s2, 7
    s_lshl_b32 s34, s34, 3
    s_bfe_u32 s31, s2, 0x30003
    s_add_u32 s34, s34, s31
    s_lshl_b32 s33, s34, 5
    s_lshl_b32 s31, s36, 3
    s_add_u32 s33, s33, s31
    v_lshrrev_b32 v5, 3, v2
    v_add_u32 v5, s33, v5
    v_and_b32 v7, 7, v2
    v_mul_u32_u24 v6, 1152, v5
    v_lshl_add_u32 v6, v7, 4, v6
    s_waitcnt lgkmcnt(0)
    s_mov_b32 s16, s40
    s_mov_b32 s17, s41
    s_mov_b32 s18, 2359296
    s_mov_b32 s19, 0x00020000
    buffer_load_dwordx4 v[12:15], v6, s[16:19], 0 offen offset:0 nt
    s_mov_b32 s24, s64
    s_mov_b32 s25, s65
    s_mov_b32 s26, 268435456
    s_mov_b32 s27, 0x00020000
    s_mov_b32 s6, 7733248
    buffer_load_dword v62, v4, s[24:27], s6 offen sc1
    buffer_load_dwordx4 v[16:19], v6, s[16:19], 0 offen offset:128 nt
    buffer_load_dwordx4 v[20:23], v6, s[16:19], 0 offen offset:256 nt
    buffer_load_dwordx4 v[24:27], v6, s[16:19], 0 offen offset:384 nt
    buffer_load_dwordx4 v[28:31], v6, s[16:19], 0 offen offset:512 nt
    buffer_load_dwordx4 v[32:35], v6, s[16:19], 0 offen offset:640 nt
    buffer_load_dwordx4 v[36:39], v6, s[16:19], 0 offen offset:768 nt
    buffer_load_dwordx4 v[40:43], v6, s[16:19], 0 offen offset:896 nt
    buffer_load_dwordx4 v[44:47], v6, s[16:19], 0 offen offset:1024 nt
    s_cmp_lg_u32 s36, 3
    s_cbranch_scc1 RI_11
    s_getreg_b32 s4, hwreg(HW_REG_XCC_ID, 0, 3)
    s_mov_b32 s72, s62
    s_mov_b32 s73, s63
    s_mov_b32 s74, 256
    s_mov_b32 s75, 0x00020000
    s_lshl_b32 s6, s4, 5
    s_mov_b64 exec, 1
    v_mov_b32 v58, 1
    buffer_atomic_add v58, v4, s[72:75], s6 offen sc0 sc1
    s_mov_b64 exec, -1
RI_11:
    v_lshlrev_b32 v5, 3, v5
    s_mov_b32 s31, 0x3f803f80
    v_mov_b32 v48, 0
    v_mov_b32 v49, 0
    v_mov_b32 v50, 0
    v_mov_b32 v51, 0
    s_sub_u32 s32, s2, 184
    s_lshr_b32 s38, s32, 2
    s_and_b32 s32, s32, 3
    s_cmp_ge_u32 s38, 9
    s_cselect_b32 s8, s56, s54
    s_cselect_b32 s9, s57, s55
    s_cselect_b32 s37, 9, 0
    s_mov_b32 s10, 5308416
    s_mov_b32 s11, 0x00020000
    s_sub_u32 s37, s38, s37
    s_mul_i32 s37, s37, 1024
    s_lshl_b32 s33, s32, 2
    s_add_u32 s33, s33, s36
    s_mul_i32 s33, s33, 331776
    s_add_u32 s33, s33, s37
    s_mul_i32 s32, s32, 36864
    s_mul_i32 s38, s38, 4
    s_min_u32 s37, s36, 3
    s_add_u32 s38, s38, s37
    s_lshl_b32 s38, s38, 9
    s_add_u32 s32, s32, s38
    s_add_u32 s32, s32, 7110656
    v_lshrrev_b32 v136, 4, v2
    v_mul_u32_u24 v136, 8960, v136
    v_add_u32 v140, v136, v3
    s_cmp_eq_u32 s36, 3
    s_waitcnt vmcnt(1)
    s_cbranch_scc1 QW_12
    s_waitcnt vmcnt(0)
QW_12:
    v_readfirstlane_b32 s3, v62
    s_add_u32 s3, s3, 1
    v_dot2c_f32_bf16 v48, s31, v12
    v_dot2c_f32_bf16 v50, v12, v12
    v_dot2c_f32_bf16 v49, s31, v13
    v_dot2c_f32_bf16 v51, v13, v13
    v_dot2c_f32_bf16 v48, s31, v14
    v_dot2c_f32_bf16 v50, v14, v14
    v_dot2c_f32_bf16 v49, s31, v15
    v_dot2c_f32_bf16 v51, v15, v15
    v_dot2c_f32_bf16 v48, s31, v16
    v_dot2c_f32_bf16 v50, v16, v16
    v_dot2c_f32_bf16 v49, s31, v17
    v_dot2c_f32_bf16 v51, v17, v17
    v_dot2c_f32_bf16 v48, s31, v18
    v_dot2c_f32_bf16 v50, v18, v18
    v_dot2c_f32_bf16 v49, s31, v19
    v_dot2c_f32_bf16 v51, v19, v19
    v_dot2c_f32_bf16 v48, s31, v20
    v_dot2c_f32_bf16 v50, v20, v20
    v_dot2c_f32_bf16 v49, s31, v21
    v_dot2c_f32_bf16 v51, v21, v21
    v_dot2c_f32_bf16 v48, s31, v22
    v_dot2c_f32_bf16 v50, v22, v22
    v_dot2c_f32_bf16 v49, s31, v23
    v_dot2c_f32_bf16 v51, v23, v23
    v_dot2c_f32_bf16 v48, s31, v24
    v_dot2c_f32_bf16 v50, v24, v24
    v_dot2c_f32_bf16 v49, s31, v25
    v_dot2c_f32_bf16 v51, v25, v25
    v_dot2c_f32_bf16 v48, s31, v26
    v_dot2c_f32_bf16 v50, v26, v26
    v_dot2c_f32_bf16 v49, s31, v27
    v_dot2c_f32_bf16 v51, v27, v27
    v_dot2c_f32_bf16 v48, s31, v28
    v_dot2c_f32_bf16 v50, v28, v28
    v_dot2c_f32_bf16 v49, s31, v29
    v_dot2c_f32_bf16 v51, v29, v29
    v_dot2c_f32_bf16 v48, s31, v30
    v_dot2c_f32_bf16 v50, v30, v30
    v_dot2c_f32_bf16 v49, s31, v31
    v_dot2c_f32_bf16 v51, v31, v31
    v_dot2c_f32_bf16 v48, s31, v32
    v_dot2c_f32_bf16 v50, v32, v32
    v_dot2c_f32_bf16 v49, s31, v33
    v_dot2c_f32_bf16 v51, v33, v33
    v_dot2c_f32_bf16 v48, s31, v34
    v_dot2c_f32_bf16 v50, v34, v34
    v_dot2c_f32_bf16 v49, s31, v35
    v_dot2c_f32_bf16 v51, v35, v35
    v_dot2c_f32_bf16 v48, s31, v36
    v_dot2c_f32_bf16 v50, v36, v36
    v_dot2c_f32_bf16 v49, s31, v37
    v_dot2c_f32_bf16 v51, v37, v37
    v_dot2c_f32_bf16 v48, s31, v38
    v_dot2c_f32_bf16 v50, v38, v38
    v_dot2c_f32_bf16 v49, s31, v39
    v_dot2c_f32_bf16 v51, v39, v39
    v_dot2c_f32_bf16 v48, s31, v40
    v_dot2c_f32_bf16 v50, v40, v40
    v_dot2c_f32_bf16 v49, s31, v41
    v_dot2c_f32_bf16 v51, v41, v41
    v_dot2c_f32_bf16 v48, s31, v42
    v_dot2c_f32_bf16 v50, v42, v42
    v_dot2c_f32_bf16 v49, s31, v43
    v_dot2c_f32_bf16 v51, v43, v43
    v_dot2c_f32_bf16 v48, s31, v44
    v_dot2c_f32_bf16 v50, v44, v44
    v_dot2c_f32_bf16 v49, s31, v45
    v_dot2c_f32_bf16 v51, v45, v45
    v_dot2c_f32_bf16 v48, s31, v46
    v_dot2c_f32_bf16 v50, v46, v46
    v_dot2c_f32_bf16 v49, s31, v47
    v_dot2c_f32_bf16 v51, v47, v47
    s_nop 2
    v_add_f32 v48, v48, v49
    v_add_f32 v50, v50, v51
    s_nop 1
    v_add_f32_dpp v48, v48, v48 quad_perm:[1,0,3,2] row_mask:0xf bank_mask:0xf
    v_add_f32_dpp v50, v50, v50 quad_perm:[1,0,3,2] row_mask:0xf bank_mask:0xf
    s_nop 1
    v_add_f32_dpp v48, v48, v48 quad_perm:[2,3,0,1] row_mask:0xf bank_mask:0xf
    v_add_f32_dpp v50, v50, v50 quad_perm:[2,3,0,1] row_mask:0xf bank_mask:0xf
    s_nop 1
    v_add_f32_dpp v48, v48, v48 row_half_mirror row_mask:0xf bank_mask:0xf
    v_add_f32_dpp v50, v50, v50 row_half_mirror row_mask:0xf bank_mask:0xf
    v_mul_f32 v48, 0.001736111111111111, v48
    v_mul_f32 v50, 0.001736111111111111, v50
    v_fma_f32 v50, -v48, v48, v50
    v_max_f32 v50, 0, v50
    v_add_f32 v50, 0x3727c5ac, v50
    v_rsq_f32 v52, v50
    s_nop 0
    v_mul_f32 v53, v48, v52
    v_sub_f32 v53, 0, v53
    s_mov_b32 s31, 7077888
    v_cmp_eq_u32 vcc, 0, v7
    s_and_saveexec_b64 s[38:39], vcc
    buffer_store_dwordx2 v[52:53], v5, s[24:27], s31 offen sc1
    s_mov_b64 exec, -1
    s_waitcnt vmcnt(0)
    s_barrier
    s_cmp_lg_u32 s36, 0
    s_cbranch_scc1 CS_j
    s_mul_i32 s38, s34, 64
    s_add_u32 s38, s38, 50331648
    s_mov_b64 exec, 65535
    v_mov_b32 v8, s3
    v_mul_u32_u24 v9, 4096, v2
    buffer_store_dword v8, v9, s[24:27], s38 offen sc1
    s_mov_b64 exec, -1
    s_branch CS_j
PACK:
    s_cmp_lt_u32 s2, 184
    s_cbranch_scc1 PK2
    s_sub_u32 s32, s2, 184
    s_lshr_b32 s38, s32, 2
    s_and_b32 s32, s32, 3
    s_cmp_ge_u32 s38, 9
    s_cselect_b32 s8, s56, s54
    s_cselect_b32 s9, s57, s55
    s_cselect_b32 s37, 9, 0
    s_mov_b32 s10, 5308416
    s_mov_b32 s11, 0x00020000
    s_sub_u32 s37, s38, s37
    s_mul_i32 s37, s37, 1024
    s_lshl_b32 s33, s32, 2
    s_add_u32 s33, s33, s36
    s_mul_i32 s33, s33, 331776
    s_add_u32 s33, s33, s37
    s_mul_i32 s32, s32, 36864
    s_mul_i32 s38, s38, 4
    s_min_u32 s37, s36, 3
    s_add_u32 s38, s38, s37
    s_lshl_b32 s38, s38, 9
    s_add_u32 s32, s32, s38
    s_add_u32 s32, s32, 7110656
    v_lshrrev_b32 v136, 4, v2
    v_mul_u32_u24 v136, 8960, v136
    v_add_u32 v140, v136, v3
CS_j:
    buffer_load_dwordx4 a[0:3], v140, s[8:11], s33 offen offset:0
    buffer_load_dwordx4 a[4:7], v140, s[8:11], s33 offen offset:256
    buffer_load_dwordx4 a[8:11], v140, s[8:11], s33 offen offset:512
    buffer_load_dwordx4 a[12:15], v140, s[8:11], s33 offen offset:768
    s_add_u32 s33, s33, 36864
    buffer_load_dwordx4 a[16:19], v140, s[8:11], s33 offen offset:0
    buffer_load_dwordx4 a[20:23], v140, s[8:11], s33 offen offset:256
    buffer_load_dwordx4 a[24:27], v140, s[8:11], s33 offen offset:512
    buffer_load_dwordx4 a[28:31], v140, s[8:11], s33 offen offset:768
    s_add_u32 s33, s33, 36864
    buffer_load_dwordx4 a[32:35], v140, s[8:11], s33 offen offset:0
    buffer_load_dwordx4 a[36:39], v140, s[8:11], s33 offen offset:256
    buffer_load_dwordx4 a[40:43], v140, s[8:11], s33 offen offset:512
    buffer_load_dwordx4 a[44:47], v140, s[8:11], s33 offen offset:768
    s_add_u32 s33, s33, 36864
    buffer_load_dwordx4 a[48:51], v140, s[8:11], s33 offen offset:0
    buffer_load_dwordx4 a[52:55], v140, s[8:11], s33 offen offset:256
    buffer_load_dwordx4 a[56:59], v140, s[8:11], s33 offen offset:512
    buffer_load_dwordx4 a[60:63], v140, s[8:11], s33 offen offset:768
    s_add_u32 s33, s33, 36864
    buffer_load_dwordx4 a[64:67], v140, s[8:11], s33 offen offset:0
    buffer_load_dwordx4 a[68:71], v140, s[8:11], s33 offen offset:256
    buffer_load_dwordx4 a[72:75], v140, s[8:11], s33 offen offset:512
    buffer_load_dwordx4 a[76:79], v140, s[8:11], s33 offen offset:768
    s_add_u32 s33, s33, 36864
    buffer_load_dwordx4 a[80:83], v140, s[8:11], s33 offen offset:0
    buffer_load_dwordx4 a[84:87], v140, s[8:11], s33 offen offset:256
    buffer_load_dwordx4 a[88:91], v140, s[8:11], s33 offen offset:512
    buffer_load_dwordx4 a[92:95], v140, s[8:11], s33 offen offset:768
    s_add_u32 s33, s33, 36864
    buffer_load_dwordx4 a[96:99], v140, s[8:11], s33 offen offset:0
    buffer_load_dwordx4 a[100:103], v140, s[8:11], s33 offen offset:256
    buffer_load_dwordx4 a[104:107], v140, s[8:11], s33 offen offset:512
    buffer_load_dwordx4 a[108:111], v140, s[8:11], s33 offen offset:768
    s_add_u32 s33, s33, 36864
    buffer_load_dwordx4 a[112:115], v140, s[8:11], s33 offen offset:0
    buffer_load_dwordx4 a[116:119], v140, s[8:11], s33 offen offset:256
    buffer_load_dwordx4 a[120:123], v140, s[8:11], s33 offen offset:512
    buffer_load_dwordx4 a[124:127], v140, s[8:11], s33 offen offset:768
    s_add_u32 s33, s33, 36864
    buffer_load_dwordx4 a[128:131], v140, s[8:11], s33 offen offset:0
    buffer_load_dwordx4 a[132:135], v140, s[8:11], s33 offen offset:256
    buffer_load_dwordx4 a[136:139], v140, s[8:11], s33 offen offset:512
    buffer_load_dwordx4 a[140:143], v140, s[8:11], s33 offen offset:768
    s_add_u32 s33, s33, 36864
    v_and_b32 v141, 1, v2
    v_lshlrev_b32 v141, 4, v141
    v_mov_b32 v142, 0x3f80
    v_lshlrev_b32 v141, v141, v142
    v_bfe_u32 v142, v2, 1, 3
    v_cmp_eq_u32 vcc, 0, v142
    s_nop 1
    v_cndmask_b32 v136, 0, v141, vcc
    v_cmp_eq_u32 vcc, 1, v142
    s_nop 1
    v_cndmask_b32 v137, 0, v141, vcc
    v_cmp_eq_u32 vcc, 2, v142
    s_nop 1
    v_cndmask_b32 v138, 0, v141, vcc
    v_cmp_eq_u32 vcc, 3, v142
    s_nop 1
    v_cndmask_b32 v139, 0, v141, vcc
    s_lshl_b32 s37, s36, 10
    s_add_u32 s37, s37, 81920
    v_add_u32 v141, s37, v3
    v_and_b32 v142, 15, v2
    v_and_b32 v143, 16, v2
    v_lshl_add_u32 v142, v142, 5, v143
    v_and_b32 v143, 32, v2
    v_lshl_add_u32 v142, v143, 25, v142
    s_min_u32 s37, s36, 3
    s_lshl_b32 s37, s37, 12
    s_add_u32 s37, s37, 81920
    v_add_u32 v143, s37, v3
    s_cmp_lg_u32 s36, 3
    s_cbranch_scc1 RP_13
    v_readfirstlane_b32 s6, v58
    v_mov_b32 v59, 112640
    s_cmp_lt_u32 s6, 32
    s_cbranch_scc0 RPs_15
RPok_14:
    s_lshl_b32 s6, s6, 3
    s_add_u32 s6, s6, s4
    v_mov_b32 v58, s6
    ds_write_b32 v59, v58
    s_waitcnt lgkmcnt(0)
RP_13:
    s_waitcnt vmcnt(35)
    v_mfma_f32_16x16x32_bf16 v[144:147], v[136:139], a[0:3], 0
    s_waitcnt vmcnt(34)
    v_mfma_f32_16x16x32_bf16 v[148:151], v[136:139], a[4:7], 0
    s_waitcnt vmcnt(33)
    v_mfma_f32_16x16x32_bf16 v[152:155], v[136:139], a[8:11], 0
    s_waitcnt vmcnt(32)
    v_mfma_f32_16x16x32_bf16 v[156:159], v[136:139], a[12:15], 0
    s_waitcnt vmcnt(31)
    v_mfma_f32_16x16x32_bf16 v[144:147], v[136:139], a[16:19], v[144:147]
    s_waitcnt vmcnt(30)
    v_mfma_f32_16x16x32_bf16 v[148:151], v[136:139], a[20:23], v[148:151]
    s_waitcnt vmcnt(29)
    v_mfma_f32_16x16x32_bf16 v[152:155], v[136:139], a[24:27], v[152:155]
    s_waitcnt vmcnt(28)
    v_mfma_f32_16x16x32_bf16 v[156:159], v[136:139], a[28:31], v[156:159]
    s_waitcnt vmcnt(27)
    v_mfma_f32_16x16x32_bf16 v[144:147], v[136:139], a[32:35], v[144:147]
    s_waitcnt vmcnt(26)
    v_mfma_f32_16x16x32_bf16 v[148:151], v[136:139], a[36:39], v[148:151]
    s_waitcnt vmcnt(25)
    v_mfma_f32_16x16x32_bf16 v[152:155], v[136:139], a[40:43], v[152:155]
    s_waitcnt vmcnt(24)
    v_mfma_f32_16x16x32_bf16 v[156:159], v[136:139], a[44:47], v[156:159]
    s_waitcnt vmcnt(23)
    v_mfma_f32_16x16x32_bf16 v[144:147], v[136:139], a[48:51], v[144:147]
    s_waitcnt vmcnt(22)
    v_mfma_f32_16x16x32_bf16 v[148:151], v[136:139], a[52:55], v[148:151]
    s_waitcnt vmcnt(21)
    v_mfma_f32_16x16x32_bf16 v[152:155], v[136:139], a[56:59], v[152:155]
    s_waitcnt vmcnt(20)
    v_mfma_f32_16x16x32_bf16 v[156:159], v[136:139], a[60:63], v[156:159]
    s_waitcnt vmcnt(19)
    v_mfma_f32_16x16x32_bf16 v[144:147], v[136:139], a[64:67], v[144:147]
    s_waitcnt vmcnt(18)
    v_mfma_f32_16x16x32_bf16 v[148:151], v[136:139], a[68:71], v[148:151]
    s_waitcnt vmcnt(17)
    v_mfma_f32_16x16x32_bf16 v[152:155], v[136:139], a[72:75], v[152:155]
    s_waitcnt vmcnt(16)
    v_mfma_f32_16x16x32_bf16 v[156:159], v[136:139], a[76:79], v[156:159]
    s_waitcnt vmcnt(15)
    v_mfma_f32_16x16x32_bf16 v[144:147], v[136:139], a[80:83], v[144:147]
    s_waitcnt vmcnt(14)
    v_mfma_f32_16x16x32_bf16 v[148:151], v[136:139], a[84:87], v[148:151]
    s_waitcnt vmcnt(13)
    v_mfma_f32_16x16x32_bf16 v[152:155], v[136:139], a[88:91], v[152:155]
    s_waitcnt vmcnt(12)
    v_mfma_f32_16x16x32_bf16 v[156:159], v[136:139], a[92:95], v[156:159]
    s_waitcnt vmcnt(11)
    v_mfma_f32_16x16x32_bf16 v[144:147], v[136:139], a[96:99], v[144:147]
    s_waitcnt vmcnt(10)
    v_mfma_f32_16x16x32_bf16 v[148:151], v[136:139], a[100:103], v[148:151]
    s_waitcnt vmcnt(9)
    v_mfma_f32_16x16x32_bf16 v[152:155], v[136:139], a[104:107], v[152:155]
    s_waitcnt vmcnt(8)
    v_mfma_f32_16x16x32_bf16 v[156:159], v[136:139], a[108:111], v[156:159]
    s_waitcnt vmcnt(7)
    v_mfma_f32_16x16x32_bf16 v[144:147], v[136:139], a[112:115], v[144:147]
    s_waitcnt vmcnt(6)
    v_mfma_f32_16x16x32_bf16 v[148:151], v[136:139], a[116:119], v[148:151]
    s_waitcnt vmcnt(5)
    v_mfma_f32_16x16x32_bf16 v[152:155], v[136:139], a[120:123], v[152:155]
    s_waitcnt vmcnt(4)
    v_mfma_f32_16x16x32_bf16 v[156:159], v[136:139], a[124:127], v[156:159]
    s_waitcnt vmcnt(3)
    v_mfma_f32_16x16x32_bf16 v[144:147], v[136:139], a[128:131], v[144:147]
    s_waitcnt vmcnt(2)
    v_mfma_f32_16x16x32_bf16 v[148:151], v[136:139], a[132:135], v[148:151]
    s_waitcnt vmcnt(1)
    v_mfma_f32_16x16x32_bf16 v[152:155], v[136:139], a[136:139], v[152:155]
    s_waitcnt vmcnt(0)
    v_mfma_f32_16x16x32_bf16 v[156:159], v[136:139], a[140:143], v[156:159]
    s_nop 7
    ds_write_b128 v141, v[144:147] offset:0
    ds_write_b128 v141, v[148:151] offset:4096
    ds_write_b128 v141, v[152:155] offset:8192
    ds_write_b128 v141, v[156:159] offset:12288
    s_waitcnt lgkmcnt(0)
    s_barrier
    ds_read_b128 v[144:147], v143 offset:0
    ds_read_b128 v[148:151], v143 offset:1024
    ds_read_b128 v[152:155], v143 offset:2048
    ds_read_b128 v[156:159], v143 offset:3072
    s_waitcnt lgkmcnt(2)
    v_add_f32 v144, v144, v148
    v_add_f32 v145, v145, v149
    v_add_f32 v146, v146, v150
    v_add_f32 v147, v147, v151
    s_waitcnt lgkmcnt(1)
    v_add_f32 v144, v144, v152
    v_add_f32 v145, v145, v153
    v_add_f32 v146, v146, v154
    v_add_f32 v147, v147, v155
    s_waitcnt lgkmcnt(0)
    v_add_f32 v144, v144, v156
    v_add_f32 v145, v145, v157
    v_add_f32 v146, v146, v158
    v_add_f32 v147, v147, v159
    buffer_store_dwordx4 v[144:147], v142, s[24:27], s32 offen sc1
    s_branch PK_end
PK2:
    s_sub_u32 s32, s2, 144
    s_mul_hi_u32 s30, s32, 0x1999999A
    s_mul_i32 s39, s30, 10
    s_sub_u32 s39, s32, s39
    s_and_b32 s32, s39, 3
    s_mul_i32 s32, s32, 9
    s_lshr_b32 s37, s39, 2
    s_lshl_b32 s37, s37, 1
    s_add_u32 s32, s32, s37
    s_and_b32 s37, s39, 1
    s_add_u32 s32, s32, s37
    s_mul_i32 s37, s37, 18
    s_add_u32 s37, s37, 8
    s_cmp_ge_u32 s39, 8
    s_cselect_b32 s32, s37, s32
    s_mul_i32 s37, s30, 36
    s_add_u32 s32, s32, s37
    s_mov_b32 s16, s58
    s_mov_b32 s17, s59
    s_mov_b32 s18, 5308416
    s_mov_b32 s19, 0x00020000
    s_mul_i32 s35, s32, 36864
    s_mul_i32 s31, s36, 9216
    s_add_u32 s35, s35, s31
    s_add_u32 m0, s31, 0
    s_add_u32 s38, s35, 0
    buffer_load_dwordx4 v3, s[16:19], s38 offen offset:0 nt lds
    buffer_load_dwordx4 v3, s[16:19], s38 offen offset:1024 nt lds
    buffer_load_dwordx4 v3, s[16:19], s38 offen offset:2048 nt lds
    buffer_load_dwordx4 v3, s[16:19], s38 offen offset:3072 nt lds
    s_add_u32 m0, s31, 4096
    s_add_u32 s38, s35, 4096
    buffer_load_dwordx4 v3, s[16:19], s38 offen offset:0 nt lds
    buffer_load_dwordx4 v3, s[16:19], s38 offen offset:1024 nt lds
    buffer_load_dwordx4 v3, s[16:19], s38 offen offset:2048 nt lds
    buffer_load_dwordx4 v3, s[16:19], s38 offen offset:3072 nt lds
    s_add_u32 m0, s31, 8192
    s_add_u32 s38, s35, 8192
    buffer_load_dwordx4 v3, s[16:19], s38 offen offset:0 nt lds
    s_add_u32 m0, s31, 36864
    s_add_u32 s38, s35, 36864
    buffer_load_dwordx4 v3, s[16:19], s38 offen offset:0 nt lds
    buffer_load_dwordx4 v3, s[16:19], s38 offen offset:1024 nt lds
    buffer_load_dwordx4 v3, s[16:19], s38 offen offset:2048 nt lds
    buffer_load_dwordx4 v3, s[16:19], s38 offen offset:3072 nt lds
    s_add_u32 m0, s31, 40960
    s_add_u32 s38, s35, 40960
    buffer_load_dwordx4 v3, s[16:19], s38 offen offset:0 nt lds
    buffer_load_dwordx4 v3, s[16:19], s38 offen offset:1024 nt lds
    buffer_load_dwordx4 v3, s[16:19], s38 offen offset:2048 nt lds
    buffer_load_dwordx4 v3, s[16:19], s38 offen offset:3072 nt lds
    s_add_u32 m0, s31, 45056
    s_add_u32 s38, s35, 45056
    buffer_load_dwordx4 v3, s[16:19], s38 offen offset:0 nt lds
    s_cmp_lg_u32 s36, 3
    s_cbranch_scc1 RP_17
    v_readfirstlane_b32 s6, v58
    v_mov_b32 v59, 112640
    s_cmp_lt_u32 s6, 32
    s_cbranch_scc0 RPs_19
RPok_18:
    s_lshl_b32 s6, s6, 3
    s_add_u32 s6, s6, s4
    v_mov_b32 v58, s6
    ds_write_b32 v59, v58
    s_waitcnt lgkmcnt(0)
RP_17:
    s_lshl_b32 s39, s39, 1
    s_lshl_b32 s33, s30, 2
    s_add_u32 s33, s33, s36
    s_mul_i32 s33, s33, 331776
    s_add_u32 s33, s33, 27262976
    s_cmp_ge_u32 s39, 16
    s_cselect_b32 s66, 4, 0
    s_cselect_b32 s67, 4, 16
    s_mul_i32 s67, s67, 1152
    v_lshrrev_b32 v5, 2, v2
    v_lshrrev_b32 v6, 4, v2
    v_mad_u32_u24 v5, v6, s66, v5
    v_mul_u32_u24 v5, 1152, v5
    v_and_b32 v6, 3, v2
    s_mul_i32 s66, s36, 288
    s_bitcmp1_b32 s36, 0
    s_cselect_b32 s68, 0, 256
    s_cselect_b32 s70, 32, 0
    s_add_u32 s68, s68, s66
    s_add_u32 s70, s70, s66
    v_lshl_add_u32 v12, v6, 3, v5
    v_add_u32 v12, s68, v12
    v_lshl_add_u32 v5, v6, 4, v5
    s_add_u32 s66, s30, 0
    s_and_b32 s66, s66, 3
    s_lshl_b32 s66, s66, 6
    s_add_u32 s66, s66, s70
    v_add_u32 v8, s66, v5
    s_add_u32 s66, s30, 1
    s_and_b32 s66, s66, 3
    s_lshl_b32 s66, s66, 6
    s_add_u32 s66, s66, s70
    v_add_u32 v9, s66, v5
    s_add_u32 s66, s30, 2
    s_and_b32 s66, s66, 3
    s_lshl_b32 s66, s66, 6
    s_add_u32 s66, s66, s70
    v_add_u32 v10, s66, v5
    s_add_u32 s66, s30, 3
    s_and_b32 s66, s66, 3
    s_lshl_b32 s66, s66, 6
    s_add_u32 s66, s66, s70
    v_add_u32 v11, s66, v5
PK_lp:
    s_lshl_b32 s70, s39, 2
    s_min_u32 s75, s39, 4
    s_add_u32 s70, s70, s75
    s_min_u32 s75, s39, 12
    s_lshl1_add_u32 s70, s75, s70
    s_add_u32 s74, s39, 216
    s_add_u32 s75, s70, 6
    s_cmp_lt_u32 s39, 4
    s_cselect_b32 s74, s75, s74
    s_lshl_b32 s73, s39, 1
    s_add_u32 s72, s73, 148
    s_add_u32 s75, s70, 4
    s_cmp_lt_u32 s39, 12
    s_cselect_b32 s72, s75, s72
    s_add_u32 s75, s73, 84
    s_cmp_ge_u32 s39, 28
    s_cselect_b32 s70, s75, s70
    s_cselect_b32 s75, 16, 2
    s_add_u32 s71, s70, s75
    s_add_u32 s73, s73, 252
    s_lshl_b32 s70, s70, 10
    s_add_u32 s70, s70, s33
    s_lshl_b32 s71, s71, 10
    s_add_u32 s71, s71, s33
    s_lshl_b32 s72, s72, 10
    s_add_u32 s72, s72, s33
    s_lshl_b32 s73, s73, 10
    s_add_u32 s73, s73, s33
    s_lshl_b32 s74, s74, 10
    s_add_u32 s74, s74, s33
    s_waitcnt vmcnt(9)
    s_barrier
    v_add_u32 v52, s67, v8
    v_add_u32 v53, s67, v9
    v_add_u32 v54, s67, v10
    v_add_u32 v55, s67, v11
    v_add_u32 v56, s67, v12
    ds_read_b64_tr_b16 v[16:17], v9 offset:0
    ds_read_b64_tr_b16 v[18:19], v53 offset:0
    ds_read_b64_tr_b16 v[20:21], v9 offset:8
    ds_read_b64_tr_b16 v[22:23], v53 offset:8
    ds_read_b64_tr_b16 v[24:25], v10 offset:0
    ds_read_b64_tr_b16 v[26:27], v54 offset:0
    ds_read_b64_tr_b16 v[28:29], v10 offset:8
    ds_read_b64_tr_b16 v[30:31], v54 offset:8
    ds_read_b64_tr_b16 v[32:33], v12 offset:0
    ds_read_b64_tr_b16 v[34:35], v56 offset:0
    ds_read_b64_tr_b16 v[36:37], v11 offset:0
    ds_read_b64_tr_b16 v[38:39], v55 offset:0
    ds_read_b64_tr_b16 v[40:41], v11 offset:8
    ds_read_b64_tr_b16 v[42:43], v55 offset:8
    ds_read_b64_tr_b16 v[44:45], v8 offset:0
    ds_read_b64_tr_b16 v[46:47], v52 offset:0
    ds_read_b64_tr_b16 v[48:49], v8 offset:8
    ds_read_b64_tr_b16 v[50:51], v52 offset:8
    s_waitcnt lgkmcnt(15)
    buffer_store_dwordx4 v[16:19], v3, s[24:27], s70 offen offset:0 sc1
    s_waitcnt lgkmcnt(14)
    buffer_store_dwordx4 v[20:23], v3, s[24:27], s70 offen offset:1024 sc1
    s_waitcnt lgkmcnt(12)
    buffer_store_dwordx4 v[24:27], v3, s[24:27], s71 offen offset:0 sc1
    s_waitcnt lgkmcnt(10)
    buffer_store_dwordx4 v[28:31], v3, s[24:27], s71 offen offset:1024 sc1
    s_waitcnt lgkmcnt(8)
    buffer_store_dwordx4 v[32:35], v3, s[24:27], s74 offen offset:0 sc1
    s_waitcnt lgkmcnt(6)
    buffer_store_dwordx4 v[36:39], v3, s[24:27], s72 offen offset:0 sc1
    s_waitcnt lgkmcnt(4)
    buffer_store_dwordx4 v[40:43], v3, s[24:27], s72 offen offset:1024 sc1
    s_waitcnt lgkmcnt(2)
    buffer_store_dwordx4 v[44:47], v3, s[24:27], s73 offen offset:0 sc1
    s_waitcnt lgkmcnt(0)
    buffer_store_dwordx4 v[48:51], v3, s[24:27], s73 offen offset:1024 sc1
    s_add_u32 s39, s39, 1
    v_add_u32 v8, 36864, v8
    v_add_u32 v9, 36864, v9
    v_add_u32 v10, 36864, v10
    v_add_u32 v11, 36864, v11
    v_add_u32 v12, 36864, v12
    s_bitcmp1_b32 s39, 0
    s_cbranch_scc1 PK_lp
PK_end:
    s_barrier
HELP_done:
    v_mov_b32 v59, 112640
    ds_read_b32 v58, v59
    s_waitcnt lgkmcnt(0)
    v_readfirstlane_b32 s6, v58
    s_and_b32 s28, s6, 7
    s_lshr_b32 s29, s6, 3
    s_lshr_b32 s43, s28, 1
    s_and_b32 s44, s29, 3
    s_and_b32 s45, s28, 1
    s_lshl_b32 s45, s45, 3
    s_lshr_b32 s5, s29, 2
    s_add_u32 s45, s45, s5
    s_and_b32 s46, s29, 1
    s_lshl_b32 s5, s43, 2
    s_add_u32 s5, s5, s44
    s_mul_i32 s5, s5, 288
    s_and_b32 s47, s5, 0xffffffc0
    s_and_b32 s5, s36, 1
    s_mul_i32 s5, s5, 442368
    s_lshl_b32 s6, s46, 6
    s_add_u32 s6, s6, s47
    s_lshl_b32 s41, s6, 1
    s_add_u32 s41, s41, s5
    s_cmp_eq_u32 s46, 0
    s_cselect_b32 s6, 256, 32
    s_add_u32 s6, s6, s47
    s_add_u32 s6, s6, s5
    s_lshl_b32 s42, s6, 1
    s_mul_i32 s40, s36, 6144
    s_add_u32 s40, s40, 16384
    s_cmp_lt_u32 s36, 2
    s_cselect_b32 s8, s54, s56
    s_cselect_b32 s9, s55, s57
    s_mov_b32 s10, 5308416
    s_mov_b32 s11, 0x00020000
    v_bfe_u32 v5, v2, 4, 1
    v_bfe_u32 v6, v2, 1, 1
    v_xor_b32 v6, v6, v5
    v_lshrrev_b32 v5, 2, v2
    v_mul_u32_u24 v5, 9216, v5
    v_lshl_add_u32 v5, v6, 5, v5
    v_and_b32 v6, 1, v2
    v_lshl_add_u32 v252, v6, 4, v5
    v_add_u32 v253, 146432, v252
    v_add_u32 v254, 292864, v252
JOIN:
    s_waitcnt lgkmcnt(0)
    v_lshrrev_b32 v192, 3, v2
    v_mul_u32_u24 v192, 9216, v192
    v_bfe_u32 v193, v2, 1, 2
    v_lshrrev_b32 v194, 4, v2
    v_xor_b32 v193, v193, v194
    v_lshl_add_u32 v192, v193, 5, v192
    v_and_b32 v193, 1, v2
    v_lshl_add_u32 v168, v193, 4, v192
    v_add_u32 v169, 72704, v168
    v_add_u32 v170, 145408, v168
    v_min_u32 v5, 35, v2
    v_mul_u32_u24 v6, 43, v5
    v_lshrrev_b32 v6, 9, v6
    v_mad_u32_u24 v5, v6, 36, v5
    s_and_b32 s73, s7, 15
    s_lshl_b32 s73, s73, 14
    s_mul_i32 s74, s36, 768
    s_add_u32 s74, s74, s73
    v_mul_u32_u24 v5, 64, v5
    v_add_u32 v114, s74, v5
    v_mul_u32_u24 v5, 64, v2
    v_add_u32 v115, s73, v5
    s_mov_b32 s68, 8126464
    buffer_load_dword v116, v114, s[24:27], s68 offen offset:0 sc1
    s_and_b32 s30, s36, 1
    s_lshr_b32 s31, s36, 1
    v_lshrrev_b32 v192, 4, v2
    v_lshrrev_b32 v193, 3, v2
    v_mul_u32_u24 v193, 5120, v193
    v_sub_u32 v104, v168, v193
    v_add_u32 v105, 31744, v104
    v_add_u32 v106, 63488, v104
    s_mul_i32 s48, s36, 196608
    s_add_u32 m0, s40, 98304
    s_add_u32 s5, s41, 0
    buffer_load_dwordx4 v168, s[8:11], s5 offen offset:0  lds
    s_lshl_b32 s73, s45, 7
    s_add_u32 s48, s48, s73
    s_add_u32 s48, s48, 4718592
    v_lshrrev_b32 v193, 2, v2
    v_and_b32 v194, 3, v2
    v_lshlrev_b32 v194, 3, v194
    v_lshl_add_u32 v195, v193, 7, v194
    v_add_u32 v195, 16384, v195
    v_bfe_u32 v5, v2, 3, 2
    buffer_load_dwordx4 v169, s[8:11], s5 offen offset:1024  lds
    s_lshl_b32 s70, s31, 1
    s_add_u32 s71, s70, 1
    s_lshl_b32 s72, s46, 1
    s_add_u32 s72, s72, s31
    s_lshl_b32 s73, s30, 1
    s_add_u32 s73, s73, s31
    s_xor_b32 s74, s73, 0
    v_xor_b32 v6, s74, v5
    v_lshl_add_u32 v88, v6, 5, v195
    buffer_load_dwordx4 v170, s[8:11], s5 offen offset:2048  lds
    v_add_u32 v89, 49152, v88
    v_add_u32 v90, 98304, v88
    s_xor_b32 s74, s73, 1
    v_xor_b32 v6, s74, v5
    v_lshl_add_u32 v91, v6, 5, v195
    v_add_u32 v92, 49152, v91
    v_add_u32 v93, 98304, v91
    v_xor_b32 v6, s70, v5
    v_lshl_add_u32 v171, v6, 5, v195
    s_add_u32 m0, s40, 101376
    s_add_u32 s5, s41, 221184
    buffer_load_dwordx4 v168, s[8:11], s5 offen offset:0  lds
    v_add_u32 v172, 49152, v171
    v_add_u32 v173, 98304, v171
    v_xor_b32 v6, s71, v5
    v_lshl_add_u32 v174, v6, 5, v195
    v_add_u32 v175, 49152, v174
    v_add_u32 v176, 98304, v174
    v_lshl_add_u32 v195, v193, 6, v194
    v_add_u32 v195, 16384, v195
    v_bfe_u32 v5, v2, 4, 1
    buffer_load_dwordx4 v169, s[8:11], s5 offen offset:1024  lds
    v_xor_b32 v6, s31, v5
    v_lshl_add_u32 v177, v6, 5, v195
    v_add_u32 v178, 49152, v177
    v_add_u32 v179, 98304, v177
    s_xor_b32 s74, s73, 0
    s_lshl_b32 s50, s45, 3
    s_add_u32 s50, s50, s74
    s_mul_i32 s50, s50, 147456
    s_xor_b32 s74, s73, 1
    buffer_load_dwordx4 v170, s[8:11], s5 offen offset:2048  lds
    s_lshl_b32 s51, s45, 3
    s_add_u32 s51, s51, s74
    s_mul_i32 s51, s51, 147456
    s_xor_b32 s74, s73, 4
    s_lshl_b32 s52, s45, 3
    s_add_u32 s52, s52, s74
    s_mul_i32 s52, s52, 147456
    s_xor_b32 s74, s73, 5
    s_lshl_b32 s53, s45, 3
    s_add_u32 m0, s40, 122880
    s_add_u32 s5, s41, 884736
    buffer_load_dwordx4 v168, s[8:11], s5 offen offset:0  lds
    s_add_u32 s53, s53, s74
    s_mul_i32 s53, s53, 147456
    s_lshr_b32 s74, s47, 5
    s_add_u32 s74, s74, s72
    s_lshl_b32 s74, s74, 10
    s_add_u32 s74, s74, 8388608
    s_add_u32 s50, s50, s74
    s_add_u32 s51, s51, s74
    s_add_u32 s52, s52, s74
    buffer_load_dwordx4 v169, s[8:11], s5 offen offset:1024  lds
    s_add_u32 s53, s53, s74
    s_cmp_eq_u32 s46, 0
    s_cselect_b32 s62, 8, 1
    s_sub_u32 s62, s62, s72
    s_lshl_b32 s62, s62, 10
    s_mul_i32 s74, s31, 147456
    s_sub_u32 s62, s62, s74
    v_and_b32 v5, 1, v192
    v_xor_b32 v5, s31, v5
    buffer_load_dwordx4 v170, s[8:11], s5 offen offset:2048  lds
    v_mul_u32_u24 v5, 147456, v5
    v_and_b32 v6, 0xf0, v3
    v_and_b32 v7, 32, v2
    v_lshl_add_u32 v6, v7, 3, v6
    s_lshl_b32 s74, s31, 9
    v_add3_u32 v189, v5, v6, s74
    s_lshl_b32 s74, s46, 8
    s_lshl_b32 s75, s31, 7
    s_add_u32 s74, s74, s75
    s_add_u32 m0, s40, 125952
    s_add_u32 s5, s41, 1105920
    buffer_load_dwordx4 v168, s[8:11], s5 offen offset:0  lds
    s_add_u32 s74, s74, 0
    v_lshl_add_u32 v180, v192, 4, s74
    s_cmp_eq_u32 s46, 0
    s_cselect_b32 s74, 1024, 0
    s_lshl_b32 s75, s72, 6
    s_add_u32 s74, s74, s75
    s_add_u32 s74, s74, 0
    v_lshl_add_u32 v181, v192, 4, s74
    v_cmp_le_u32 vcc, 80, v0
    buffer_load_dwordx4 v169, s[8:11], s5 offen offset:1024  lds
    v_lshlrev_b32 v113, 4, v0
    v_mov_b32 v5, 17152
    v_cndmask_b32 v5, 0, v5, vcc
    v_add_u32 v5, v5, v113
    v_cmp_le_u32 vcc, 160, v0
    v_mov_b32 v6, 0x7ffffff0
    v_mov_b32 v7, 4608
    v_cndmask_b32 v112, v5, v6, vcc
    v_add_u32 v113, 0, v113
    buffer_load_dwordx4 v170, s[8:11], s5 offen offset:2048  lds
    v_cndmask_b32 v113, v113, v7, vcc
    v_and_b32 v5, 15, v2
    s_lshl_b32 s74, s73, 7
    s_add_u32 s74, s74, 2560
    v_lshl_add_u32 v6, v5, 3, s74
    s_xor_b32 s74, s74, 128
    v_lshl_add_u32 v255, v5, 3, s74
    v_lshrrev_b32 v7, 2, v5
    v_cmp_eq_u32 vcc, v7, v192
    v_lshlrev_b32 v7, 3, v2
    v_add_u32 v7, 3584, v7
    v_cndmask_b32 v111, v7, v6, vcc
    v_and_b32 v7, 1, v2
    v_cmp_ne_u32 s[32:33], 0, v7
    v_and_b32 v7, 2, v2
    v_cmp_ne_u32 s[34:35], 0, v7
    v_mov_b32 v244, 0x3f803f80
    v_mov_b32 v245, 0x3f803f80
    v_mov_b32 v246, 0x3f803f80
    v_mov_b32 v247, 0x3f803f80
    v_add_u32 v186, 16384, v3
    v_add_u32 v187, 65536, v3
    v_add_u32 v188, 114688, v3
    s_lshl_b32 s74, s43, 2
    s_add_u32 s74, s74, s44
    s_mul_i32 s49, s74, 331776
    s_mul_i32 s75, s36, 6144
    s_add_u32 s49, s49, s75
    s_add_u32 s49, s49, 27262976
    s_lshl_b32 s74, s45, 3
    s_lshl_b32 s75, s36, 1
    s_add_u32 s74, s74, s75
    s_mul_i32 s74, s74, 144
    s_mul_i32 s75, s43, 36
    s_add_u32 s74, s74, s75
    s_lshl_b32 s74, s74, 10
    s_add_u32 s63, s74, 8388608
    s_lshl_b32 s74, s45, 2
    s_add_u32 s74, s74, s43
    s_lshl_b32 s74, s74, 10
    s_add_u32 s65, s74, 51380224
    s_lshl_b32 s74, s44, 8
    s_add_u32 s66, s65, s74
    v_lshlrev_b32 v190, 5, v194
    v_and_b32 v5, 4, v2
    v_lshl_add_u32 v5, v5, 3, v190
    s_lshl_b32 s74, s31, 4
    v_add_u32 v191, s74, v5
    s_waitcnt vmcnt(12)
    s_barrier
    s_cmp_lg_u32 s36, 0
    s_cbranch_scc1 F_j1
    s_mul_i32 s74, s7, 64
    s_add_u32 s74, s74, 7864320
    s_mov_b64 exec, 65535
    v_mov_b32 v196, s3
    v_mul_u32_u24 v197, 16384, v2
    buffer_store_dword v196, v197, s[24:27], s74 offen sc1
    s_mov_b64 exec, -1
F_j1:
    v_cmp_ne_u32 vcc, s3, v116
    s_cbranch_vccnz SLOW_21
BACK_22:
    s_mov_b32 s68, 7864320
    s_add_u32 m0, s40, 0
    s_add_u32 s75, s48, 0
    buffer_load_dwordx4 v104, s[24:27], s75 offen offset:0 sc1 lds
    buffer_load_dwordx4 v105, s[24:27], s75 offen offset:1024 sc1 lds
    buffer_load_dwordx4 v106, s[24:27], s75 offen offset:2048 sc1 lds
    s_add_u32 m0, s40, 3072
    s_add_u32 s75, s48, 98304
    buffer_load_dwordx4 v104, s[24:27], s75 offen offset:0 sc1 lds
    buffer_load_dwordx4 v105, s[24:27], s75 offen offset:1024 sc1 lds
    buffer_load_dwordx4 v106, s[24:27], s75 offen offset:2048 sc1 lds
    s_add_u32 m0, s40, 24576
    s_add_u32 s75, s48, 786432
    buffer_load_dwordx4 v104, s[24:27], s75 offen offset:0 sc1 lds
    buffer_load_dwordx4 v105, s[24:27], s75 offen offset:1024 sc1 lds
    buffer_load_dwordx4 v106, s[24:27], s75 offen offset:2048 sc1 lds
    s_add_u32 m0, s40, 27648
    s_add_u32 s75, s48, 884736
    buffer_load_dwordx4 v104, s[24:27], s75 offen offset:0 sc1 lds
    buffer_load_dwordx4 v105, s[24:27], s75 offen offset:1024 sc1 lds
    buffer_load_dwordx4 v106, s[24:27], s75 offen offset:2048 sc1 lds
    s_add_u32 m0, s40, 73728
    s_add_u32 s75, s41, 1769472
    buffer_load_dwordx4 v168, s[8:11], s75 offen offset:0  lds
    buffer_load_dwordx4 v169, s[8:11], s75 offen offset:1024  lds
    buffer_load_dwordx4 v170, s[8:11], s75 offen offset:2048  lds
    s_add_u32 m0, s40, 76800
    s_add_u32 s75, s41, 1990656
    buffer_load_dwordx4 v168, s[8:11], s75 offen offset:0  lds
    buffer_load_dwordx4 v169, s[8:11], s75 offen offset:1024  lds
    buffer_load_dwordx4 v170, s[8:11], s75 offen offset:2048  lds
    s_add_u32 m0, s40, 49152
    s_add_u32 s75, s48, 1572864
    buffer_load_dwordx4 v104, s[24:27], s75 offen offset:0 sc1 lds
    buffer_load_dwordx4 v105, s[24:27], s75 offen offset:1024 sc1 lds
    buffer_load_dwordx4 v106, s[24:27], s75 offen offset:2048 sc1 lds
    s_add_u32 m0, s40, 52224
    s_add_u32 s75, s48, 1671168
    buffer_load_dwordx4 v104, s[24:27], s75 offen offset:0 sc1 lds
    buffer_load_dwordx4 v105, s[24:27], s75 offen offset:1024 sc1 lds
    buffer_load_dwordx4 v106, s[24:27], s75 offen offset:2048 sc1 lds
    s_add_u32 s18, s45, 20
    s_lshl_b32 s12, s18, 2
    s_min_u32 s17, s18, 4
    s_add_u32 s12, s12, s17
    s_min_u32 s17, s18, 12
    s_lshl1_add_u32 s12, s17, s12
    s_add_u32 s16, s18, 216
    s_add_u32 s17, s12, 6
    s_cmp_lt_u32 s18, 4
    s_cselect_b32 s16, s17, s16
    s_lshl_b32 s15, s18, 1
    s_add_u32 s14, s15, 148
    s_add_u32 s17, s12, 4
    s_cmp_lt_u32 s18, 12
    s_cselect_b32 s14, s17, s14
    s_add_u32 s17, s15, 84
    s_cmp_ge_u32 s18, 28
    s_cselect_b32 s12, s17, s12
    s_cselect_b32 s17, 16, 2
    s_add_u32 s13, s12, s17
    s_add_u32 s15, s15, 252
    s_cmp_eq_u32 s36, 1
    s_cselect_b32 s15, s12, s15
    s_cmp_eq_u32 s36, 2
    s_cselect_b32 s15, s13, s15
    s_cmp_eq_u32 s36, 3
    s_cselect_b32 s15, s14, s15
    s_cselect_b32 s94, 0, 0x40000000
    s_mul_i32 s12, s36, 6144
    s_sub_u32 s12, s49, s12
    s_lshl_b32 s15, s15, 10
    s_lshl_b32 s16, s16, 10
    s_add_u32 s15, s15, s12
    s_add_u32 s16, s16, s12
    s_bfe_u32 s12, s45, 0x20001
    s_mul_i32 s13, s12, 9
    s_and_b32 s12, s12, 1
    s_add_u32 s13, s13, s12
    s_and_b32 s12, s45, 1
    s_add_u32 s13, s13, s12
    s_lshr_b32 s12, s45, 3
    s_lshl_b32 s12, s12, 1
    s_add_u32 s13, s13, s12
    s_mul_i32 s12, s43, 36
    s_add_u32 s13, s13, s12
    s_mul_i32 s13, s13, 36864
    s_mul_i32 s12, s44, 288
    s_add_u32 s13, s13, s12
    s_add_u32 s12, s43, s36
    s_and_b32 s12, s12, 3
    s_lshl_b32 s12, s12, 6
    s_add_u32 s12, s12, s13
    s_lshl_b32 s14, s46, 5
    s_add_u32 s12, s12, s14
    s_lshl_b32 s14, s46, 8
    s_xor_b32 s14, s14, 256
    s_add_u32 s13, s13, s14
    s_add_u32 s14, s12, 17408
    s_lshl_b32 s17, s36, 11
    s_add_u32 s17, s17, 5120
    s_mov_b32 s20, s58
    s_mov_b32 s21, s59
    s_mov_b32 s22, 5308416
    s_mov_b32 s23, 0x00020000
    s_lshl_b32 s18, s43, 2
    s_add_u32 s18, s18, s44
    s_lshl_b32 s18, s18, 12
    s_add_u32 s18, s18, 51511296
    s_lshl_b32 s19, s45, 2
    s_add_u32 s19, s19, s36
    s_lshl_b32 s19, s19, 6
    s_add_u32 s19, s19, s18
    s_waitcnt vmcnt(18)
    s_barrier
    ds_read_b64_tr_b16 a[0:1], v88 offset:0
    ds_read_b64_tr_b16 a[2:3], v88 offset:2048
    ds_read_b64_tr_b16 a[4:5], v91 offset:0
    ds_read_b64_tr_b16 a[6:7], v91 offset:2048
    ds_read_b64_tr_b16 a[16:17], v88 offset:4096
    ds_read_b64_tr_b16 a[18:19], v88 offset:6144
    ds_read_b64_tr_b16 a[20:21], v91 offset:4096
    ds_read_b64_tr_b16 a[22:23], v91 offset:6144
    ds_read_b64_tr_b16 v[196:197], v173 offset:0
    ds_read_b64_tr_b16 v[198:199], v173 offset:2048
    ds_read_b64_tr_b16 v[200:201], v176 offset:0
    ds_read_b64_tr_b16 v[202:203], v176 offset:2048
    ds_read_b64_tr_b16 v[204:205], v173 offset:12288
    ds_read_b64_tr_b16 v[206:207], v173 offset:14336
    ds_read_b64_tr_b16 v[208:209], v176 offset:12288
    ds_read_b64_tr_b16 v[210:211], v176 offset:14336
    ds_read_b64_tr_b16 v[212:213], v173 offset:4096
    ds_read_b64_tr_b16 v[214:215], v173 offset:6144
    ds_read_b64_tr_b16 v[216:217], v176 offset:4096
    ds_read_b64_tr_b16 v[218:219], v176 offset:6144
    s_waitcnt lgkmcnt(8)
    v_mfma_f32_16x16x32_bf16 v[8:11], v[196:199], a[0:3], 0
    ds_read_b64_tr_b16 a[32:33], v88 offset:8192
    ds_read_b64_tr_b16 v[220:221], v173 offset:16384
    v_mfma_f32_16x16x32_bf16 v[12:15], v[196:199], a[4:7], 0
    ds_read_b64_tr_b16 v[222:223], v173 offset:18432
    v_mfma_f32_16x16x32_bf16 v[16:19], v[200:203], a[0:3], 0
    ds_read_b64_tr_b16 v[224:225], v176 offset:16384
    ds_read_b64_tr_b16 a[34:35], v88 offset:10240
    v_mfma_f32_16x16x32_bf16 v[20:23], v[200:203], a[4:7], 0
    ds_read_b64_tr_b16 v[226:227], v176 offset:18432
    v_mfma_f32_16x16x32_bf16 v[228:231], v[244:247], a[0:3], 0
    s_waitcnt lgkmcnt(10)
    v_mfma_f32_16x16x32_bf16 v[24:27], v[204:207], a[0:3], 0
    ds_read_b64_tr_b16 v[196:197], v173 offset:8192
    ds_read_b64_tr_b16 a[36:37], v91 offset:8192
    v_mfma_f32_16x16x32_bf16 v[28:31], v[204:207], a[4:7], 0
    ds_read_b64_tr_b16 v[198:199], v173 offset:10240
    v_mfma_f32_16x16x32_bf16 v[32:35], v[208:211], a[0:3], 0
    ds_read_b64_tr_b16 v[200:201], v176 offset:8192
    v_mfma_f32_16x16x32_bf16 v[36:39], v[208:211], a[4:7], 0
    ds_read_b64_tr_b16 a[38:39], v91 offset:10240
    ds_read_b64_tr_b16 v[202:203], v176 offset:10240
    v_mfma_f32_16x16x32_bf16 v[236:239], a[0:3], a[0:3], 0
    s_waitcnt lgkmcnt(12)
    v_mfma_f32_16x16x32_bf16 v[8:11], v[212:215], a[16:19], v[8:11]
    ds_read_b64_tr_b16 v[204:205], v173 offset:20480
    buffer_load_dword v116, v114, s[24:27], s68 offen offset:0 sc1
    ds_read_b64_tr_b16 a[48:49], v88 offset:12288
    v_mfma_f32_16x16x32_bf16 v[12:15], v[212:215], a[20:23], v[12:15]
    ds_read_b64_tr_b16 v[206:207], v173 offset:22528
    v_mfma_f32_16x16x32_bf16 v[16:19], v[216:219], a[16:19], v[16:19]
    s_barrier
    ds_read_b64_tr_b16 v[208:209], v176 offset:20480
    v_mfma_f32_16x16x32_bf16 v[20:23], v[216:219], a[20:23], v[20:23]
    ds_read_b64_tr_b16 v[210:211], v176 offset:22528
    ds_read_b64_tr_b16 a[50:51], v88 offset:14336
    v_mfma_f32_16x16x32_bf16 v[228:231], v[244:247], a[16:19], v[228:231]
    s_waitcnt lgkmcnt(12)
    v_mfma_f32_16x16x32_bf16 v[24:27], v[220:223], a[16:19], v[24:27]
    ds_read_b64_tr_b16 v[212:213], v173 offset:24576
    v_mfma_f32_16x16x32_bf16 v[28:31], v[220:223], a[20:23], v[28:31]
    ds_read_b64_tr_b16 a[52:53], v91 offset:12288
    ds_read_b64_tr_b16 v[214:215], v173 offset:26624
    v_mfma_f32_16x16x32_bf16 v[32:35], v[224:227], a[16:19], v[32:35]
    ds_read_b64_tr_b16 v[216:217], v176 offset:24576
    v_mfma_f32_16x16x32_bf16 v[36:39], v[224:227], a[20:23], v[36:39]
    ds_read_b64_tr_b16 v[218:219], v176 offset:26624
    ds_read_b64_tr_b16 a[54:55], v91 offset:14336
    v_mfma_f32_16x16x32_bf16 v[236:239], a[16:19], a[16:19], v[236:239]
    s_waitcnt lgkmcnt(12)
    v_mfma_f32_16x16x32_bf16 v[8:11], v[196:199], a[32:35], v[8:11]
    ds_read_b64_tr_b16 v[220:221], v173 offset:36864
    v_mfma_f32_16x16x32_bf16 v[12:15], v[196:199], a[36:39], v[12:15]
    ds_read_b64_tr_b16 v[222:223], v173 offset:38912
    ds_read_b64_tr_b16 a[64:65], v88 offset:16384
    v_mfma_f32_16x16x32_bf16 v[16:19], v[200:203], a[32:35], v[16:19]
    ds_read_b64_tr_b16 v[224:225], v176 offset:36864
    v_mfma_f32_16x16x32_bf16 v[20:23], v[200:203], a[36:39], v[20:23]
    ds_read_b64_tr_b16 v[226:227], v176 offset:38912
    v_mfma_f32_16x16x32_bf16 v[228:231], v[244:247], a[32:35], v[228:231]
    ds_read_b64_tr_b16 a[66:67], v88 offset:18432
    s_waitcnt lgkmcnt(13)
    v_mfma_f32_16x16x32_bf16 v[24:27], v[204:207], a[32:35], v[24:27]
    ds_read_b64_tr_b16 v[196:197], v173 offset:28672
    v_mfma_f32_16x16x32_bf16 v[28:31], v[204:207], a[36:39], v[28:31]
    ds_read_b64_tr_b16 v[198:199], v173 offset:30720
    ds_read_b64_tr_b16 a[68:69], v91 offset:16384
    v_mfma_f32_16x16x32_bf16 v[32:35], v[208:211], a[32:35], v[32:35]
    ds_read_b64_tr_b16 v[200:201], v176 offset:28672
    v_mfma_f32_16x16x32_bf16 v[36:39], v[208:211], a[36:39], v[36:39]
    ds_read_b64_tr_b16 v[202:203], v176 offset:30720
    v_mfma_f32_16x16x32_bf16 v[236:239], a[32:35], a[32:35], v[236:239]
    ds_read_b64_tr_b16 a[70:71], v91 offset:18432
    s_waitcnt lgkmcnt(12)
    v_mfma_f32_16x16x32_bf16 v[8:11], v[212:215], a[48:51], v[8:11]
    ds_read_b64_tr_b16 v[204:205], v173 offset:40960
    v_mfma_f32_16x16x32_bf16 v[12:15], v[212:215], a[52:55], v[12:15]
    ds_read_b64_tr_b16 v[206:207], v173 offset:43008
    v_mfma_f32_16x16x32_bf16 v[16:19], v[216:219], a[48:51], v[16:19]
    ds_read_b64_tr_b16 a[80:81], v88 offset:20480
    ds_read_b64_tr_b16 v[208:209], v176 offset:40960
    v_mfma_f32_16x16x32_bf16 v[20:23], v[216:219], a[52:55], v[20:23]
    ds_read_b64_tr_b16 v[210:211], v176 offset:43008
    v_mfma_f32_16x16x32_bf16 v[228:231], v[244:247], a[48:51], v[228:231]
    ds_read_b64_tr_b16 a[82:83], v88 offset:22528
    s_waitcnt lgkmcnt(13)
    v_mfma_f32_16x16x32_bf16 v[24:27], v[220:223], a[48:51], v[24:27]
    ds_read_b64_tr_b16 v[212:213], v173 offset:32768
    v_mfma_f32_16x16x32_bf16 v[28:31], v[220:223], a[52:55], v[28:31]
    ds_read_b64_tr_b16 v[214:215], v173 offset:34816
    v_mfma_f32_16x16x32_bf16 v[32:35], v[224:227], a[48:51], v[32:35]
    ds_read_b64_tr_b16 v[216:217], v176 offset:32768
    ds_read_b64_tr_b16 a[84:85], v91 offset:20480
    v_mfma_f32_16x16x32_bf16 v[36:39], v[224:227], a[52:55], v[36:39]
    ds_read_b64_tr_b16 v[218:219], v176 offset:34816
    v_mfma_f32_16x16x32_bf16 v[236:239], a[48:51], a[48:51], v[236:239]
    s_waitcnt lgkmcnt(11)
    v_mfma_f32_16x16x32_bf16 v[8:11], v[196:199], a[64:67], v[8:11]
    ds_read_b64_tr_b16 a[86:87], v91 offset:22528
    ds_read_b64_tr_b16 v[220:221], v173 offset:45056
    v_mfma_f32_16x16x32_bf16 v[12:15], v[196:199], a[68:71], v[12:15]
    ds_read_b64_tr_b16 v[222:223], v173 offset:47104
    v_mfma_f32_16x16x32_bf16 v[16:19], v[200:203], a[64:67], v[16:19]
    s_waitcnt vmcnt(1) lgkmcnt(2)
    s_barrier
    ds_read_b64_tr_b16 v[224:225], v176 offset:45056
    ds_read_b64_tr_b16 a[96:97], v88 offset:24576
    v_mfma_f32_16x16x32_bf16 v[20:23], v[200:203], a[68:71], v[20:23]
    ds_read_b64_tr_b16 v[226:227], v176 offset:47104
    v_mfma_f32_16x16x32_bf16 v[228:231], v[244:247], a[64:67], v[228:231]
    ds_read_b64_tr_b16 a[98:99], v88 offset:26624
    v_mfma_f32_16x16x32_bf16 v[24:27], v[204:207], a[64:67], v[24:27]
    ds_read_b64_tr_b16 v[196:197], v172 offset:24576
    s_waitcnt vmcnt(0)
    v_cmp_ne_u32 vcc, s3, v116
    s_cbranch_vccnz SLOW_25
BACK_26:
    s_add_u32 m0, s40, 0
    s_add_u32 s75, s48, 2048
    buffer_load_dwordx4 v104, s[24:27], s75 offen offset:0 sc1 lds
    v_mfma_f32_16x16x32_bf16 v[28:31], v[204:207], a[68:71], v[28:31]
    ds_read_b64_tr_b16 a[100:101], v91 offset:24576
    ds_read_b64_tr_b16 v[198:199], v172 offset:26624
    v_mfma_f32_16x16x32_bf16 v[32:35], v[208:211], a[64:67], v[32:35]
    ds_read_b64_tr_b16 v[200:201], v175 offset:24576
    buffer_load_dwordx4 v105, s[24:27], s75 offen offset:1024 sc1 lds
    ds_read_b64_tr_b16 a[102:103], v91 offset:26624
    v_mfma_f32_16x16x32_bf16 v[36:39], v[208:211], a[68:71], v[36:39]
    ds_read_b64_tr_b16 v[202:203], v175 offset:26624
    v_mfma_f32_16x16x32_bf16 v[236:239], a[64:67], a[64:67], v[236:239]
    buffer_load_dwordx4 v106, s[24:27], s75 offen offset:2048 sc1 lds
    ds_read_b64_tr_b16 a[112:113], v88 offset:28672
    v_mfma_f32_16x16x32_bf16 v[8:11], v[212:215], a[80:83], v[8:11]
    ds_read_b64_tr_b16 v[204:205], v172 offset:36864
    v_mfma_f32_16x16x32_bf16 v[12:15], v[212:215], a[84:87], v[12:15]
    ds_read_b64_tr_b16 v[206:207], v172 offset:38912
    s_add_u32 m0, s40, 3072
    s_add_u32 s75, s48, 100352
    buffer_load_dwordx4 v104, s[24:27], s75 offen offset:0 sc1 lds
    ds_read_b64_tr_b16 a[114:115], v88 offset:30720
    v_mfma_f32_16x16x32_bf16 v[16:19], v[216:219], a[80:83], v[16:19]
    ds_read_b64_tr_b16 v[208:209], v175 offset:36864
    v_mfma_f32_16x16x32_bf16 v[20:23], v[216:219], a[84:87], v[20:23]
    ds_read_b64_tr_b16 v[210:211], v175 offset:38912
    ds_read_b64_tr_b16 a[116:117], v91 offset:28672
    buffer_load_dwordx4 v105, s[24:27], s75 offen offset:1024 sc1 lds
    v_mfma_f32_16x16x32_bf16 v[228:231], v[244:247], a[80:83], v[228:231]
    s_waitcnt lgkmcnt(14)
    v_mfma_f32_16x16x32_bf16 v[24:27], v[220:223], a[80:83], v[24:27]
    ds_read_b64_tr_b16 a[118:119], v91 offset:30720
    ds_read_b64_tr_b16 v[212:213], v172 offset:28672
    buffer_load_dwordx4 v106, s[24:27], s75 offen offset:2048 sc1 lds
    v_mfma_f32_16x16x32_bf16 v[28:31], v[220:223], a[84:87], v[28:31]
    ds_read_b64_tr_b16 v[214:215], v172 offset:30720
    v_lshrrev_b32 v94, 2, v2
    ds_read_b64_tr_b16 a[128:129], v88 offset:32768
    v_mfma_f32_16x16x32_bf16 v[32:35], v[224:227], a[80:83], v[32:35]
    ds_read_b64_tr_b16 v[216:217], v175 offset:28672
    v_mfma_f32_16x16x32_bf16 v[36:39], v[224:227], a[84:87], v[36:39]
    ds_read_b64_tr_b16 v[218:219], v175 offset:30720
    v_mul_u32_u24 v94, 1088, v94
    ds_read_b64_tr_b16 a[130:131], v88 offset:34816
    v_mfma_f32_16x16x32_bf16 v[236:239], a[80:83], a[80:83], v[236:239]
    s_waitcnt lgkmcnt(14)
    v_mfma_f32_16x16x32_bf16 v[8:11], v[196:199], a[96:99], v[8:11]
    ds_read_b64_tr_b16 v[220:221], v172 offset:40960
    ds_read_b64_tr_b16 a[132:133], v91 offset:32768
    v_add_u32 v94, v94, v3
    v_mfma_f32_16x16x32_bf16 v[12:15], v[196:199], a[100:103], v[12:15]
    ds_read_b64_tr_b16 v[222:223], v172 offset:43008
    v_mfma_f32_16x16x32_bf16 v[16:19], v[200:203], a[96:99], v[16:19]
    ds_read_b64_tr_b16 v[224:225], v175 offset:40960
    ds_read_b64_tr_b16 a[134:135], v91 offset:34816
    v_lshrrev_b32 v95, 1, v2
    v_mfma_f32_16x16x32_bf16 v[20:23], v[200:203], a[100:103], v[20:23]
    ds_read_b64_tr_b16 v[226:227], v175 offset:43008
    v_mfma_f32_16x16x32_bf16 v[228:231], v[244:247], a[96:99], v[228:231]
    ds_read_b64_tr_b16 a[192:193], v89 offset:0
    ds_read_b64_tr_b16 a[144:145], v88 offset:36864
    v_mul_u32_u24 v95, 1120, v95
    s_waitcnt lgkmcnt(15)
    v_mfma_f32_16x16x32_bf16 v[24:27], v[204:207], a[96:99], v[24:27]
    ds_read_b64_tr_b16 v[196:197], v172 offset:32768
    ds_read_b64_tr_b16 a[194:195], v89 offset:2048
    ds_read_b64_tr_b16 a[146:147], v88 offset:38912
    v_mfma_f32_16x16x32_bf16 v[28:31], v[204:207], a[100:103], v[28:31]
    ds_read_b64_tr_b16 v[198:199], v172 offset:34816
    v_add_u32 v95, v95, v3
    v_mfma_f32_16x16x32_bf16 v[32:35], v[208:211], a[96:99], v[32:35]
    ds_read_b64_tr_b16 a[196:197], v92 offset:0
    ds_read_b64_tr_b16 v[200:201], v175 offset:32768
    ds_read_b64_tr_b16 a[148:149], v91 offset:36864
    v_mfma_f32_16x16x32_bf16 v[36:39], v[208:211], a[100:103], v[36:39]
    ds_read_b64_tr_b16 v[202:203], v175 offset:34816
    ds_read_b64_tr_b16 a[198:199], v92 offset:2048
    v_mfma_f32_16x16x32_bf16 v[236:239], a[96:99], a[96:99], v[236:239]
    ds_read_b64_tr_b16 a[150:151], v91 offset:38912
    s_waitcnt lgkmcnt(15)
    v_mfma_f32_16x16x32_bf16 v[8:11], v[212:215], a[112:115], v[8:11]
    ds_read_b64_tr_b16 a[208:209], v89 offset:4096
    ds_read_b64_tr_b16 v[204:205], v172 offset:45056
    s_mov_b32 m0, s17
    s_add_u32 s12, s12, 147456
    buffer_load_dwordx4 v94, s[20:23], s12 offen offset:0 nt lds
    v_mfma_f32_16x16x32_bf16 v[12:15], v[212:215], a[116:119], v[12:15]
    ds_read_b64_tr_b16 v[206:207], v172 offset:47104
    ds_read_b64_tr_b16 a[160:161], v88 offset:40960
    ds_read_b64_tr_b16 a[210:211], v89 offset:6144
    v_mfma_f32_16x16x32_bf16 v[16:19], v[216:219], a[112:115], v[16:19]
    ds_read_b64_tr_b16 v[208:209], v175 offset:45056
    s_add_u32 s14, s14, 147456
    buffer_load_dwordx4 v94, s[20:23], s14 offen offset:1024 nt lds
    v_mfma_f32_16x16x32_bf16 v[20:23], v[216:219], a[116:119], v[20:23]
    ds_read_b64_tr_b16 a[212:213], v92 offset:4096
    ds_read_b64_tr_b16 a[162:163], v88 offset:43008
    ds_read_b64_tr_b16 v[210:211], v175 offset:47104
    v_mfma_f32_16x16x32_bf16 v[228:231], v[244:247], a[112:115], v[228:231]
    s_mov_b32 m0, 13312
    s_add_u32 s13, s13, 147456
    buffer_load_dwordx4 v95, s[20:23], s13 offen offset:0 nt lds
    ds_read_b64_tr_b16 a[214:215], v92 offset:6144
    ds_read_b64_tr_b16 a[164:165], v91 offset:40960
    s_waitcnt lgkmcnt(15)
    v_mfma_f32_16x16x32_bf16 v[24:27], v[220:223], a[112:115], v[24:27]
    ds_read_b64_tr_b16 v[212:213], v173 offset:0
    v_mfma_f32_16x16x32_bf16 v[28:31], v[220:223], a[116:119], v[28:31]
    ds_read_b64_tr_b16 a[224:225], v89 offset:8192
    ds_read_b64_tr_b16 v[214:215], v173 offset:2048
    ds_read_b64_tr_b16 a[166:167], v91 offset:43008
    v_mfma_f32_16x16x32_bf16 v[32:35], v[224:227], a[112:115], v[32:35]
    ds_read_b64_tr_b16 v[216:217], v176 offset:0
    ds_read_b64_tr_b16 a[226:227], v89 offset:10240
    v_mfma_f32_16x16x32_bf16 v[36:39], v[224:227], a[116:119], v[36:39]
    ds_read_b64_tr_b16 v[218:219], v176 offset:2048
    ds_read_b64_tr_b16 a[176:177], v88 offset:45056
    v_mfma_f32_16x16x32_bf16 v[236:239], a[112:115], a[112:115], v[236:239]
    ds_read_b64_tr_b16 a[228:229], v92 offset:8192
    s_waitcnt lgkmcnt(15)
    v_mfma_f32_16x16x32_bf16 v[8:11], v[196:199], a[128:131], v[8:11]
    ds_read_b64_tr_b16 v[220:221], v173 offset:12288
    ds_read_b64_tr_b16 a[178:179], v88 offset:47104
    ds_read_b64_tr_b16 a[230:231], v92 offset:10240
    v_mfma_f32_16x16x32_bf16 v[12:15], v[196:199], a[132:135], v[12:15]
    ds_read_b64_tr_b16 v[222:223], v173 offset:14336
    v_mfma_f32_16x16x32_bf16 v[16:19], v[200:203], a[128:131], v[16:19]
    ds_read_b64_tr_b16 a[180:181], v91 offset:45056
    ds_read_b64_tr_b16 v[224:225], v176 offset:12288
    ds_read_b64_tr_b16 a[240:241], v89 offset:12288
    v_mfma_f32_16x16x32_bf16 v[20:23], v[200:203], a[132:135], v[20:23]
    ds_read_b64_tr_b16 v[226:227], v176 offset:14336
    ds_read_b64_tr_b16 a[242:243], v89 offset:14336
    v_mfma_f32_16x16x32_bf16 v[228:231], v[244:247], a[128:131], v[228:231]
    ds_read_b64_tr_b16 a[182:183], v91 offset:47104
    s_waitcnt lgkmcnt(15)
    v_mfma_f32_16x16x32_bf16 v[24:27], v[204:207], a[128:131], v[24:27]
    ds_read_b64_tr_b16 v[196:197], v173 offset:4096
    ds_read_b64_tr_b16 a[244:245], v92 offset:12288
    v_mfma_f32_16x16x32_bf16 v[28:31], v[204:207], a[132:135], v[28:31]
    ds_read_b64_tr_b16 v[198:199], v173 offset:6144
    ds_read_b64_tr_b16 a[246:247], v92 offset:14336
    v_mfma_f32_16x16x32_bf16 v[32:35], v[208:211], a[128:131], v[32:35]
    ds_read_b64_tr_b16 v[200:201], v176 offset:4096
    v_mfma_f32_16x16x32_bf16 v[36:39], v[208:211], a[132:135], v[36:39]
    ds_read_b64_tr_b16 v[202:203], v176 offset:6144
    ds_read_b64_tr_b16 v[136:137], v89 offset:16384
    v_mfma_f32_16x16x32_bf16 v[236:239], a[128:131], a[128:131], v[236:239]
    ds_read_b64_tr_b16 v[138:139], v89 offset:18432
    v_mfma_f32_16x16x32_bf16 v[228:231], v[244:247], a[144:147], v[228:231]
    v_mfma_f32_16x16x32_bf16 v[236:239], a[144:147], a[144:147], v[236:239]
    ds_read_b64_tr_b16 v[140:141], v92 offset:16384
    v_mfma_f32_16x16x32_bf16 v[228:231], v[244:247], a[160:163], v[228:231]
    ds_read_b64_tr_b16 v[142:143], v92 offset:18432
    v_mfma_f32_16x16x32_bf16 v[236:239], a[160:163], a[160:163], v[236:239]
    s_waitcnt lgkmcnt(15)
    v_mfma_f32_16x16x32_bf16 v[228:231], v[244:247], a[176:179], v[228:231]
    ds_read_b64_tr_b16 v[152:153], v89 offset:20480
    v_mfma_f32_16x16x32_bf16 v[236:239], a[176:179], a[176:179], v[236:239]
    ds_read_b64_tr_b16 v[154:155], v89 offset:22528
    v_mfma_f32_16x16x32_bf16 v[228:231], v[244:247], a[192:195], v[228:231]
    v_mfma_f32_16x16x32_bf16 v[236:239], a[192:195], a[192:195], v[236:239]
    ds_read_b64_tr_b16 v[156:157], v92 offset:20480
    v_mfma_f32_16x16x32_bf16 v[228:231], v[244:247], a[208:211], v[228:231]
    v_mfma_f32_16x16x32_bf16 v[236:239], a[208:211], a[208:211], v[236:239]
    ds_read_b64_tr_b16 v[158:159], v92 offset:22528
    v_mfma_f32_16x16x32_bf16 v[228:231], v[244:247], a[224:227], v[228:231]
    s_waitcnt vmcnt(3) lgkmcnt(0)
    s_barrier
    ds_read_b64_tr_b16 a[8:9], v88 offset:0
    v_mfma_f32_16x16x32_bf16 v[236:239], a[224:227], a[224:227], v[236:239]
    ds_read_b64_tr_b16 a[10:11], v88 offset:2048
    s_add_u32 m0, s40, 24576
    s_add_u32 s75, s48, 788480
    buffer_load_dwordx4 v104, s[24:27], s75 offen offset:0 sc1 lds
    ds_read_b64_tr_b16 a[12:13], v91 offset:0
    v_mfma_f32_16x16x32_bf16 v[228:231], v[244:247], a[240:243], v[228:231]
    ds_read_b64_tr_b16 a[14:15], v91 offset:2048
    v_mfma_f32_16x16x32_bf16 v[236:239], a[240:243], a[240:243], v[236:239]
    v_mfma_f32_16x16x32_bf16 v[228:231], v[244:247], v[136:139], v[228:231]
    ds_read_b64_tr_b16 a[24:25], v88 offset:4096
    v_mfma_f32_16x16x32_bf16 v[236:239], v[136:139], v[136:139], v[236:239]
    buffer_load_dwordx4 v105, s[24:27], s75 offen offset:1024 sc1 lds
    v_mfma_f32_16x16x32_bf16 v[228:231], v[244:247], v[152:155], v[228:231]
    ds_read_b64_tr_b16 a[26:27], v88 offset:6144
    v_mfma_f32_16x16x32_bf16 v[236:239], v[152:155], v[152:155], v[236:239]
    s_waitcnt lgkmcnt(2)
    v_mfma_f32_16x16x32_bf16 v[40:43], v[212:215], a[8:11], 0
    ds_read_b64_tr_b16 v[204:205], v173 offset:16384
    buffer_load_dwordx4 v106, s[24:27], s75 offen offset:2048 sc1 lds
    ds_read_b64_tr_b16 a[28:29], v91 offset:4096
    v_mfma_f32_16x16x32_bf16 v[44:47], v[212:215], a[12:15], 0
    ds_read_b64_tr_b16 v[206:207], v173 offset:18432
    v_mfma_f32_16x16x32_bf16 v[48:51], v[216:219], a[8:11], 0
    ds_read_b64_tr_b16 v[208:209], v176 offset:16384
    v_mfma_f32_16x16x32_bf16 v[52:55], v[216:219], a[12:15], 0
    ds_read_b64_tr_b16 v[210:211], v176 offset:18432
    ds_read_b64_tr_b16 a[30:31], v91 offset:6144
    v_mfma_f32_16x16x32_bf16 v[232:235], v[244:247], a[8:11], 0
    s_add_u32 m0, s40, 27648
    s_add_u32 s75, s48, 886784
    buffer_load_dwordx4 v104, s[24:27], s75 offen offset:0 sc1 lds
    v_mfma_f32_16x16x32_bf16 v[56:59], v[220:223], a[8:11], 0
    ds_read_b64_tr_b16 v[212:213], v173 offset:8192
    ds_read_b64_tr_b16 a[40:41], v88 offset:8192
    v_mfma_f32_16x16x32_bf16 v[60:63], v[220:223], a[12:15], 0
    ds_read_b64_tr_b16 v[214:215], v173 offset:10240
    v_mfma_f32_16x16x32_bf16 v[64:67], v[224:227], a[8:11], 0
    ds_read_b64_tr_b16 v[216:217], v176 offset:8192
    buffer_load_dwordx4 v105, s[24:27], s75 offen offset:1024 sc1 lds
    v_mfma_f32_16x16x32_bf16 v[68:71], v[224:227], a[12:15], 0
    ds_read_b64_tr_b16 a[42:43], v88 offset:10240
    ds_read_b64_tr_b16 v[218:219], v176 offset:10240
    v_mfma_f32_16x16x32_bf16 v[240:243], a[8:11], a[8:11], 0
    s_waitcnt lgkmcnt(6)
    v_mfma_f32_16x16x32_bf16 v[40:43], v[196:199], a[24:27], v[40:43]
    ds_read_b64_tr_b16 v[220:221], v173 offset:20480
    ds_read_b64_tr_b16 a[44:45], v91 offset:8192
    v_mfma_f32_16x16x32_bf16 v[44:47], v[196:199], a[28:31], v[44:47]
    buffer_load_dwordx4 v106, s[24:27], s75 offen offset:2048 sc1 lds
    ds_read_b64_tr_b16 v[222:223], v173 offset:22528
    v_mfma_f32_16x16x32_bf16 v[48:51], v[200:203], a[24:27], v[48:51]
    ds_read_b64_tr_b16 v[224:225], v176 offset:20480
    ds_read_b64_tr_b16 a[46:47], v91 offset:10240
    v_mfma_f32_16x16x32_bf16 v[52:55], v[200:203], a[28:31], v[52:55]
    ds_read_b64_tr_b16 v[226:227], v176 offset:22528
    v_mfma_f32_16x16x32_bf16 v[232:235], v[244:247], a[24:27], v[232:235]
    s_add_u32 m0, s40, 49152
    s_add_u32 s75, s41, 2654208
    buffer_load_dwordx4 v168, s[8:11], s75 offen offset:0  lds
    v_mfma_f32_16x16x32_bf16 v[56:59], v[204:207], a[24:27], v[56:59]
    ds_read_b64_tr_b16 v[196:197], v173 offset:24576
    ds_read_b64_tr_b16 a[56:57], v88 offset:12288
    v_mfma_f32_16x16x32_bf16 v[60:63], v[204:207], a[28:31], v[60:63]
    ds_read_b64_tr_b16 v[198:199], v173 offset:26624
    v_mfma_f32_16x16x32_bf16 v[64:67], v[208:211], a[24:27], v[64:67]
    ds_read_b64_tr_b16 v[200:201], v176 offset:24576
    ds_read_b64_tr_b16 a[58:59], v88 offset:14336
    v_mfma_f32_16x16x32_bf16 v[68:71], v[208:211], a[28:31], v[68:71]
    buffer_load_dwordx4 v169, s[8:11], s75 offen offset:1024  lds
    ds_read_b64_tr_b16 v[202:203], v176 offset:26624
    v_mfma_f32_16x16x32_bf16 v[240:243], a[24:27], a[24:27], v[240:243]
    s_waitcnt lgkmcnt(7)
    v_mfma_f32_16x16x32_bf16 v[40:43], v[212:215], a[40:43], v[40:43]
    ds_read_b64_tr_b16 v[204:205], v173 offset:36864
    ds_read_b64_tr_b16 a[60:61], v91 offset:12288
    v_mfma_f32_16x16x32_bf16 v[44:47], v[212:215], a[44:47], v[44:47]
    ds_read_b64_tr_b16 v[206:207], v173 offset:38912
    buffer_load_dwordx4 v170, s[8:11], s75 offen offset:2048  lds
    v_mfma_f32_16x16x32_bf16 v[48:51], v[216:219], a[40:43], v[48:51]
    ds_read_b64_tr_b16 v[208:209], v176 offset:36864
    ds_read_b64_tr_b16 a[62:63], v91 offset:14336
    v_mfma_f32_16x16x32_bf16 v[52:55], v[216:219], a[44:47], v[52:55]
    ds_read_b64_tr_b16 v[210:211], v176 offset:38912
    v_mfma_f32_16x16x32_bf16 v[232:235], v[244:247], a[40:43], v[232:235]
    s_waitcnt lgkmcnt(12)
    v_mfma_f32_16x16x32_bf16 v[56:59], v[220:223], a[40:43], v[56:59]
    s_add_u32 m0, s40, 52224
    s_add_u32 s75, s41, 2875392
    buffer_load_dwordx4 v168, s[8:11], s75 offen offset:0  lds
    ds_read_b64_tr_b16 a[72:73], v88 offset:16384
    ds_read_b64_tr_b16 v[212:213], v173 offset:28672
    v_mfma_f32_16x16x32_bf16 v[60:63], v[220:223], a[44:47], v[60:63]
    ds_read_b64_tr_b16 v[214:215], v173 offset:30720
    v_mfma_f32_16x16x32_bf16 v[64:67], v[224:227], a[40:43], v[64:67]
    ds_read_b64_tr_b16 v[216:217], v176 offset:28672
    ds_read_b64_tr_b16 a[74:75], v88 offset:18432
    v_mfma_f32_16x16x32_bf16 v[68:71], v[224:227], a[44:47], v[68:71]
    ds_read_b64_tr_b16 v[218:219], v176 offset:30720
    buffer_load_dwordx4 v169, s[8:11], s75 offen offset:1024  lds
    v_mfma_f32_16x16x32_bf16 v[240:243], a[40:43], a[40:43], v[240:243]
    ds_read_b64_tr_b16 a[76:77], v91 offset:16384
    s_waitcnt lgkmcnt(8)
    v_mfma_f32_16x16x32_bf16 v[40:43], v[196:199], a[56:59], v[40:43]
    ds_read_b64_tr_b16 v[220:221], v173 offset:40960
    v_mfma_f32_16x16x32_bf16 v[44:47], v[196:199], a[60:63], v[44:47]
    ds_read_b64_tr_b16 v[222:223], v173 offset:43008
    v_mfma_f32_16x16x32_bf16 v[48:51], v[200:203], a[56:59], v[48:51]
    buffer_load_dwordx4 v170, s[8:11], s75 offen offset:2048  lds
    ds_read_b64_tr_b16 v[224:225], v176 offset:40960
    ds_read_b64_tr_b16 a[78:79], v91 offset:18432
    v_mfma_f32_16x16x32_bf16 v[52:55], v[200:203], a[60:63], v[52:55]
    ds_read_b64_tr_b16 v[226:227], v176 offset:43008
    v_mfma_f32_16x16x32_bf16 v[232:235], v[244:247], a[56:59], v[232:235]
    ds_read_b64_tr_b16 a[88:89], v88 offset:20480
    s_waitcnt lgkmcnt(13)
    v_mfma_f32_16x16x32_bf16 v[56:59], v[204:207], a[56:59], v[56:59]
    ds_read_b64_tr_b16 v[196:197], v173 offset:32768
    v_mfma_f32_16x16x32_bf16 v[60:63], v[204:207], a[60:63], v[60:63]
    ds_read_b64_tr_b16 v[198:199], v173 offset:34816
    v_mfma_f32_16x16x32_bf16 v[64:67], v[208:211], a[56:59], v[64:67]
    ds_read_b64_tr_b16 a[90:91], v88 offset:22528
    ds_read_b64_tr_b16 v[200:201], v176 offset:32768
    v_mfma_f32_16x16x32_bf16 v[68:71], v[208:211], a[60:63], v[68:71]
    ds_read_b64_tr_b16 v[202:203], v176 offset:34816
    v_mfma_f32_16x16x32_bf16 v[240:243], a[56:59], a[56:59], v[240:243]
    ds_read_b64_tr_b16 a[92:93], v91 offset:20480
    s_waitcnt lgkmcnt(8)
    v_mfma_f32_16x16x32_bf16 v[40:43], v[212:215], a[72:75], v[40:43]
    ds_read_b64_tr_b16 v[204:205], v173 offset:45056
    s_add_u32 m0, s40, 0
    v_mfma_f32_16x16x32_bf16 v[44:47], v[212:215], a[76:79], v[44:47]
    ds_read_b64_tr_b16 v[206:207], v173 offset:47104
    s_add_u32 s75, s41, 3538944
    v_mfma_f32_16x16x32_bf16 v[48:51], v[216:219], a[72:75], v[48:51]
    ds_read_b64_tr_b16 a[94:95], v91 offset:22528
    ds_read_b64_tr_b16 v[208:209], v176 offset:45056
    v_mfma_f32_16x16x32_bf16 v[52:55], v[216:219], a[76:79], v[52:55]
    ds_read_b64_tr_b16 v[210:211], v176 offset:47104
    v_mfma_f32_16x16x32_bf16 v[232:235], v[244:247], a[72:75], v[232:235]
    s_waitcnt vmcnt(6) lgkmcnt(2)
    s_barrier
    ds_read_b64_tr_b16 a[104:105], v88 offset:24576
    v_mfma_f32_16x16x32_bf16 v[56:59], v[220:223], a[72:75], v[56:59]
    ds_read_b64_tr_b16 v[212:213], v172 offset:24576
    buffer_load_dwordx4 v168, s[8:11], s75 offen offset:0  lds
    v_mfma_f32_16x16x32_bf16 v[60:63], v[220:223], a[76:79], v[60:63]
    ds_read_b64_tr_b16 v[214:215], v172 offset:26624
    ds_read_b64_tr_b16 a[106:107], v88 offset:26624
    v_mfma_f32_16x16x32_bf16 v[64:67], v[224:227], a[72:75], v[64:67]
    ds_read_b64_tr_b16 v[216:217], v175 offset:24576
    buffer_load_dwordx4 v169, s[8:11], s75 offen offset:1024  lds
    v_mfma_f32_16x16x32_bf16 v[68:71], v[224:227], a[76:79], v[68:71]
    ds_read_b64_tr_b16 v[218:219], v175 offset:26624
    buffer_load_dwordx4 v170, s[8:11], s75 offen offset:2048  lds
    v_mfma_f32_16x16x32_bf16 v[240:243], a[72:75], a[72:75], v[240:243]
    ds_read_b64_tr_b16 a[108:109], v91 offset:24576
    s_add_u32 m0, s40, 3072
    v_mfma_f32_16x16x32_bf16 v[40:43], v[196:199], a[88:91], v[40:43]
    ds_read_b64_tr_b16 v[220:221], v172 offset:36864
    s_add_u32 s75, s41, 3760128
    v_mfma_f32_16x16x32_bf16 v[44:47], v[196:199], a[92:95], v[44:47]
    ds_read_b64_tr_b16 v[222:223], v172 offset:38912
    ds_read_b64_tr_b16 a[110:111], v91 offset:26624
    v_mfma_f32_16x16x32_bf16 v[48:51], v[200:203], a[88:91], v[48:51]
    ds_read_b64_tr_b16 v[224:225], v175 offset:36864
    buffer_load_dwordx4 v168, s[8:11], s75 offen offset:0  lds
    v_mfma_f32_16x16x32_bf16 v[52:55], v[200:203], a[92:95], v[52:55]
    ds_read_b64_tr_b16 v[226:227], v175 offset:38912
    ds_read_b64_tr_b16 a[120:121], v88 offset:28672
    v_mfma_f32_16x16x32_bf16 v[232:235], v[244:247], a[88:91], v[232:235]
    buffer_load_dwordx4 v169, s[8:11], s75 offen offset:1024  lds
    s_waitcnt lgkmcnt(13)
    v_mfma_f32_16x16x32_bf16 v[56:59], v[204:207], a[88:91], v[56:59]
    ds_read_b64_tr_b16 v[196:197], v172 offset:28672
    ds_read_b64_tr_b16 a[122:123], v88 offset:30720
    v_mfma_f32_16x16x32_bf16 v[60:63], v[204:207], a[92:95], v[60:63]
    ds_read_b64_tr_b16 v[198:199], v172 offset:30720
    buffer_load_dwordx4 v170, s[8:11], s75 offen offset:2048  lds
    v_mfma_f32_16x16x32_bf16 v[64:67], v[208:211], a[88:91], v[64:67]
    ds_read_b64_tr_b16 v[200:201], v175 offset:28672
    s_add_u32 m0, s40, 98304
    v_mfma_f32_16x16x32_bf16 v[68:71], v[208:211], a[92:95], v[68:71]
    ds_read_b64_tr_b16 a[124:125], v91 offset:28672
    ds_read_b64_tr_b16 v[202:203], v175 offset:30720
    v_mfma_f32_16x16x32_bf16 v[240:243], a[88:91], a[88:91], v[240:243]
    s_add_u32 s75, s48, 1574912
    s_waitcnt lgkmcnt(9)
    v_mfma_f32_16x16x32_bf16 v[40:43], v[212:215], a[104:107], v[40:43]
    ds_read_b64_tr_b16 v[204:205], v172 offset:40960
    ds_read_b64_tr_b16 a[126:127], v91 offset:30720
    v_mfma_f32_16x16x32_bf16 v[44:47], v[212:215], a[108:111], v[44:47]
    ds_read_b64_tr_b16 v[206:207], v172 offset:43008
    buffer_load_dwordx4 v104, s[24:27], s75 offen offset:0 sc1 lds
    v_mfma_f32_16x16x32_bf16 v[48:51], v[216:219], a[104:107], v[48:51]
    ds_read_b64_tr_b16 v[208:209], v175 offset:40960
    ds_read_b64_tr_b16 a[136:137], v88 offset:32768
    v_mfma_f32_16x16x32_bf16 v[52:55], v[216:219], a[108:111], v[52:55]
    ds_read_b64_tr_b16 v[210:211], v175 offset:43008
    buffer_load_dwordx4 v105, s[24:27], s75 offen offset:1024 sc1 lds
    v_mfma_f32_16x16x32_bf16 v[232:235], v[244:247], a[104:107], v[232:235]
    buffer_load_dwordx4 v106, s[24:27], s75 offen offset:2048 sc1 lds
    s_waitcnt lgkmcnt(13)
    v_mfma_f32_16x16x32_bf16 v[56:59], v[220:223], a[104:107], v[56:59]
    ds_read_b64_tr_b16 a[138:139], v88 offset:34816
    ds_read_b64_tr_b16 v[212:213], v172 offset:32768
    v_mfma_f32_16x16x32_bf16 v[60:63], v[220:223], a[108:111], v[60:63]
    ds_read_b64_tr_b16 v[214:215], v172 offset:34816
    s_add_u32 m0, s40, 101376
    v_mfma_f32_16x16x32_bf16 v[64:67], v[224:227], a[104:107], v[64:67]
    ds_read_b64_tr_b16 v[216:217], v175 offset:32768
    ds_read_b64_tr_b16 a[140:141], v91 offset:32768
    s_add_u32 s75, s48, 1673216
    v_mfma_f32_16x16x32_bf16 v[68:71], v[224:227], a[108:111], v[68:71]
    ds_read_b64_tr_b16 v[218:219], v175 offset:34816
    buffer_load_dwordx4 v104, s[24:27], s75 offen offset:0 sc1 lds
    v_mfma_f32_16x16x32_bf16 v[240:243], a[104:107], a[104:107], v[240:243]
    ds_read_b64_tr_b16 a[142:143], v91 offset:34816
    s_waitcnt lgkmcnt(11)
    v_mfma_f32_16x16x32_bf16 v[40:43], v[196:199], a[120:123], v[40:43]
    ds_read_b64_tr_b16 v[220:221], v172 offset:45056
    buffer_load_dwordx4 v105, s[24:27], s75 offen offset:1024 sc1 lds
    v_mfma_f32_16x16x32_bf16 v[44:47], v[196:199], a[124:127], v[44:47]
    ds_read_b64_tr_b16 v[222:223], v172 offset:47104
    ds_read_b64_tr_b16 a[152:153], v88 offset:36864
    v_mfma_f32_16x16x32_bf16 v[48:51], v[200:203], a[120:123], v[48:51]
    s_waitcnt vmcnt(11)
    s_barrier
    ds_read_b64_tr_b16 v[224:225], v175 offset:45056
    buffer_load_dwordx4 v106, s[24:27], s75 offen offset:2048 sc1 lds
    v_mfma_f32_16x16x32_bf16 v[52:55], v[200:203], a[124:127], v[52:55]
    ds_read_b64_tr_b16 v[226:227], v175 offset:47104
    s_add_u32 m0, s40, 122880
    v_mfma_f32_16x16x32_bf16 v[232:235], v[244:247], a[120:123], v[232:235]
    ds_read_b64_tr_b16 a[154:155], v88 offset:38912
    s_waitcnt lgkmcnt(13)
    v_mfma_f32_16x16x32_bf16 v[56:59], v[204:207], a[120:123], v[56:59]
    s_add_u32 s75, s41, 4423680
    buffer_load_dwordx4 v168, s[8:11], s75 offen offset:0  lds
    v_mfma_f32_16x16x32_bf16 v[60:63], v[204:207], a[124:127], v[60:63]
    ds_read_b64_tr_b16 a[156:157], v91 offset:36864
    v_mfma_f32_16x16x32_bf16 v[64:67], v[208:211], a[120:123], v[64:67]
    v_mfma_f32_16x16x32_bf16 v[68:71], v[208:211], a[124:127], v[68:71]
    ds_read_b64_tr_b16 a[158:159], v91 offset:38912
    v_mfma_f32_16x16x32_bf16 v[240:243], a[120:123], a[120:123], v[240:243]
    buffer_load_dwordx4 v169, s[8:11], s75 offen offset:1024  lds
    s_waitcnt lgkmcnt(8)
    v_mfma_f32_16x16x32_bf16 v[40:43], v[212:215], a[136:139], v[40:43]
    ds_read_b64_tr_b16 v[196:197], v172 offset:0
    v_mfma_f32_16x16x32_bf16 v[44:47], v[212:215], a[140:143], v[44:47]
    ds_read_b64_tr_b16 a[168:169], v88 offset:40960
    ds_read_b64_tr_b16 v[198:199], v172 offset:2048
    v_mfma_f32_16x16x32_bf16 v[48:51], v[216:219], a[136:139], v[48:51]
    ds_read_b64_tr_b16 v[200:201], v175 offset:0
    v_mfma_f32_16x16x32_bf16 v[52:55], v[216:219], a[140:143], v[52:55]
    ds_read_b64_tr_b16 v[202:203], v175 offset:2048
    ds_read_b64_tr_b16 a[170:171], v88 offset:43008
    v_mfma_f32_16x16x32_bf16 v[232:235], v[244:247], a[136:139], v[232:235]
    s_waitcnt lgkmcnt(9)
    v_mfma_f32_16x16x32_bf16 v[56:59], v[220:223], a[136:139], v[56:59]
    ds_read_b64_tr_b16 v[204:205], v172 offset:12288
    ds_read_b64_tr_b16 a[172:173], v91 offset:40960
    v_mfma_f32_16x16x32_bf16 v[60:63], v[220:223], a[140:143], v[60:63]
    ds_read_b64_tr_b16 v[206:207], v172 offset:14336
    buffer_load_dwordx4 v170, s[8:11], s75 offen offset:2048  lds
    v_mfma_f32_16x16x32_bf16 v[64:67], v[224:227], a[136:139], v[64:67]
    ds_read_b64_tr_b16 v[208:209], v175 offset:12288
    ds_read_b64_tr_b16 a[174:175], v91 offset:43008
    v_mfma_f32_16x16x32_bf16 v[68:71], v[224:227], a[140:143], v[68:71]
    s_mov_b32 s68, 7873536
    s_mov_b32 s69, 7876608
    ds_read_b64_tr_b16 v[210:211], v175 offset:14336
    v_mfma_f32_16x16x32_bf16 v[240:243], a[136:139], a[136:139], v[240:243]
    buffer_load_dword v116, v115, s[24:27], s68 offen offset:0 sc1
    buffer_load_dword v117, v115, s[24:27], s69 offen offset:0 sc1
    s_waitcnt lgkmcnt(9)
    v_mfma_f32_16x16x32_bf16 v[8:11], v[196:199], a[144:147], v[8:11]
    ds_read_b64_tr_b16 a[184:185], v88 offset:45056
    ds_read_b64_tr_b16 v[212:213], v172 offset:4096
    s_waitcnt lgkmcnt(9)
    v_mfma_f32_16x16x32_bf16 v[16:19], v[200:203], a[144:147], v[16:19]
    ds_read_b64_tr_b16 v[214:215], v172 offset:6144
    s_add_u32 m0, s40, 125952
    v_mfma_f32_16x16x32_bf16 v[12:15], v[196:199], a[148:151], v[12:15]
    ds_read_b64_tr_b16 a[186:187], v88 offset:47104
    s_add_u32 s75, s41, 4644864
    v_mfma_f32_16x16x32_bf16 v[20:23], v[200:203], a[148:151], v[20:23]
    buffer_load_dwordx4 v168, s[8:11], s75 offen offset:0  lds
    v_mfma_f32_16x16x32_bf16 v[40:43], v[196:199], a[152:155], v[40:43]
    ds_read_b64_tr_b16 v[216:217], v175 offset:4096
    ds_read_b64_tr_b16 a[188:189], v91 offset:45056
    v_mfma_f32_16x16x32_bf16 v[48:51], v[200:203], a[152:155], v[48:51]
    ds_read_b64_tr_b16 v[218:219], v175 offset:6144
    v_mfma_f32_16x16x32_bf16 v[44:47], v[196:199], a[156:159], v[44:47]
    v_mfma_f32_16x16x32_bf16 v[52:55], v[200:203], a[156:159], v[52:55]
    ds_read_b64_tr_b16 a[190:191], v91 offset:47104
    v_mfma_f32_16x16x32_bf16 v[232:235], v[244:247], a[152:155], v[232:235]
    s_waitcnt lgkmcnt(11)
    v_mfma_f32_16x16x32_bf16 v[60:63], v[204:207], a[156:159], v[60:63]
    ds_read_b64_tr_b16 v[220:221], v172 offset:16384
    s_waitcnt lgkmcnt(9)
    v_mfma_f32_16x16x32_bf16 v[68:71], v[208:211], a[156:159], v[68:71]
    ds_read_b64_tr_b16 v[222:223], v172 offset:18432
    buffer_load_dwordx4 v169, s[8:11], s75 offen offset:1024  lds
    v_mfma_f32_16x16x32_bf16 v[56:59], v[204:207], a[152:155], v[56:59]
    v_mfma_f32_16x16x32_bf16 v[64:67], v[208:211], a[152:155], v[64:67]
    v_mfma_f32_16x16x32_bf16 v[28:31], v[204:207], a[148:151], v[28:31]
    ds_read_b64_tr_b16 v[224:225], v175 offset:16384
    v_mfma_f32_16x16x32_bf16 v[36:39], v[208:211], a[148:151], v[36:39]
    ds_read_b64_tr_b16 v[226:227], v175 offset:18432
    v_mfma_f32_16x16x32_bf16 v[24:27], v[204:207], a[144:147], v[24:27]
    v_mfma_f32_16x16x32_bf16 v[32:35], v[208:211], a[144:147], v[32:35]
    v_mfma_f32_16x16x32_bf16 v[240:243], a[152:155], a[152:155], v[240:243]
    buffer_load_dwordx4 v170, s[8:11], s75 offen offset:2048  lds
    s_waitcnt lgkmcnt(9)
    v_mfma_f32_16x16x32_bf16 v[8:11], v[212:215], a[160:163], v[8:11]
    ds_read_b64_tr_b16 v[196:197], v172 offset:8192
    s_waitcnt lgkmcnt(6)
    v_mfma_f32_16x16x32_bf16 v[16:19], v[216:219], a[160:163], v[16:19]
    ds_read_b64_tr_b16 v[198:199], v172 offset:10240
    v_mfma_f32_16x16x32_bf16 v[12:15], v[212:215], a[164:167], v[12:15]
    v_mfma_f32_16x16x32_bf16 v[20:23], v[216:219], a[164:167], v[20:23]
    v_mfma_f32_16x16x32_bf16 v[40:43], v[212:215], a[168:171], v[40:43]
    ds_read_b64_tr_b16 v[200:201], v175 offset:8192
    v_mfma_f32_16x16x32_bf16 v[48:51], v[216:219], a[168:171], v[48:51]
    ds_read_b64_tr_b16 v[202:203], v175 offset:10240
    v_mfma_f32_16x16x32_bf16 v[44:47], v[212:215], a[172:175], v[44:47]
    v_mfma_f32_16x16x32_bf16 v[52:55], v[216:219], a[172:175], v[52:55]
    v_mfma_f32_16x16x32_bf16 v[232:235], v[244:247], a[168:171], v[232:235]
    s_waitcnt lgkmcnt(6)
    v_mfma_f32_16x16x32_bf16 v[60:63], v[220:223], a[172:175], v[60:63]
    ds_read_b64_tr_b16 v[204:205], v172 offset:20480
    s_waitcnt lgkmcnt(5)
    v_mfma_f32_16x16x32_bf16 v[68:71], v[224:227], a[172:175], v[68:71]
    ds_read_b64_tr_b16 v[206:207], v172 offset:22528
    v_mfma_f32_16x16x32_bf16 v[56:59], v[220:223], a[168:171], v[56:59]
    v_mfma_f32_16x16x32_bf16 v[64:67], v[224:227], a[168:171], v[64:67]
    v_mfma_f32_16x16x32_bf16 v[28:31], v[220:223], a[164:167], v[28:31]
    ds_read_b64_tr_b16 v[208:209], v175 offset:20480
    v_mfma_f32_16x16x32_bf16 v[36:39], v[224:227], a[164:167], v[36:39]
    ds_read_b64_tr_b16 v[210:211], v175 offset:22528
    s_add_u32 m0, s40, 73728
    v_mfma_f32_16x16x32_bf16 v[24:27], v[220:223], a[160:163], v[24:27]
    s_add_u32 s75, s41, 128
    v_mfma_f32_16x16x32_bf16 v[32:35], v[224:227], a[160:163], v[32:35]
    v_mfma_f32_16x16x32_bf16 v[240:243], a[168:171], a[168:171], v[240:243]
    s_waitcnt lgkmcnt(6)
    v_mfma_f32_16x16x32_bf16 v[8:11], v[196:199], a[176:179], v[8:11]
    s_waitcnt vmcnt(8)
    s_barrier
    ds_read_b64_tr_b16 v[212:213], v171 offset:0
    s_waitcnt lgkmcnt(5)
    v_mfma_f32_16x16x32_bf16 v[16:19], v[200:203], a[176:179], v[16:19]
    ds_read_b64_tr_b16 a[200:201], v90 offset:0
    ds_read_b64_tr_b16 v[214:215], v171 offset:2048
    v_mfma_f32_16x16x32_bf16 v[12:15], v[196:199], a[180:183], v[12:15]
    buffer_load_dwordx4 v168, s[8:11], s75 offen offset:0  lds
    v_mfma_f32_16x16x32_bf16 v[20:23], v[200:203], a[180:183], v[20:23]
    ds_read_b64_tr_b16 a[202:203], v90 offset:2048
    v_mfma_f32_16x16x32_bf16 v[40:43], v[196:199], a[184:187], v[40:43]
    ds_read_b64_tr_b16 v[216:217], v174 offset:0
    v_mfma_f32_16x16x32_bf16 v[48:51], v[200:203], a[184:187], v[48:51]
    ds_read_b64_tr_b16 v[218:219], v174 offset:2048
    ds_read_b64_tr_b16 a[204:205], v93 offset:0
    v_mfma_f32_16x16x32_bf16 v[44:47], v[196:199], a[188:191], v[44:47]
    v_mfma_f32_16x16x32_bf16 v[52:55], v[200:203], a[188:191], v[52:55]
    ds_read_b64_tr_b16 a[206:207], v93 offset:2048
    buffer_load_dwordx4 v169, s[8:11], s75 offen offset:1024  lds
    v_mfma_f32_16x16x32_bf16 v[232:235], v[244:247], a[184:187], v[232:235]
    s_waitcnt lgkmcnt(10)
    v_mfma_f32_16x16x32_bf16 v[60:63], v[204:207], a[188:191], v[60:63]
    ds_read_b64_tr_b16 v[220:221], v171 offset:12288
    ds_read_b64_tr_b16 a[216:217], v90 offset:4096
    s_waitcnt lgkmcnt(10)
    v_mfma_f32_16x16x32_bf16 v[68:71], v[208:211], a[188:191], v[68:71]
    ds_read_b64_tr_b16 v[222:223], v171 offset:14336
    v_mfma_f32_16x16x32_bf16 v[56:59], v[204:207], a[184:187], v[56:59]
    ds_read_b64_tr_b16 a[218:219], v90 offset:6144
    v_mfma_f32_16x16x32_bf16 v[64:67], v[208:211], a[184:187], v[64:67]
    v_mfma_f32_16x16x32_bf16 v[28:31], v[204:207], a[180:183], v[28:31]
    ds_read_b64_tr_b16 v[224:225], v174 offset:12288
    ds_read_b64_tr_b16 a[220:221], v93 offset:4096
    v_mfma_f32_16x16x32_bf16 v[36:39], v[208:211], a[180:183], v[36:39]
    ds_read_b64_tr_b16 v[226:227], v174 offset:14336
    buffer_load_dwordx4 v170, s[8:11], s75 offen offset:2048  lds
    v_mfma_f32_16x16x32_bf16 v[24:27], v[204:207], a[176:179], v[24:27]
    ds_read_b64_tr_b16 a[222:223], v93 offset:6144
    v_mfma_f32_16x16x32_bf16 v[32:35], v[208:211], a[176:179], v[32:35]
    v_mfma_f32_16x16x32_bf16 v[240:243], a[184:187], a[184:187], v[240:243]
    s_add_u32 m0, s40, 76800
    s_waitcnt lgkmcnt(13)
    v_mfma_f32_16x16x32_bf16 v[8:11], v[212:215], a[192:195], v[8:11]
    ds_read_b64_tr_b16 a[232:233], v90 offset:8192
    ds_read_b64_tr_b16 v[196:197], v171 offset:4096
    s_waitcnt lgkmcnt(12)
    v_mfma_f32_16x16x32_bf16 v[16:19], v[216:219], a[192:195], v[16:19]
    ds_read_b64_tr_b16 v[198:199], v171 offset:6144
    s_add_u32 s75, s41, 221312
    v_mfma_f32_16x16x32_bf16 v[12:15], v[212:215], a[196:199], v[12:15]
    ds_read_b64_tr_b16 a[234:235], v90 offset:10240
    v_mfma_f32_16x16x32_bf16 v[20:23], v[216:219], a[196:199], v[20:23]
    buffer_load_dwordx4 v168, s[8:11], s75 offen offset:0  lds
    s_waitcnt lgkmcnt(12)
    v_mfma_f32_16x16x32_bf16 v[40:43], v[212:215], a[200:203], v[40:43]
    ds_read_b64_tr_b16 v[200:201], v174 offset:4096
    ds_read_b64_tr_b16 a[236:237], v93 offset:8192
    v_mfma_f32_16x16x32_bf16 v[48:51], v[216:219], a[200:203], v[48:51]
    ds_read_b64_tr_b16 v[202:203], v174 offset:6144
    v_mfma_f32_16x16x32_bf16 v[44:47], v[212:215], a[204:207], v[44:47]
    ds_read_b64_tr_b16 a[238:239], v93 offset:10240
    v_mfma_f32_16x16x32_bf16 v[52:55], v[216:219], a[204:207], v[52:55]
    v_mfma_f32_16x16x32_bf16 v[232:235], v[244:247], a[200:203], v[232:235]
    ds_read_b64_tr_b16 a[248:249], v90 offset:12288
    s_waitcnt lgkmcnt(14)
    v_mfma_f32_16x16x32_bf16 v[60:63], v[220:223], a[204:207], v[60:63]
    ds_read_b64_tr_b16 v[204:205], v171 offset:16384
    s_waitcnt lgkmcnt(11)
    v_mfma_f32_16x16x32_bf16 v[68:71], v[224:227], a[204:207], v[68:71]
    s_waitcnt vmcnt(7)
    v_xor_b32 v116, s3, v116
    v_xor_b32 v117, s3, v117
    v_or_b32 v116, v116, v117
    v_cmp_ne_u32 vcc, 0, v116
    s_cbranch_vccnz SLOW_29
BACK_30:
    ds_read_b64_tr_b16 v[206:207], v171 offset:18432
    ds_read_b64_tr_b16 a[250:251], v90 offset:14336
    v_mfma_f32_16x16x32_bf16 v[56:59], v[220:223], a[200:203], v[56:59]
    s_or_b32 s74, s7, s36
    s_cbranch_scc1 EPW_33
    s_mov_b32 s74, 7733248
    s_mov_b64 exec, 1
    v_mov_b32 v116, s3
    v_mul_u32_u24 v117, 0, v2
    buffer_store_dword v116, v117, s[24:27], s74 offen sc1
    s_mov_b64 exec, -1
EPW_33:
    v_mfma_f32_16x16x32_bf16 v[64:67], v[224:227], a[200:203], v[64:67]
    s_lshl_b32 s74, s47, 2
    s_add_u32 s74, s74, 7110656
    buffer_load_dwordx4 v[120:123], v112, s[24:27], s74 offen sc1
    s_add_u32 s74, s74, 36864
    buffer_load_dwordx4 v[124:127], v112, s[24:27], s74 offen sc1
    s_add_u32 s74, s74, 36864
    buffer_load_dwordx4 v[128:131], v112, s[24:27], s74 offen sc1
    s_add_u32 s74, s74, 36864
    buffer_load_dwordx4 v[132:135], v112, s[24:27], s74 offen sc1
    ds_read_b64_tr_b16 a[252:253], v93 offset:12288
    v_mfma_f32_16x16x32_bf16 v[28:31], v[220:223], a[196:199], v[28:31]
    ds_read_b64_tr_b16 v[208:209], v174 offset:16384
    buffer_load_dwordx4 v169, s[8:11], s75 offen offset:1024  lds
    v_mfma_f32_16x16x32_bf16 v[36:39], v[224:227], a[196:199], v[36:39]
    ds_read_b64_tr_b16 v[210:211], v174 offset:18432
    ds_read_b64_tr_b16 a[254:255], v93 offset:14336
    v_mfma_f32_16x16x32_bf16 v[24:27], v[220:223], a[192:195], v[24:27]
    v_mfma_f32_16x16x32_bf16 v[32:35], v[224:227], a[192:195], v[32:35]
    v_mfma_f32_16x16x32_bf16 v[240:243], a[200:203], a[200:203], v[240:243]
    ds_read_b64_tr_b16 v[144:145], v90 offset:16384
    s_waitcnt lgkmcnt(14)
    v_mfma_f32_16x16x32_bf16 v[8:11], v[196:199], a[208:211], v[8:11]
    ds_read_b64_tr_b16 v[212:213], v171 offset:8192
    s_waitcnt lgkmcnt(11)
    v_mfma_f32_16x16x32_bf16 v[16:19], v[200:203], a[208:211], v[16:19]
    ds_read_b64_tr_b16 v[214:215], v171 offset:10240
    ds_read_b64_tr_b16 v[146:147], v90 offset:18432
    v_mfma_f32_16x16x32_bf16 v[12:15], v[196:199], a[212:215], v[12:15]
    buffer_load_dwordx4 v170, s[8:11], s75 offen offset:2048  lds
    v_mfma_f32_16x16x32_bf16 v[20:23], v[200:203], a[212:215], v[20:23]
    ds_read_b64_tr_b16 v[148:149], v93 offset:16384
    v_mfma_f32_16x16x32_bf16 v[40:43], v[196:199], a[216:219], v[40:43]
    ds_read_b64_tr_b16 v[216:217], v174 offset:8192
    v_mfma_f32_16x16x32_bf16 v[48:51], v[200:203], a[216:219], v[48:51]
    ds_read_b64_tr_b16 v[218:219], v174 offset:10240
    ds_read_b64_tr_b16 v[150:151], v93 offset:18432
    v_mfma_f32_16x16x32_bf16 v[44:47], v[196:199], a[220:223], v[44:47]
    v_mfma_f32_16x16x32_bf16 v[52:55], v[200:203], a[220:223], v[52:55]
    ds_read_b64_tr_b16 v[160:161], v90 offset:20480
    v_mfma_f32_16x16x32_bf16 v[232:235], v[244:247], a[216:219], v[232:235]
    s_waitcnt lgkmcnt(14)
    v_mfma_f32_16x16x32_bf16 v[60:63], v[204:207], a[220:223], v[60:63]
    ds_read_b64_tr_b16 v[220:221], v171 offset:20480
    ds_read_b64_tr_b16 v[162:163], v90 offset:22528
    s_waitcnt lgkmcnt(12)
    v_mfma_f32_16x16x32_bf16 v[68:71], v[208:211], a[220:223], v[68:71]
    ds_read_b64_tr_b16 v[222:223], v171 offset:22528
    v_mfma_f32_16x16x32_bf16 v[56:59], v[204:207], a[216:219], v[56:59]
    ds_read_b64_tr_b16 v[164:165], v93 offset:20480
    v_mfma_f32_16x16x32_bf16 v[64:67], v[208:211], a[216:219], v[64:67]
    v_mfma_f32_16x16x32_bf16 v[28:31], v[204:207], a[212:215], v[28:31]
    ds_read_b64_tr_b16 v[224:225], v174 offset:20480
    v_mfma_f32_16x16x32_bf16 v[36:39], v[208:211], a[212:215], v[36:39]
    ds_read_b64_tr_b16 v[166:167], v93 offset:22528
    ds_read_b64_tr_b16 v[226:227], v174 offset:22528
    v_mfma_f32_16x16x32_bf16 v[24:27], v[204:207], a[208:211], v[24:27]
    s_add_u32 m0, s40, 24576
    s_add_u32 s75, s41, 884864
    v_mfma_f32_16x16x32_bf16 v[32:35], v[208:211], a[208:211], v[32:35]
    v_mfma_f32_16x16x32_bf16 v[240:243], a[216:219], a[216:219], v[240:243]
    s_waitcnt lgkmcnt(13)
    v_mfma_f32_16x16x32_bf16 v[8:11], v[212:215], a[224:227], v[8:11]
    s_waitcnt vmcnt(10) lgkmcnt(1)
    s_barrier
    ds_read_b64_tr_b16 v[196:197], v173 offset:24576
    v_mfma_f32_16x16x32_bf16 v[16:19], v[216:219], a[224:227], v[16:19]
    ds_read_b64_tr_b16 v[198:199], v173 offset:26624
    buffer_load_dwordx4 v168, s[8:11], s75 offen offset:0  lds
    v_mfma_f32_16x16x32_bf16 v[12:15], v[212:215], a[228:231], v[12:15]
    v_mfma_f32_16x16x32_bf16 v[20:23], v[216:219], a[228:231], v[20:23]
    v_mfma_f32_16x16x32_bf16 v[40:43], v[212:215], a[232:235], v[40:43]
    ds_read_b64_tr_b16 v[200:201], v176 offset:24576
    buffer_load_dwordx4 v169, s[8:11], s75 offen offset:1024  lds
    v_mfma_f32_16x16x32_bf16 v[48:51], v[216:219], a[232:235], v[48:51]
    ds_read_b64_tr_b16 v[202:203], v176 offset:26624
    v_mfma_f32_16x16x32_bf16 v[44:47], v[212:215], a[236:239], v[44:47]
    v_mfma_f32_16x16x32_bf16 v[52:55], v[216:219], a[236:239], v[52:55]
    buffer_load_dwordx4 v170, s[8:11], s75 offen offset:2048  lds
    s_add_u32 m0, s40, 27648
    v_mfma_f32_16x16x32_bf16 v[232:235], v[244:247], a[232:235], v[232:235]
    s_add_u32 s75, s41, 1106048
    v_mfma_f32_16x16x32_bf16 v[60:63], v[220:223], a[236:239], v[60:63]
    ds_read_b64_tr_b16 v[204:205], v173 offset:36864
    s_waitcnt lgkmcnt(5)
    v_mfma_f32_16x16x32_bf16 v[68:71], v[224:227], a[236:239], v[68:71]
    ds_read_b64_tr_b16 v[206:207], v173 offset:38912
    v_mfma_f32_16x16x32_bf16 v[56:59], v[220:223], a[232:235], v[56:59]
    buffer_load_dwordx4 v168, s[8:11], s75 offen offset:0  lds
    v_mfma_f32_16x16x32_bf16 v[64:67], v[224:227], a[232:235], v[64:67]
    v_mfma_f32_16x16x32_bf16 v[28:31], v[220:223], a[228:231], v[28:31]
    ds_read_b64_tr_b16 v[208:209], v176 offset:36864
    v_mfma_f32_16x16x32_bf16 v[36:39], v[224:227], a[228:231], v[36:39]
    ds_read_b64_tr_b16 v[210:211], v176 offset:38912
    buffer_load_dwordx4 v169, s[8:11], s75 offen offset:1024  lds
    v_mfma_f32_16x16x32_bf16 v[24:27], v[220:223], a[224:227], v[24:27]
    v_mfma_f32_16x16x32_bf16 v[32:35], v[224:227], a[224:227], v[32:35]
    v_mfma_f32_16x16x32_bf16 v[240:243], a[232:235], a[232:235], v[240:243]
    s_waitcnt lgkmcnt(6)
    v_mfma_f32_16x16x32_bf16 v[8:11], v[196:199], a[240:243], v[8:11]
    ds_read_b64_tr_b16 v[212:213], v173 offset:28672
    s_waitcnt lgkmcnt(5)
    v_mfma_f32_16x16x32_bf16 v[16:19], v[200:203], a[240:243], v[16:19]
    ds_read_b64_tr_b16 v[214:215], v173 offset:30720
    buffer_load_dwordx4 v170, s[8:11], s75 offen offset:2048  lds
    v_mfma_f32_16x16x32_bf16 v[12:15], v[196:199], a[244:247], v[12:15]
    s_add_u32 m0, s40, 49152
    s_add_u32 s75, s41, 1769600
    v_mfma_f32_16x16x32_bf16 v[20:23], v[200:203], a[244:247], v[20:23]
    buffer_load_dwordx4 v168, s[8:11], s75 offen offset:0  lds
    v_mfma_f32_16x16x32_bf16 v[40:43], v[196:199], a[248:251], v[40:43]
    ds_read_b64_tr_b16 v[216:217], v176 offset:28672
    v_mfma_f32_16x16x32_bf16 v[48:51], v[200:203], a[248:251], v[48:51]
    ds_read_b64_tr_b16 v[218:219], v176 offset:30720
    v_mfma_f32_16x16x32_bf16 v[44:47], v[196:199], a[252:255], v[44:47]
    v_mfma_f32_16x16x32_bf16 v[52:55], v[200:203], a[252:255], v[52:55]
    buffer_load_dwordx4 v169, s[8:11], s75 offen offset:1024  lds
    v_mfma_f32_16x16x32_bf16 v[232:235], v[244:247], a[248:251], v[232:235]
    v_add_u32 v86, s17, v3
    s_waitcnt lgkmcnt(6)
    v_mfma_f32_16x16x32_bf16 v[60:63], v[204:207], a[252:255], v[60:63]
    ds_read_b64_tr_b16 v[220:221], v173 offset:40960
    v_lshrrev_b32 v85, 1, v3
    s_waitcnt lgkmcnt(5)
    v_mfma_f32_16x16x32_bf16 v[68:71], v[208:211], a[252:255], v[68:71]
    ds_read_b64_tr_b16 v[222:223], v173 offset:43008
    buffer_load_dwordx4 v170, s[8:11], s75 offen offset:2048  lds
    v_mfma_f32_16x16x32_bf16 v[56:59], v[204:207], a[248:251], v[56:59]
    v_or_b32 v87, s94, v3
    s_add_u32 m0, s40, 52224
    v_mfma_f32_16x16x32_bf16 v[64:67], v[208:211], a[248:251], v[64:67]
    ds_read_b64_tr_b16 v[72:73], v86 offset:0
    s_add_u32 s75, s41, 1990784
    v_mfma_f32_16x16x32_bf16 v[28:31], v[204:207], a[244:247], v[28:31]
    ds_read_b64_tr_b16 v[224:225], v176 offset:40960
    v_mfma_f32_16x16x32_bf16 v[36:39], v[208:211], a[244:247], v[36:39]
    ds_read_b64_tr_b16 v[226:227], v176 offset:43008
    ds_read_b64_tr_b16 v[74:75], v86 offset:1024
    v_mfma_f32_16x16x32_bf16 v[24:27], v[204:207], a[240:243], v[24:27]
    ds_read_b64_tr_b16 v[76:77], v86 offset:8
    buffer_load_dwordx4 v168, s[8:11], s75 offen offset:0  lds
    v_mfma_f32_16x16x32_bf16 v[32:35], v[208:211], a[240:243], v[32:35]
    v_mfma_f32_16x16x32_bf16 v[240:243], a[248:251], a[248:251], v[240:243]
    ds_read_b64_tr_b16 v[78:79], v86 offset:1032
    s_waitcnt lgkmcnt(10)
    v_mfma_f32_16x16x32_bf16 v[8:11], v[212:215], v[136:139], v[8:11]
    ds_read_b64_tr_b16 v[196:197], v173 offset:32768
    ds_read_b64_tr_b16 v[80:81], v85 offset:13312
    s_waitcnt lgkmcnt(10)
    v_mfma_f32_16x16x32_bf16 v[16:19], v[216:219], v[136:139], v[16:19]
    ds_read_b64_tr_b16 v[198:199], v173 offset:34816
    buffer_load_dwordx4 v169, s[8:11], s75 offen offset:1024  lds
    v_mfma_f32_16x16x32_bf16 v[12:15], v[212:215], v[140:143], v[12:15]
    ds_read_b64_tr_b16 v[82:83], v85 offset:13824
    v_mfma_f32_16x16x32_bf16 v[20:23], v[216:219], v[140:143], v[20:23]
    buffer_load_dwordx4 v170, s[8:11], s75 offen offset:2048  lds
    v_mfma_f32_16x16x32_bf16 v[40:43], v[212:215], v[144:147], v[40:43]
    ds_read_b64_tr_b16 v[200:201], v176 offset:32768
    v_mfma_f32_16x16x32_bf16 v[48:51], v[216:219], v[144:147], v[48:51]
    ds_read_b64_tr_b16 v[202:203], v176 offset:34816
    v_mfma_f32_16x16x32_bf16 v[44:47], v[212:215], v[148:151], v[44:47]
    v_mov_b32 v195, v111
    v_mfma_f32_16x16x32_bf16 v[52:55], v[216:219], v[148:151], v[52:55]
    v_mfma_f32_16x16x32_bf16 v[232:235], v[244:247], v[144:147], v[232:235]
    s_waitcnt lgkmcnt(12)
    v_mfma_f32_16x16x32_bf16 v[60:63], v[220:223], v[148:151], v[60:63]
    ds_read_b64_tr_b16 v[204:205], v173 offset:45056
    s_waitcnt lgkmcnt(10)
    v_mfma_f32_16x16x32_bf16 v[68:71], v[224:227], v[148:151], v[68:71]
    ds_read_b64_tr_b16 v[206:207], v173 offset:47104
    v_mfma_f32_16x16x32_bf16 v[56:59], v[220:223], v[144:147], v[56:59]
    v_mfma_f32_16x16x32_bf16 v[64:67], v[224:227], v[144:147], v[64:67]
    v_mfma_f32_16x16x32_bf16 v[28:31], v[220:223], v[140:143], v[28:31]
    ds_read_b64_tr_b16 v[208:209], v176 offset:45056
    v_mfma_f32_16x16x32_bf16 v[36:39], v[224:227], v[140:143], v[36:39]
    ds_read_b64_tr_b16 v[210:211], v176 offset:47104
    s_add_u32 m0, s40, 98304
    v_mfma_f32_16x16x32_bf16 v[24:27], v[220:223], v[136:139], v[24:27]
    s_add_u32 s75, s41, 2654336
    v_mfma_f32_16x16x32_bf16 v[32:35], v[224:227], v[136:139], v[32:35]
    s_waitcnt lgkmcnt(12)
    buffer_store_dwordx4 v[72:75], v3, s[24:27], s15 offen offset:0 sc1
    v_mfma_f32_16x16x32_bf16 v[240:243], v[144:147], v[144:147], v[240:243]
    s_waitcnt lgkmcnt(7)
    v_mfma_f32_16x16x32_bf16 v[8:11], v[196:199], v[152:155], v[8:11]
    s_waitcnt vmcnt(13)
    s_barrier
    ds_read_b64_tr_b16 v[212:213], v172 offset:24576
    ds_read_b64_tr_b16 v[216:217], v172 offset:28672
    v_add_f32 v120, v120, v124
    v_add_f32 v128, v128, v132
    v_add_f32 v120, v120, v128
    s_waitcnt lgkmcnt(6)
    v_mfma_f32_16x16x32_bf16 v[16:19], v[200:203], v[152:155], v[16:19]
    ds_read_b64_tr_b16 v[214:215], v172 offset:26624
    ds_read_b64_tr_b16 v[218:219], v172 offset:30720
    v_mfma_f32_16x16x32_bf16 v[12:15], v[196:199], v[156:159], v[12:15]
    v_add_f32 v121, v121, v125
    v_add_f32 v129, v129, v133
    v_add_f32 v121, v121, v129
    buffer_store_dwordx4 v[76:79], v3, s[24:27], s15 offen offset:1024 sc1
    v_mfma_f32_16x16x32_bf16 v[20:23], v[200:203], v[156:159], v[20:23]
    buffer_load_dwordx4 v168, s[8:11], s75 offen offset:0  lds
    v_mfma_f32_16x16x32_bf16 v[40:43], v[196:199], v[160:163], v[40:43]
    ds_read_b64_tr_b16 v[220:221], v172 offset:32768
    v_add_f32 v122, v122, v126
    v_add_f32 v130, v130, v134
    v_add_f32 v122, v122, v130
    v_mfma_f32_16x16x32_bf16 v[48:51], v[200:203], v[160:163], v[48:51]
    ds_read_b64_tr_b16 v[222:223], v172 offset:34816
    v_mfma_f32_16x16x32_bf16 v[44:47], v[196:199], v[164:167], v[44:47]
    v_add_f32 v123, v123, v127
    v_add_f32 v131, v131, v135
    v_add_f32 v123, v123, v131
    buffer_store_dwordx4 v[80:83], v87, s[24:27], s16 offen offset:0 sc1
    v_mfma_f32_16x16x32_bf16 v[52:55], v[200:203], v[164:167], v[52:55]
    buffer_load_dwordx4 v169, s[8:11], s75 offen offset:1024  lds
    v_mfma_f32_16x16x32_bf16 v[232:235], v[244:247], v[160:163], v[232:235]
    ds_write_b128 v113, v[120:123]
    s_waitcnt lgkmcnt(9)
    v_mfma_f32_16x16x32_bf16 v[60:63], v[204:207], v[164:167], v[60:63]
    ds_read_b64_tr_b16 v[224:225], v175 offset:24576
    s_waitcnt lgkmcnt(8)
    v_mfma_f32_16x16x32_bf16 v[68:71], v[208:211], v[164:167], v[68:71]
    ds_read_b64_tr_b16 v[226:227], v175 offset:26624
    v_mfma_f32_16x16x32_bf16 v[56:59], v[204:207], v[160:163], v[56:59]
    v_mfma_f32_16x16x32_bf16 v[64:67], v[208:211], v[160:163], v[64:67]
    v_mfma_f32_16x16x32_bf16 v[28:31], v[204:207], v[156:159], v[28:31]
    ds_read_b64_tr_b16 v[196:197], v175 offset:28672
    v_mfma_f32_16x16x32_bf16 v[36:39], v[208:211], v[156:159], v[36:39]
    ds_read_b64_tr_b16 v[198:199], v175 offset:30720
    buffer_load_dwordx4 v170, s[8:11], s75 offen offset:2048  lds
    v_mfma_f32_16x16x32_bf16 v[24:27], v[204:207], v[152:155], v[24:27]
    v_mfma_f32_16x16x32_bf16 v[32:35], v[208:211], v[152:155], v[32:35]
    v_mfma_f32_16x16x32_bf16 v[240:243], v[160:163], v[160:163], v[240:243]
    s_add_u32 m0, s40, 101376
    s_waitcnt lgkmcnt(8)
    v_mfma_f32_16x16x32_bf16 v[72:75], v[212:215], a[0:3], 0
    ds_read_b64_tr_b16 v[200:201], v175 offset:32768
    s_waitcnt lgkmcnt(8)
    v_mfma_f32_16x16x32_bf16 v[72:75], v[216:219], a[16:19], v[72:75]
    ds_read_b64_tr_b16 v[202:203], v175 offset:34816
    s_waitcnt lgkmcnt(7)
    v_mfma_f32_16x16x32_bf16 v[72:75], v[220:223], a[32:35], v[72:75]
    s_add_u32 s75, s41, 2875520
    v_mfma_f32_16x16x32_bf16 v[76:79], v[220:223], a[36:39], 0
    buffer_load_dwordx4 v168, s[8:11], s75 offen offset:0  lds
    v_mfma_f32_16x16x32_bf16 v[76:79], v[216:219], a[20:23], v[76:79]
    ds_read_b64_tr_b16 v[204:205], v172 offset:36864
    v_mfma_f32_16x16x32_bf16 v[76:79], v[212:215], a[4:7], v[76:79]
    ds_read_b64_tr_b16 v[206:207], v172 offset:38912
    v_cndmask_b32 v236, v236, v237, s[32:33]
    v_mfma_f32_16x16x32_bf16 v[104:107], v[212:215], a[8:11], 0
    v_cndmask_b32 v238, v238, v239, s[32:33]
    v_mfma_f32_16x16x32_bf16 v[104:107], v[216:219], a[24:27], v[104:107]
    v_mul_f32 v228, -0.001736111111111111, v228
    v_mfma_f32_16x16x32_bf16 v[104:107], v[220:223], a[40:43], v[104:107]
    ds_read_b64_tr_b16 v[208:209], v172 offset:40960
    v_cndmask_b32 v236, v236, v238, s[34:35]
    v_mfma_f32_16x16x32_bf16 v[108:111], v[220:223], a[44:47], 0
    ds_read_b64_tr_b16 v[210:211], v172 offset:43008
    v_mov_b32 v182, v228
    v_mfma_f32_16x16x32_bf16 v[108:111], v[216:219], a[28:31], v[108:111]
    v_mul_f32 v236, 0.001736111111111111, v236
    buffer_load_dwordx4 v169, s[8:11], s75 offen offset:1024  lds
    v_mfma_f32_16x16x32_bf16 v[108:111], v[212:215], a[12:15], v[108:111]
    v_fma_f32 v236, -v228, v228, v236
    s_waitcnt lgkmcnt(8)
    v_mfma_f32_16x16x32_bf16 v[116:119], v[224:227], a[12:15], 0
    ds_read_b64_tr_b16 v[212:213], v172 offset:45056
    v_max_f32 v236, 0, v236
    s_waitcnt lgkmcnt(7)
    v_mfma_f32_16x16x32_bf16 v[116:119], v[196:199], a[28:31], v[116:119]
    ds_read_b64_tr_b16 v[214:215], v172 offset:47104
    v_add_f32 v236, 0x3727c5ac, v236
    s_waitcnt lgkmcnt(6)
    v_mfma_f32_16x16x32_bf16 v[116:119], v[200:203], a[44:47], v[116:119]
    v_rcp_f32 v229, v236
    v_mfma_f32_16x16x32_bf16 v[112:115], v[200:203], a[40:43], 0
    v_cndmask_b32 v240, v240, v241, s[32:33]
    v_mfma_f32_16x16x32_bf16 v[112:115], v[196:199], a[24:27], v[112:115]
    ds_read_b64_tr_b16 v[216:217], v175 offset:36864
    v_cndmask_b32 v242, v242, v243, s[32:33]
    v_mfma_f32_16x16x32_bf16 v[112:115], v[224:227], a[8:11], v[112:115]
    ds_read_b64_tr_b16 v[218:219], v175 offset:38912
    v_mul_f32 v232, -0.001736111111111111, v232
    v_mfma_f32_16x16x32_bf16 v[84:87], v[224:227], a[4:7], 0
    v_cndmask_b32 v240, v240, v242, s[34:35]
    buffer_load_dwordx4 v170, s[8:11], s75 offen offset:2048  lds
    v_mfma_f32_16x16x32_bf16 v[84:87], v[196:199], a[20:23], v[84:87]
    v_mov_b32 v184, v232
    v_mfma_f32_16x16x32_bf16 v[84:87], v[200:203], a[36:39], v[84:87]
    ds_read_b64_tr_b16 v[220:221], v175 offset:40960
    v_mul_f32 v240, 0.001736111111111111, v240
    v_mfma_f32_16x16x32_bf16 v[80:83], v[200:203], a[32:35], 0
    ds_read_b64_tr_b16 v[222:223], v175 offset:43008
    v_fma_f32 v240, -v232, v232, v240
    v_mfma_f32_16x16x32_bf16 v[80:83], v[196:199], a[16:19], v[80:83]
    v_max_f32 v240, 0, v240
    v_mfma_f32_16x16x32_bf16 v[80:83], v[224:227], a[0:3], v[80:83]
    v_add_f32 v240, 0x3727c5ac, v240
    s_waitcnt lgkmcnt(8)
    v_mfma_f32_16x16x32_bf16 v[88:91], v[204:207], a[0:3], 0
    ds_read_b64_tr_b16 v[224:225], v175 offset:45056
    v_rcp_f32 v233, v240
    s_waitcnt lgkmcnt(7)
    v_mfma_f32_16x16x32_bf16 v[88:91], v[208:211], a[16:19], v[88:91]
    ds_read_b64_tr_b16 v[226:227], v175 offset:47104
    s_waitcnt lgkmcnt(6)
    v_mfma_f32_16x16x32_bf16 v[88:91], v[212:215], a[32:35], v[88:91]
    s_add_u32 m0, s40, 0
    s_add_u32 s75, s41, 3539072
    v_mfma_f32_16x16x32_bf16 v[92:95], v[212:215], a[36:39], 0
    ds_write_b64 v195, v[228:229] offset:0
    ds_write_b64 v195, v[232:233] offset:512
    v_mfma_f32_16x16x32_bf16 v[92:95], v[208:211], a[20:23], v[92:95]
    v_mfma_f32_16x16x32_bf16 v[92:95], v[204:207], a[4:7], v[92:95]
    v_mfma_f32_16x16x32_bf16 v[120:123], v[204:207], a[8:11], 0
    s_waitcnt vmcnt(15) lgkmcnt(0)
    s_barrier
    ds_read_b64_tr_b16 v[196:197], v171 offset:24576
    v_mfma_f32_16x16x32_bf16 v[120:123], v[208:211], a[24:27], v[120:123]
    ds_read_b64_tr_b16 v[198:199], v171 offset:26624
    buffer_load_dwordx4 v168, s[8:11], s75 offen offset:0  lds
    v_mfma_f32_16x16x32_bf16 v[120:123], v[212:215], a[40:43], v[120:123]
    ds_read_b64_tr_b16 v[200:201], v171 offset:28672
    ds_read_b32 v183, v255 offset:0
    v_mfma_f32_16x16x32_bf16 v[124:127], v[212:215], a[44:47], 0
    ds_read_b64_tr_b16 v[202:203], v171 offset:30720
    ds_read_b32 v185, v255 offset:512
    v_mfma_f32_16x16x32_bf16 v[124:127], v[208:211], a[28:31], v[124:127]
    buffer_load_dwordx4 v169, s[8:11], s75 offen offset:1024  lds
    v_mfma_f32_16x16x32_bf16 v[124:127], v[204:207], a[12:15], v[124:127]
    ds_read_b128 v[228:231], v180 offset:0
    ds_read_b128 v[232:235], v180 offset:64
    v_mfma_f32_16x16x32_bf16 v[132:135], v[216:219], a[12:15], 0
    ds_read_b64_tr_b16 v[204:205], v171 offset:32768
    ds_read_b128 v[236:239], v180 offset:1280
    v_mfma_f32_16x16x32_bf16 v[132:135], v[220:223], a[28:31], v[132:135]
    ds_read_b64_tr_b16 v[206:207], v171 offset:34816
    buffer_load_dwordx4 v170, s[8:11], s75 offen offset:2048  lds
    v_mfma_f32_16x16x32_bf16 v[132:135], v[224:227], a[44:47], v[132:135]
    s_add_u32 m0, s40, 3072
    s_add_u32 s75, s41, 3760256
    v_mfma_f32_16x16x32_bf16 v[128:131], v[224:227], a[40:43], 0
    ds_read_b128 v[240:243], v180 offset:1344
    s_waitcnt lgkmcnt(0)
    v_fmac_f32 v8, v182, v228
    v_mfma_f32_16x16x32_bf16 v[128:131], v[220:223], a[24:27], v[128:131]
    ds_read_b64_tr_b16 v[208:209], v174 offset:24576
    v_fmac_f32 v9, v182, v229
    v_mfma_f32_16x16x32_bf16 v[128:131], v[216:219], a[8:11], v[128:131]
    ds_read_b64_tr_b16 v[210:211], v174 offset:26624
    buffer_load_dwordx4 v168, s[8:11], s75 offen offset:0  lds
    v_mfma_f32_16x16x32_bf16 v[100:103], v[216:219], a[4:7], 0
    v_fmac_f32 v10, v182, v230
    v_fmac_f32 v11, v182, v231
    v_mfma_f32_16x16x32_bf16 v[100:103], v[220:223], a[20:23], v[100:103]
    v_fmac_f32 v16, v182, v232
    v_fmac_f32 v17, v182, v233
    v_mfma_f32_16x16x32_bf16 v[100:103], v[224:227], a[36:39], v[100:103]
    ds_read_b64_tr_b16 v[212:213], v174 offset:28672
    buffer_load_dwordx4 v169, s[8:11], s75 offen offset:1024  lds
    v_mfma_f32_16x16x32_bf16 v[96:99], v[224:227], a[32:35], 0
    ds_read_b64_tr_b16 v[214:215], v174 offset:30720
    v_fmac_f32 v18, v182, v234
    v_mfma_f32_16x16x32_bf16 v[96:99], v[220:223], a[16:19], v[96:99]
    v_fmac_f32 v19, v182, v235
    v_fmac_f32 v24, v182, v236
    v_mfma_f32_16x16x32_bf16 v[96:99], v[216:219], a[0:3], v[96:99]
    v_fmac_f32 v25, v182, v237
    v_fmac_f32 v26, v182, v238
    v_mfma_f32_16x16x32_bf16 v[72:75], v[196:199], a[48:51], v[72:75]
    ds_read_b64_tr_b16 v[216:217], v174 offset:32768
    buffer_load_dwordx4 v170, s[8:11], s75 offen offset:2048  lds
    v_mfma_f32_16x16x32_bf16 v[72:75], v[200:203], a[64:67], v[72:75]
    ds_read_b64_tr_b16 v[218:219], v174 offset:34816
    s_add_u32 m0, s40, 122880
    v_mfma_f32_16x16x32_bf16 v[72:75], v[204:207], a[80:83], v[72:75]
    s_add_u32 s75, s41, 4423808
    v_fmac_f32 v27, v182, v239
    v_mfma_f32_16x16x32_bf16 v[76:79], v[204:207], a[84:87], v[76:79]
    buffer_load_dwordx4 v168, s[8:11], s75 offen offset:0  lds
    v_fmac_f32 v32, v182, v240
    v_mfma_f32_16x16x32_bf16 v[76:79], v[200:203], a[68:71], v[76:79]
    ds_read_b64_tr_b16 v[220:221], v171 offset:36864
    v_fmac_f32 v33, v182, v241
    v_mfma_f32_16x16x32_bf16 v[76:79], v[196:199], a[52:55], v[76:79]
    ds_read_b64_tr_b16 v[222:223], v171 offset:38912
    v_fmac_f32 v34, v182, v242
    v_mfma_f32_16x16x32_bf16 v[104:107], v[196:199], a[56:59], v[104:107]
    v_fmac_f32 v35, v182, v243
    v_max_f32 v8, 0, v8
    v_mfma_f32_16x16x32_bf16 v[104:107], v[200:203], a[72:75], v[104:107]
    buffer_load_dwordx4 v169, s[8:11], s75 offen offset:1024  lds
    v_max_f32 v9, 0, v9
    v_mfma_f32_16x16x32_bf16 v[104:107], v[204:207], a[88:91], v[104:107]
    ds_read_b64_tr_b16 v[224:225], v171 offset:40960
    v_max_f32 v10, 0, v10
    v_mfma_f32_16x16x32_bf16 v[108:111], v[204:207], a[92:95], v[108:111]
    ds_read_b64_tr_b16 v[226:227], v171 offset:43008
    v_max_f32 v11, 0, v11
    v_mfma_f32_16x16x32_bf16 v[108:111], v[200:203], a[76:79], v[108:111]
    buffer_load_dwordx4 v170, s[8:11], s75 offen offset:2048  lds
    s_add_u32 m0, s40, 125952
    v_mfma_f32_16x16x32_bf16 v[108:111], v[196:199], a[60:63], v[108:111]
    s_add_u32 s75, s41, 4644992
    s_waitcnt lgkmcnt(8)
    v_mfma_f32_16x16x32_bf16 v[116:119], v[208:211], a[60:63], v[116:119]
    ds_read_b64_tr_b16 v[196:197], v171 offset:45056
    s_waitcnt lgkmcnt(7)
    v_mfma_f32_16x16x32_bf16 v[116:119], v[212:215], a[76:79], v[116:119]
    ds_read_b64_tr_b16 v[198:199], v171 offset:47104
    s_waitcnt lgkmcnt(6)
    v_mfma_f32_16x16x32_bf16 v[116:119], v[216:219], a[92:95], v[116:119]
    buffer_load_dwordx4 v168, s[8:11], s75 offen offset:0  lds
    v_max_f32 v16, 0, v16
    v_mfma_f32_16x16x32_bf16 v[112:115], v[216:219], a[88:91], v[112:115]
    v_max_f32 v17, 0, v17
    v_max_f32 v18, 0, v18
    v_mfma_f32_16x16x32_bf16 v[112:115], v[212:215], a[72:75], v[112:115]
    ds_read_b64_tr_b16 v[200:201], v174 offset:36864
    v_max_f32 v19, 0, v19
    v_mfma_f32_16x16x32_bf16 v[112:115], v[208:211], a[56:59], v[112:115]
    ds_read_b64_tr_b16 v[202:203], v174 offset:38912
    buffer_load_dwordx4 v169, s[8:11], s75 offen offset:1024  lds
    v_mfma_f32_16x16x32_bf16 v[84:87], v[208:211], a[52:55], v[84:87]
    v_mul_f32 v8, v8, v24
    v_mul_f32 v9, v9, v25
    v_mfma_f32_16x16x32_bf16 v[84:87], v[212:215], a[68:71], v[84:87]
    v_mul_f32 v10, v10, v26
    v_mul_f32 v11, v11, v27
    v_mfma_f32_16x16x32_bf16 v[84:87], v[216:219], a[84:87], v[84:87]
    ds_read_b64_tr_b16 v[204:205], v174 offset:40960
    v_mul_f32 v16, v16, v32
    v_mfma_f32_16x16x32_bf16 v[80:83], v[216:219], a[80:83], v[80:83]
    ds_read_b64_tr_b16 v[206:207], v174 offset:43008
    buffer_load_dwordx4 v170, s[8:11], s75 offen offset:2048  lds
    v_mfma_f32_16x16x32_bf16 v[80:83], v[212:215], a[64:67], v[80:83]
    v_mul_f32 v17, v17, v33
    v_mul_f32 v18, v18, v34
    v_mfma_f32_16x16x32_bf16 v[80:83], v[208:211], a[48:51], v[80:83]
    v_mul_f32 v19, v19, v35
    s_waitcnt lgkmcnt(8)
    v_mfma_f32_16x16x32_bf16 v[88:91], v[220:223], a[48:51], v[88:91]
    ds_read_b64_tr_b16 v[208:209], v174 offset:45056
    s_waitcnt lgkmcnt(7)
    v_mfma_f32_16x16x32_bf16 v[88:91], v[224:227], a[64:67], v[88:91]
    ds_read_b64_tr_b16 v[210:211], v174 offset:47104
    s_waitcnt lgkmcnt(6)
    v_mfma_f32_16x16x32_bf16 v[88:91], v[196:199], a[80:83], v[88:91]
    s_add_u32 m0, s40, 73728
    s_add_u32 s75, s42, 0
    v_mfma_f32_16x16x32_bf16 v[92:95], v[196:199], a[84:87], v[92:95]
    v_cvt_pk_bf16_f32 v244, v8, v9
    v_cvt_pk_bf16_f32 v245, v10, v11
    v_mfma_f32_16x16x32_bf16 v[92:95], v[224:227], a[68:71], v[92:95]
    v_cvt_pk_bf16_f32 v246, v16, v17
    v_cvt_pk_bf16_f32 v247, v18, v19
    v_mfma_f32_16x16x32_bf16 v[92:95], v[220:223], a[52:55], v[92:95]
    buffer_store_dwordx4 v[244:247], v3, s[24:27], s50 offen offset:0 sc1
    v_fmac_f32 v12, v183, v228
    v_mfma_f32_16x16x32_bf16 v[120:123], v[220:223], a[56:59], v[120:123]
    s_waitcnt vmcnt(22)
    s_barrier
    ds_read_b64_tr_b16 v[212:213], v172 offset:0
    v_mfma_f32_16x16x32_bf16 v[120:123], v[224:227], a[72:75], v[120:123]
    ds_read_b64_tr_b16 v[214:215], v172 offset:2048
    buffer_load_dwordx4 v252, s[8:11], s75 offen offset:0  lds
    v_mfma_f32_16x16x32_bf16 v[120:123], v[196:199], a[88:91], v[120:123]
    ds_read_b64_tr_b16 v[216:217], v172 offset:4096
    v_fmac_f32 v13, v183, v229
    v_mfma_f32_16x16x32_bf16 v[124:127], v[196:199], a[92:95], v[124:127]
    ds_read_b64_tr_b16 v[218:219], v172 offset:6144
    v_fmac_f32 v14, v183, v230
    v_mfma_f32_16x16x32_bf16 v[124:127], v[224:227], a[76:79], v[124:127]
    v_fmac_f32 v15, v183, v231
    v_fmac_f32 v20, v183, v232
    v_mfma_f32_16x16x32_bf16 v[124:127], v[220:223], a[60:63], v[124:127]
    v_fmac_f32 v21, v183, v233
    s_waitcnt lgkmcnt(8)
    v_mfma_f32_16x16x32_bf16 v[132:135], v[200:203], a[60:63], v[132:135]
    ds_read_b64_tr_b16 v[220:221], v172 offset:8192
    s_waitcnt lgkmcnt(7)
    v_mfma_f32_16x16x32_bf16 v[132:135], v[204:207], a[76:79], v[132:135]
    ds_read_b64_tr_b16 v[222:223], v172 offset:10240
    s_waitcnt lgkmcnt(6)
    v_mfma_f32_16x16x32_bf16 v[132:135], v[208:211], a[92:95], v[132:135]
    buffer_load_dwordx4 v253, s[8:11], s75 offen offset:1024  lds
    v_fmac_f32 v22, v183, v234
    v_mfma_f32_16x16x32_bf16 v[128:131], v[208:211], a[88:91], v[128:131]
    v_fmac_f32 v23, v183, v235
    v_fmac_f32 v28, v183, v236
    v_mfma_f32_16x16x32_bf16 v[128:131], v[204:207], a[72:75], v[128:131]
    ds_read_b64_tr_b16 v[224:225], v175 offset:0
    v_fmac_f32 v29, v183, v237
    v_mfma_f32_16x16x32_bf16 v[128:131], v[200:203], a[56:59], v[128:131]
    ds_read_b64_tr_b16 v[226:227], v175 offset:2048
    v_fmac_f32 v30, v183, v238
    v_mfma_f32_16x16x32_bf16 v[100:103], v[200:203], a[52:55], v[100:103]
    s_waitcnt vmcnt(20)
    s_mov_b64 exec, 1
    v_mov_b32 v192, s3
    buffer_store_dword v192, v4, s[24:27], s19 offen sc1
    s_mov_b64 exec, -1
    v_mfma_f32_16x16x32_bf16 v[100:103], v[204:207], a[68:71], v[100:103]
    v_fmac_f32 v31, v183, v239
    v_fmac_f32 v36, v183, v240
    v_mfma_f32_16x16x32_bf16 v[100:103], v[208:211], a[84:87], v[100:103]
    ds_read_b64_tr_b16 v[196:197], v175 offset:4096
    buffer_load_dwordx4 v254, s[8:11], s75 offen offset:2048  lds
    v_mfma_f32_16x16x32_bf16 v[96:99], v[208:211], a[80:83], v[96:99]
    ds_read_b64_tr_b16 v[198:199], v175 offset:6144
    v_fmac_f32 v37, v183, v241
    v_mfma_f32_16x16x32_bf16 v[96:99], v[204:207], a[64:67], v[96:99]
    v_fmac_f32 v38, v183, v242
    v_fmac_f32 v39, v183, v243
    v_mfma_f32_16x16x32_bf16 v[96:99], v[200:203], a[48:51], v[96:99]
    s_add_u32 m0, s40, 76800
    s_waitcnt lgkmcnt(8)
    v_mfma_f32_16x16x32_bf16 v[72:75], v[212:215], a[96:99], v[72:75]
    ds_read_b64_tr_b16 v[200:201], v175 offset:8192
    s_waitcnt lgkmcnt(7)
    v_mfma_f32_16x16x32_bf16 v[72:75], v[216:219], a[112:115], v[72:75]
    ds_read_b64_tr_b16 v[202:203], v175 offset:10240
    s_waitcnt lgkmcnt(6)
    v_mfma_f32_16x16x32_bf16 v[72:75], v[220:223], a[128:131], v[72:75]
    s_add_u32 s75, s42, 442368
    v_max_f32 v12, 0, v12
    v_mfma_f32_16x16x32_bf16 v[76:79], v[220:223], a[132:135], v[76:79]
    buffer_load_dwordx4 v252, s[8:11], s75 offen offset:0  lds
    v_max_f32 v13, 0, v13
    v_mfma_f32_16x16x32_bf16 v[76:79], v[216:219], a[116:119], v[76:79]
    ds_read_b64_tr_b16 v[204:205], v172 offset:12288
    v_max_f32 v14, 0, v14
    v_mfma_f32_16x16x32_bf16 v[76:79], v[212:215], a[100:103], v[76:79]
    ds_read_b64_tr_b16 v[206:207], v172 offset:14336
    v_max_f32 v15, 0, v15
    v_mfma_f32_16x16x32_bf16 v[104:107], v[212:215], a[104:107], v[104:107]
    v_max_f32 v20, 0, v20
    v_max_f32 v21, 0, v21
    v_mfma_f32_16x16x32_bf16 v[104:107], v[216:219], a[120:123], v[104:107]
    v_max_f32 v22, 0, v22
    v_max_f32 v23, 0, v23
    v_mfma_f32_16x16x32_bf16 v[104:107], v[220:223], a[136:139], v[104:107]
    ds_read_b64_tr_b16 v[208:209], v172 offset:16384
    v_mul_f32 v12, v12, v28
    v_mfma_f32_16x16x32_bf16 v[108:111], v[220:223], a[140:143], v[108:111]
    ds_read_b64_tr_b16 v[210:211], v172 offset:18432
    v_mul_f32 v13, v13, v29
    v_mfma_f32_16x16x32_bf16 v[108:111], v[216:219], a[124:127], v[108:111]
    buffer_load_dwordx4 v253, s[8:11], s75 offen offset:1024  lds
    v_mul_f32 v14, v14, v30
    v_mfma_f32_16x16x32_bf16 v[108:111], v[212:215], a[108:111], v[108:111]
    v_mul_f32 v15, v15, v31
    s_waitcnt lgkmcnt(8)
    v_mfma_f32_16x16x32_bf16 v[116:119], v[224:227], a[108:111], v[116:119]
    ds_read_b64_tr_b16 v[212:213], v172 offset:20480
    s_waitcnt lgkmcnt(7)
    v_mfma_f32_16x16x32_bf16 v[116:119], v[196:199], a[124:127], v[116:119]
    ds_read_b64_tr_b16 v[214:215], v172 offset:22528
    s_waitcnt lgkmcnt(6)
    v_mfma_f32_16x16x32_bf16 v[116:119], v[200:203], a[140:143], v[116:119]
    v_mul_f32 v20, v20, v36
    v_mul_f32 v21, v21, v37
    v_mfma_f32_16x16x32_bf16 v[112:115], v[200:203], a[136:139], v[112:115]
    v_mul_f32 v22, v22, v38
    v_mul_f32 v23, v23, v39
    v_mfma_f32_16x16x32_bf16 v[112:115], v[196:199], a[120:123], v[112:115]
    ds_read_b64_tr_b16 v[216:217], v175 offset:12288
    v_cvt_pk_bf16_f32 v248, v12, v13
    v_mfma_f32_16x16x32_bf16 v[112:115], v[224:227], a[104:107], v[112:115]
    ds_read_b64_tr_b16 v[218:219], v175 offset:14336
    buffer_load_dwordx4 v254, s[8:11], s75 offen offset:2048  lds
    v_mfma_f32_16x16x32_bf16 v[84:87], v[224:227], a[100:103], v[84:87]
    v_cvt_pk_bf16_f32 v249, v14, v15
    v_cvt_pk_bf16_f32 v250, v20, v21
    v_mfma_f32_16x16x32_bf16 v[84:87], v[196:199], a[116:119], v[84:87]
    v_cvt_pk_bf16_f32 v251, v22, v23
    buffer_store_dwordx4 v[248:251], v3, s[24:27], s51 offen offset:0 sc1
    v_mfma_f32_16x16x32_bf16 v[84:87], v[200:203], a[132:135], v[84:87]
    ds_read_b64_tr_b16 v[220:221], v175 offset:16384
    v_fmac_f32 v40, v184, v228
    v_mfma_f32_16x16x32_bf16 v[80:83], v[200:203], a[128:131], v[80:83]
    ds_read_b64_tr_b16 v[222:223], v175 offset:18432
    v_fmac_f32 v41, v184, v229
    v_mfma_f32_16x16x32_bf16 v[80:83], v[196:199], a[112:115], v[80:83]
    v_fmac_f32 v42, v184, v230
    v_fmac_f32 v43, v184, v231
    v_mfma_f32_16x16x32_bf16 v[80:83], v[224:227], a[96:99], v[80:83]
    v_fmac_f32 v48, v184, v232
    s_waitcnt lgkmcnt(8)
    v_mfma_f32_16x16x32_bf16 v[88:91], v[204:207], a[96:99], v[88:91]
    ds_read_b64_tr_b16 v[224:225], v175 offset:20480
    s_waitcnt lgkmcnt(7)
    v_mfma_f32_16x16x32_bf16 v[88:91], v[208:211], a[112:115], v[88:91]
    ds_read_b64_tr_b16 v[226:227], v175 offset:22528
    s_waitcnt lgkmcnt(6)
    v_mfma_f32_16x16x32_bf16 v[88:91], v[212:215], a[128:131], v[88:91]
    s_add_u32 m0, s40, 24576
    s_add_u32 s75, s42, 1769472
    v_mfma_f32_16x16x32_bf16 v[92:95], v[212:215], a[132:135], v[92:95]
    v_fmac_f32 v49, v184, v233
    v_fmac_f32 v50, v184, v234
    v_mfma_f32_16x16x32_bf16 v[92:95], v[208:211], a[116:119], v[92:95]
    v_fmac_f32 v51, v184, v235
    v_fmac_f32 v56, v184, v236
    v_mfma_f32_16x16x32_bf16 v[92:95], v[204:207], a[100:103], v[92:95]
    v_fmac_f32 v57, v184, v237
    v_fmac_f32 v58, v184, v238
    v_mfma_f32_16x16x32_bf16 v[120:123], v[204:207], a[104:107], v[120:123]
    s_waitcnt vmcnt(21)
    s_barrier
    ds_read_b64_tr_b16 v[196:197], v173 offset:0
    v_mfma_f32_16x16x32_bf16 v[120:123], v[208:211], a[120:123], v[120:123]
    ds_read_b64_tr_b16 v[198:199], v173 offset:2048
    buffer_load_dwordx4 v252, s[8:11], s75 offen offset:0  lds
    v_mfma_f32_16x16x32_bf16 v[120:123], v[212:215], a[136:139], v[120:123]
    ds_read_b64_tr_b16 v[200:201], v173 offset:4096
    v_fmac_f32 v59, v184, v239
    v_mfma_f32_16x16x32_bf16 v[124:127], v[212:215], a[140:143], v[124:127]
    ds_read_b64_tr_b16 v[202:203], v173 offset:6144
    v_fmac_f32 v64, v184, v240
    v_mfma_f32_16x16x32_bf16 v[124:127], v[208:211], a[124:127], v[124:127]
    v_fmac_f32 v65, v184, v241
    v_fmac_f32 v66, v184, v242
    v_mfma_f32_16x16x32_bf16 v[124:127], v[204:207], a[108:111], v[124:127]
    v_fmac_f32 v67, v184, v243
    s_waitcnt lgkmcnt(8)
    v_mfma_f32_16x16x32_bf16 v[132:135], v[216:219], a[108:111], v[132:135]
    ds_read_b64_tr_b16 v[204:205], v173 offset:8192
    s_waitcnt lgkmcnt(7)
    v_mfma_f32_16x16x32_bf16 v[132:135], v[220:223], a[124:127], v[132:135]
    ds_read_b64_tr_b16 v[206:207], v173 offset:10240
    s_waitcnt lgkmcnt(6)
    v_mfma_f32_16x16x32_bf16 v[132:135], v[224:227], a[140:143], v[132:135]
    buffer_load_dwordx4 v253, s[8:11], s75 offen offset:1024  lds
    v_max_f32 v40, 0, v40
    v_mfma_f32_16x16x32_bf16 v[128:131], v[224:227], a[136:139], v[128:131]
    v_max_f32 v41, 0, v41
    v_max_f32 v42, 0, v42
    v_mfma_f32_16x16x32_bf16 v[128:131], v[220:223], a[120:123], v[128:131]
    ds_read_b64_tr_b16 v[208:209], v176 offset:0
    v_max_f32 v43, 0, v43
    v_mfma_f32_16x16x32_bf16 v[128:131], v[216:219], a[104:107], v[128:131]
    ds_read_b64_tr_b16 v[210:211], v176 offset:2048
    v_max_f32 v48, 0, v48
    v_mfma_f32_16x16x32_bf16 v[100:103], v[216:219], a[100:103], v[100:103]
    v_max_f32 v49, 0, v49
    v_max_f32 v50, 0, v50
    v_mfma_f32_16x16x32_bf16 v[100:103], v[220:223], a[116:119], v[100:103]
    v_max_f32 v51, 0, v51
    v_mul_f32 v40, v40, v56
    v_mfma_f32_16x16x32_bf16 v[100:103], v[224:227], a[132:135], v[100:103]
    ds_read_b64_tr_b16 v[212:213], v176 offset:4096
    buffer_load_dwordx4 v254, s[8:11], s75 offen offset:2048  lds
    v_mfma_f32_16x16x32_bf16 v[96:99], v[224:227], a[128:131], v[96:99]
    ds_read_b64_tr_b16 v[214:215], v176 offset:6144
    v_mul_f32 v41, v41, v57
    v_mfma_f32_16x16x32_bf16 v[96:99], v[220:223], a[112:115], v[96:99]
    v_mul_f32 v42, v42, v58
    v_mul_f32 v43, v43, v59
    v_mfma_f32_16x16x32_bf16 v[96:99], v[216:219], a[96:99], v[96:99]
    s_add_u32 m0, s40, 27648
    s_waitcnt lgkmcnt(8)
    v_mfma_f32_16x16x32_bf16 v[72:75], v[196:199], a[144:147], v[72:75]
    ds_read_b64_tr_b16 v[216:217], v176 offset:8192
    s_waitcnt lgkmcnt(7)
    v_mfma_f32_16x16x32_bf16 v[72:75], v[200:203], a[160:163], v[72:75]
    ds_read_b64_tr_b16 v[218:219], v176 offset:10240
    s_waitcnt lgkmcnt(6)
    v_mfma_f32_16x16x32_bf16 v[72:75], v[204:207], a[176:179], v[72:75]
    s_add_u32 s75, s42, 2211840
    v_mul_f32 v48, v48, v64
    v_mfma_f32_16x16x32_bf16 v[76:79], v[204:207], a[180:183], v[76:79]
    buffer_load_dwordx4 v252, s[8:11], s75 offen offset:0  lds
    v_mul_f32 v49, v49, v65
    v_mfma_f32_16x16x32_bf16 v[76:79], v[200:203], a[164:167], v[76:79]
    ds_read_b64_tr_b16 v[220:221], v173 offset:12288
    v_mul_f32 v50, v50, v66
    v_mfma_f32_16x16x32_bf16 v[76:79], v[196:199], a[148:151], v[76:79]
    ds_read_b64_tr_b16 v[222:223], v173 offset:14336
    v_mul_f32 v51, v51, v67
    v_mfma_f32_16x16x32_bf16 v[104:107], v[196:199], a[152:155], v[104:107]
    v_cvt_pk_bf16_f32 v244, v40, v41
    v_cvt_pk_bf16_f32 v245, v42, v43
    v_mfma_f32_16x16x32_bf16 v[104:107], v[200:203], a[168:171], v[104:107]
    v_cvt_pk_bf16_f32 v246, v48, v49
    v_cvt_pk_bf16_f32 v247, v50, v51
    v_mfma_f32_16x16x32_bf16 v[104:107], v[204:207], a[184:187], v[104:107]
    ds_read_b64_tr_b16 v[224:225], v173 offset:16384
    buffer_store_dwordx4 v[244:247], v3, s[24:27], s52 offen offset:0 sc1
    v_mfma_f32_16x16x32_bf16 v[108:111], v[204:207], a[188:191], v[108:111]
    ds_read_b64_tr_b16 v[226:227], v173 offset:18432
    v_fmac_f32 v44, v185, v228
    v_mfma_f32_16x16x32_bf16 v[108:111], v[200:203], a[172:175], v[108:111]
    buffer_load_dwordx4 v253, s[8:11], s75 offen offset:1024  lds
    v_fmac_f32 v45, v185, v229
    v_mfma_f32_16x16x32_bf16 v[108:111], v[196:199], a[156:159], v[108:111]
    v_fmac_f32 v46, v185, v230
    s_waitcnt lgkmcnt(8)
    v_mfma_f32_16x16x32_bf16 v[116:119], v[208:211], a[156:159], v[116:119]
    ds_read_b64_tr_b16 v[196:197], v173 offset:20480
    s_waitcnt lgkmcnt(7)
    v_mfma_f32_16x16x32_bf16 v[116:119], v[212:215], a[172:175], v[116:119]
    ds_read_b64_tr_b16 v[198:199], v173 offset:22528
    s_waitcnt lgkmcnt(6)
    v_mfma_f32_16x16x32_bf16 v[116:119], v[216:219], a[188:191], v[116:119]
    v_fmac_f32 v47, v185, v231
    v_fmac_f32 v52, v185, v232
    v_mfma_f32_16x16x32_bf16 v[112:115], v[216:219], a[184:187], v[112:115]
    v_fmac_f32 v53, v185, v233
    v_fmac_f32 v54, v185, v234
    v_mfma_f32_16x16x32_bf16 v[112:115], v[212:215], a[168:171], v[112:115]
    ds_read_b64_tr_b16 v[200:201], v176 offset:12288
    v_fmac_f32 v55, v185, v235
    v_mfma_f32_16x16x32_bf16 v[112:115], v[208:211], a[152:155], v[112:115]
    ds_read_b64_tr_b16 v[202:203], v176 offset:14336
    buffer_load_dwordx4 v254, s[8:11], s75 offen offset:2048  lds
    v_mfma_f32_16x16x32_bf16 v[84:87], v[208:211], a[148:151], v[84:87]
    v_fmac_f32 v60, v185, v236
    v_fmac_f32 v61, v185, v237
    v_mfma_f32_16x16x32_bf16 v[84:87], v[212:215], a[164:167], v[84:87]
    v_fmac_f32 v62, v185, v238
    v_fmac_f32 v63, v185, v239
    v_mfma_f32_16x16x32_bf16 v[84:87], v[216:219], a[180:183], v[84:87]
    ds_read_b64_tr_b16 v[204:205], v176 offset:16384
    v_fmac_f32 v68, v185, v240
    v_mfma_f32_16x16x32_bf16 v[80:83], v[216:219], a[176:179], v[80:83]
    ds_read_b64_tr_b16 v[206:207], v176 offset:18432
    v_fmac_f32 v69, v185, v241
    v_mfma_f32_16x16x32_bf16 v[80:83], v[212:215], a[160:163], v[80:83]
    v_fmac_f32 v70, v185, v242
    v_fmac_f32 v71, v185, v243
    v_mfma_f32_16x16x32_bf16 v[80:83], v[208:211], a[144:147], v[80:83]
    v_max_f32 v44, 0, v44
    s_waitcnt lgkmcnt(8)
    v_mfma_f32_16x16x32_bf16 v[88:91], v[220:223], a[144:147], v[88:91]
    ds_read_b64_tr_b16 v[208:209], v176 offset:20480
    s_waitcnt lgkmcnt(7)
    v_mfma_f32_16x16x32_bf16 v[88:91], v[224:227], a[160:163], v[88:91]
    ds_read_b64_tr_b16 v[210:211], v176 offset:22528
    s_waitcnt lgkmcnt(6)
    v_mfma_f32_16x16x32_bf16 v[88:91], v[196:199], a[176:179], v[88:91]
    s_add_u32 m0, s40, 49152
    s_add_u32 s75, s42, 3538944
    v_mfma_f32_16x16x32_bf16 v[92:95], v[196:199], a[180:183], v[92:95]
    v_max_f32 v45, 0, v45
    v_max_f32 v46, 0, v46
    v_mfma_f32_16x16x32_bf16 v[92:95], v[224:227], a[164:167], v[92:95]
    v_max_f32 v47, 0, v47
    v_max_f32 v52, 0, v52
    v_mfma_f32_16x16x32_bf16 v[92:95], v[220:223], a[148:151], v[92:95]
    v_max_f32 v53, 0, v53
    v_max_f32 v54, 0, v54
    v_mfma_f32_16x16x32_bf16 v[120:123], v[220:223], a[152:155], v[120:123]
    s_waitcnt vmcnt(22)
    s_barrier
    ds_read_b64_tr_b16 v[212:213], v171 offset:0
    v_mfma_f32_16x16x32_bf16 v[120:123], v[224:227], a[168:171], v[120:123]
    ds_read_b64_tr_b16 v[214:215], v171 offset:2048
    buffer_load_dwordx4 v252, s[8:11], s75 offen offset:0  lds
    v_mfma_f32_16x16x32_bf16 v[120:123], v[196:199], a[184:187], v[120:123]
    ds_read_b64_tr_b16 v[216:217], v171 offset:4096
    v_max_f32 v55, 0, v55
    v_mfma_f32_16x16x32_bf16 v[124:127], v[196:199], a[188:191], v[124:127]
    ds_read_b64_tr_b16 v[218:219], v171 offset:6144
    v_mul_f32 v44, v44, v60
    v_mfma_f32_16x16x32_bf16 v[124:127], v[224:227], a[172:175], v[124:127]
    v_mul_f32 v45, v45, v61
    v_mul_f32 v46, v46, v62
    v_mfma_f32_16x16x32_bf16 v[124:127], v[220:223], a[156:159], v[124:127]
    v_mul_f32 v47, v47, v63
    s_waitcnt lgkmcnt(8)
    v_mfma_f32_16x16x32_bf16 v[132:135], v[200:203], a[156:159], v[132:135]
    ds_read_b64_tr_b16 v[220:221], v171 offset:8192
    s_waitcnt lgkmcnt(7)
    v_mfma_f32_16x16x32_bf16 v[132:135], v[204:207], a[172:175], v[132:135]
    ds_read_b64_tr_b16 v[222:223], v171 offset:10240
    s_waitcnt lgkmcnt(6)
    v_mfma_f32_16x16x32_bf16 v[132:135], v[208:211], a[188:191], v[132:135]
    buffer_load_dwordx4 v253, s[8:11], s75 offen offset:1024  lds
    v_mul_f32 v52, v52, v68
    v_mfma_f32_16x16x32_bf16 v[128:131], v[208:211], a[184:187], v[128:131]
    v_mul_f32 v53, v53, v69
    v_mul_f32 v54, v54, v70
    v_mfma_f32_16x16x32_bf16 v[128:131], v[204:207], a[168:171], v[128:131]
    ds_read_b64_tr_b16 v[224:225], v174 offset:0
    v_mul_f32 v55, v55, v71
    v_mfma_f32_16x16x32_bf16 v[128:131], v[200:203], a[152:155], v[128:131]
    ds_read_b64_tr_b16 v[226:227], v174 offset:2048
    v_cvt_pk_bf16_f32 v248, v44, v45
    v_mfma_f32_16x16x32_bf16 v[100:103], v[200:203], a[148:151], v[100:103]
    v_cvt_pk_bf16_f32 v249, v46, v47
    v_cvt_pk_bf16_f32 v250, v52, v53
    v_mfma_f32_16x16x32_bf16 v[100:103], v[204:207], a[164:167], v[100:103]
    v_cvt_pk_bf16_f32 v251, v54, v55
    buffer_store_dwordx4 v[248:251], v3, s[24:27], s53 offen offset:0 sc1
    v_mfma_f32_16x16x32_bf16 v[100:103], v[208:211], a[180:183], v[100:103]
    ds_read_b64_tr_b16 v[196:197], v174 offset:4096
    buffer_load_dwordx4 v254, s[8:11], s75 offen offset:2048  lds
    v_mfma_f32_16x16x32_bf16 v[96:99], v[208:211], a[176:179], v[96:99]
    ds_read_b64_tr_b16 v[198:199], v174 offset:6144
    v_mfma_f32_16x16x32_bf16 v[96:99], v[204:207], a[160:163], v[96:99]
    v_mfma_f32_16x16x32_bf16 v[96:99], v[200:203], a[144:147], v[96:99]
    s_add_u32 m0, s40, 52224
    s_waitcnt lgkmcnt(8)
    v_mfma_f32_16x16x32_bf16 v[72:75], v[212:215], a[192:195], v[72:75]
    ds_read_b64_tr_b16 v[200:201], v174 offset:8192
    s_waitcnt lgkmcnt(7)
    v_mfma_f32_16x16x32_bf16 v[72:75], v[216:219], a[208:211], v[72:75]
    ds_read_b64_tr_b16 v[202:203], v174 offset:10240
    s_waitcnt lgkmcnt(6)
    v_mfma_f32_16x16x32_bf16 v[72:75], v[220:223], a[224:227], v[72:75]
    s_add_u32 s75, s42, 3981312
    v_mfma_f32_16x16x32_bf16 v[76:79], v[220:223], a[228:231], v[76:79]
    buffer_load_dwordx4 v252, s[8:11], s75 offen offset:0  lds
    v_mfma_f32_16x16x32_bf16 v[76:79], v[216:219], a[212:215], v[76:79]
    ds_read_b64_tr_b16 v[204:205], v171 offset:12288
    v_mfma_f32_16x16x32_bf16 v[76:79], v[212:215], a[196:199], v[76:79]
    ds_read_b64_tr_b16 v[206:207], v171 offset:14336
    v_mfma_f32_16x16x32_bf16 v[104:107], v[212:215], a[200:203], v[104:107]
    v_mfma_f32_16x16x32_bf16 v[104:107], v[216:219], a[216:219], v[104:107]
    v_mfma_f32_16x16x32_bf16 v[104:107], v[220:223], a[232:235], v[104:107]
    ds_read_b64_tr_b16 v[208:209], v171 offset:16384
    v_mfma_f32_16x16x32_bf16 v[108:111], v[220:223], a[236:239], v[108:111]
    ds_read_b64_tr_b16 v[210:211], v171 offset:18432
    v_mfma_f32_16x16x32_bf16 v[108:111], v[216:219], a[220:223], v[108:111]
    buffer_load_dwordx4 v253, s[8:11], s75 offen offset:1024  lds
    v_mfma_f32_16x16x32_bf16 v[108:111], v[212:215], a[204:207], v[108:111]
    s_waitcnt lgkmcnt(8)
    v_mfma_f32_16x16x32_bf16 v[116:119], v[224:227], a[204:207], v[116:119]
    ds_read_b64_tr_b16 v[212:213], v171 offset:20480
    s_waitcnt lgkmcnt(7)
    v_mfma_f32_16x16x32_bf16 v[116:119], v[196:199], a[220:223], v[116:119]
    ds_read_b64_tr_b16 v[214:215], v171 offset:22528
    s_waitcnt lgkmcnt(6)
    v_mfma_f32_16x16x32_bf16 v[116:119], v[200:203], a[236:239], v[116:119]
    v_mfma_f32_16x16x32_bf16 v[112:115], v[200:203], a[232:235], v[112:115]
    v_mfma_f32_16x16x32_bf16 v[112:115], v[196:199], a[216:219], v[112:115]
    ds_read_b64_tr_b16 v[216:217], v174 offset:12288
    v_mfma_f32_16x16x32_bf16 v[112:115], v[224:227], a[200:203], v[112:115]
    ds_read_b64_tr_b16 v[218:219], v174 offset:14336
    buffer_load_dwordx4 v254, s[8:11], s75 offen offset:2048  lds
    v_mfma_f32_16x16x32_bf16 v[84:87], v[224:227], a[196:199], v[84:87]
    v_mfma_f32_16x16x32_bf16 v[84:87], v[196:199], a[212:215], v[84:87]
    v_mfma_f32_16x16x32_bf16 v[84:87], v[200:203], a[228:231], v[84:87]
    ds_read_b64_tr_b16 v[220:221], v174 offset:16384
    v_mfma_f32_16x16x32_bf16 v[80:83], v[200:203], a[224:227], v[80:83]
    ds_read_b64_tr_b16 v[222:223], v174 offset:18432
    v_mfma_f32_16x16x32_bf16 v[80:83], v[196:199], a[208:211], v[80:83]
    v_mfma_f32_16x16x32_bf16 v[80:83], v[224:227], a[192:195], v[80:83]
    s_waitcnt lgkmcnt(8)
    v_mfma_f32_16x16x32_bf16 v[88:91], v[204:207], a[192:195], v[88:91]
    ds_read_b64_tr_b16 v[224:225], v174 offset:20480
    s_waitcnt lgkmcnt(7)
    v_mfma_f32_16x16x32_bf16 v[88:91], v[208:211], a[208:211], v[88:91]
    ds_read_b64_tr_b16 v[226:227], v174 offset:22528
    s_waitcnt lgkmcnt(6)
    v_mfma_f32_16x16x32_bf16 v[88:91], v[212:215], a[224:227], v[88:91]
    s_add_u32 m0, s40, 98304
    s_add_u32 s75, s41, 256
    v_mfma_f32_16x16x32_bf16 v[92:95], v[212:215], a[228:231], v[92:95]
    v_mfma_f32_16x16x32_bf16 v[92:95], v[208:211], a[212:215], v[92:95]
    v_mfma_f32_16x16x32_bf16 v[92:95], v[204:207], a[196:199], v[92:95]
    v_mfma_f32_16x16x32_bf16 v[120:123], v[204:207], a[200:203], v[120:123]
    s_waitcnt vmcnt(23)
    s_barrier
    ds_read_b64_tr_b16 v[196:197], v173 offset:24576
    v_mfma_f32_16x16x32_bf16 v[120:123], v[208:211], a[216:219], v[120:123]
    ds_read_b64_tr_b16 v[198:199], v173 offset:26624
    buffer_load_dwordx4 v168, s[8:11], s75 offen offset:0  lds
    v_mfma_f32_16x16x32_bf16 v[120:123], v[212:215], a[232:235], v[120:123]
    ds_read_b64_tr_b16 v[200:201], v173 offset:28672
    v_mfma_f32_16x16x32_bf16 v[124:127], v[212:215], a[236:239], v[124:127]
    ds_read_b64_tr_b16 v[202:203], v173 offset:30720
    v_mfma_f32_16x16x32_bf16 v[124:127], v[208:211], a[220:223], v[124:127]
    v_mfma_f32_16x16x32_bf16 v[124:127], v[204:207], a[204:207], v[124:127]
    s_waitcnt lgkmcnt(8)
    v_mfma_f32_16x16x32_bf16 v[132:135], v[216:219], a[204:207], v[132:135]
    ds_read_b64_tr_b16 v[204:205], v173 offset:32768
    s_waitcnt lgkmcnt(7)
    v_mfma_f32_16x16x32_bf16 v[132:135], v[220:223], a[220:223], v[132:135]
    ds_read_b64_tr_b16 v[206:207], v173 offset:34816
    s_waitcnt lgkmcnt(6)
    v_mfma_f32_16x16x32_bf16 v[132:135], v[224:227], a[236:239], v[132:135]
    buffer_load_dwordx4 v169, s[8:11], s75 offen offset:1024  lds
    v_mfma_f32_16x16x32_bf16 v[128:131], v[224:227], a[232:235], v[128:131]
    v_mfma_f32_16x16x32_bf16 v[128:131], v[220:223], a[216:219], v[128:131]
    ds_read_b64_tr_b16 v[208:209], v176 offset:24576
    v_mfma_f32_16x16x32_bf16 v[128:131], v[216:219], a[200:203], v[128:131]
    ds_read_b64_tr_b16 v[210:211], v176 offset:26624
    v_mfma_f32_16x16x32_bf16 v[100:103], v[216:219], a[196:199], v[100:103]
    v_mfma_f32_16x16x32_bf16 v[100:103], v[220:223], a[212:215], v[100:103]
    v_mfma_f32_16x16x32_bf16 v[100:103], v[224:227], a[228:231], v[100:103]
    ds_read_b64_tr_b16 v[212:213], v176 offset:28672
    buffer_load_dwordx4 v170, s[8:11], s75 offen offset:2048  lds
    v_mfma_f32_16x16x32_bf16 v[96:99], v[224:227], a[224:227], v[96:99]
    ds_read_b64_tr_b16 v[214:215], v176 offset:30720
    v_mfma_f32_16x16x32_bf16 v[96:99], v[220:223], a[208:211], v[96:99]
    v_mfma_f32_16x16x32_bf16 v[96:99], v[216:219], a[192:195], v[96:99]
    s_add_u32 m0, s40, 101376
    s_waitcnt lgkmcnt(8)
    v_mfma_f32_16x16x32_bf16 v[72:75], v[196:199], a[240:243], v[72:75]
    ds_read_b64_tr_b16 v[216:217], v176 offset:32768
    s_waitcnt lgkmcnt(7)
    v_mfma_f32_16x16x32_bf16 v[72:75], v[200:203], v[136:139], v[72:75]
    ds_read_b64_tr_b16 v[218:219], v176 offset:34816
    s_waitcnt lgkmcnt(6)
    v_mfma_f32_16x16x32_bf16 v[72:75], v[204:207], v[152:155], v[72:75]
    s_add_u32 s75, s41, 221440
    v_mfma_f32_16x16x32_bf16 v[76:79], v[204:207], v[156:159], v[76:79]
    buffer_load_dwordx4 v168, s[8:11], s75 offen offset:0  lds
    v_mfma_f32_16x16x32_bf16 v[76:79], v[200:203], v[140:143], v[76:79]
    ds_read_b64_tr_b16 v[220:221], v173 offset:36864
    v_mfma_f32_16x16x32_bf16 v[76:79], v[196:199], a[244:247], v[76:79]
    ds_read_b64_tr_b16 v[222:223], v173 offset:38912
    v_mfma_f32_16x16x32_bf16 v[104:107], v[196:199], a[248:251], v[104:107]
    v_mfma_f32_16x16x32_bf16 v[104:107], v[200:203], v[144:147], v[104:107]
    v_mfma_f32_16x16x32_bf16 v[104:107], v[204:207], v[160:163], v[104:107]
    ds_read_b64_tr_b16 v[224:225], v173 offset:40960
    v_mfma_f32_16x16x32_bf16 v[108:111], v[204:207], v[164:167], v[108:111]
    ds_read_b64_tr_b16 v[226:227], v173 offset:43008
    v_mfma_f32_16x16x32_bf16 v[108:111], v[200:203], v[148:151], v[108:111]
    buffer_load_dwordx4 v169, s[8:11], s75 offen offset:1024  lds
    v_mfma_f32_16x16x32_bf16 v[108:111], v[196:199], a[252:255], v[108:111]
    s_waitcnt lgkmcnt(8)
    v_mfma_f32_16x16x32_bf16 v[116:119], v[208:211], a[252:255], v[116:119]
    ds_read_b64_tr_b16 v[196:197], v173 offset:45056
    s_waitcnt lgkmcnt(7)
    v_mfma_f32_16x16x32_bf16 v[116:119], v[212:215], v[148:151], v[116:119]
    ds_read_b64_tr_b16 v[198:199], v173 offset:47104
    s_waitcnt lgkmcnt(6)
    v_mfma_f32_16x16x32_bf16 v[116:119], v[216:219], v[164:167], v[116:119]
    v_mfma_f32_16x16x32_bf16 v[112:115], v[216:219], v[160:163], v[112:115]
    v_mfma_f32_16x16x32_bf16 v[112:115], v[212:215], v[144:147], v[112:115]
    ds_read_b64_tr_b16 v[200:201], v176 offset:36864
    v_mfma_f32_16x16x32_bf16 v[112:115], v[208:211], a[248:251], v[112:115]
    ds_read_b64_tr_b16 v[202:203], v176 offset:38912
    buffer_load_dwordx4 v170, s[8:11], s75 offen offset:2048  lds
    v_mfma_f32_16x16x32_bf16 v[84:87], v[208:211], a[244:247], v[84:87]
    v_mfma_f32_16x16x32_bf16 v[84:87], v[212:215], v[140:143], v[84:87]
    v_mfma_f32_16x16x32_bf16 v[84:87], v[216:219], v[156:159], v[84:87]
    ds_read_b64_tr_b16 v[204:205], v176 offset:40960
    v_mfma_f32_16x16x32_bf16 v[80:83], v[216:219], v[152:155], v[80:83]
    ds_read_b64_tr_b16 v[206:207], v176 offset:43008
    v_mfma_f32_16x16x32_bf16 v[80:83], v[212:215], v[136:139], v[80:83]
    v_mfma_f32_16x16x32_bf16 v[80:83], v[208:211], a[240:243], v[80:83]
    s_waitcnt lgkmcnt(8)
    v_mfma_f32_16x16x32_bf16 v[88:91], v[220:223], a[240:243], v[88:91]
    ds_read_b64_tr_b16 v[208:209], v176 offset:45056
    s_waitcnt lgkmcnt(7)
    v_mfma_f32_16x16x32_bf16 v[88:91], v[224:227], v[136:139], v[88:91]
    ds_read_b64_tr_b16 v[210:211], v176 offset:47104
    s_waitcnt lgkmcnt(6)
    v_mfma_f32_16x16x32_bf16 v[88:91], v[196:199], v[152:155], v[88:91]
    s_add_u32 m0, s40, 0
    s_add_u32 s75, s41, 884992
    v_mfma_f32_16x16x32_bf16 v[92:95], v[196:199], v[156:159], v[92:95]
    v_mfma_f32_16x16x32_bf16 v[92:95], v[224:227], v[140:143], v[92:95]
    v_mfma_f32_16x16x32_bf16 v[92:95], v[220:223], a[244:247], v[92:95]
    v_mfma_f32_16x16x32_bf16 v[120:123], v[220:223], a[248:251], v[120:123]
    s_waitcnt vmcnt(21)
    s_barrier
    ds_read_b64_tr_b16 v[212:213], v178 offset:24576
    v_mfma_f32_16x16x32_bf16 v[120:123], v[224:227], v[144:147], v[120:123]
    ds_read_b64_tr_b16 v[214:215], v178 offset:25600
    buffer_load_dwordx4 v168, s[8:11], s75 offen offset:0  lds
    v_mfma_f32_16x16x32_bf16 v[120:123], v[196:199], v[160:163], v[120:123]
    ds_read_b64_tr_b16 v[216:217], v178 offset:26624
    v_mfma_f32_16x16x32_bf16 v[124:127], v[196:199], v[164:167], v[124:127]
    ds_read_b64_tr_b16 v[218:219], v178 offset:27648
    v_mfma_f32_16x16x32_bf16 v[124:127], v[224:227], v[148:151], v[124:127]
    v_mfma_f32_16x16x32_bf16 v[124:127], v[220:223], a[252:255], v[124:127]
    s_waitcnt lgkmcnt(8)
    v_mfma_f32_16x16x32_bf16 v[132:135], v[200:203], a[252:255], v[132:135]
    ds_read_b64_tr_b16 v[220:221], v178 offset:28672
    s_waitcnt lgkmcnt(7)
    v_mfma_f32_16x16x32_bf16 v[132:135], v[204:207], v[148:151], v[132:135]
    ds_read_b64_tr_b16 v[222:223], v178 offset:29696
    s_waitcnt lgkmcnt(6)
    v_mfma_f32_16x16x32_bf16 v[132:135], v[208:211], v[164:167], v[132:135]
    buffer_load_dwordx4 v169, s[8:11], s75 offen offset:1024  lds
    v_mfma_f32_16x16x32_bf16 v[128:131], v[208:211], v[160:163], v[128:131]
    v_mfma_f32_16x16x32_bf16 v[128:131], v[204:207], v[144:147], v[128:131]
    ds_read_b64_tr_b16 v[224:225], v178 offset:36864
    v_mfma_f32_16x16x32_bf16 v[128:131], v[200:203], a[248:251], v[128:131]
    ds_read_b64_tr_b16 v[226:227], v178 offset:37888
    v_mfma_f32_16x16x32_bf16 v[100:103], v[200:203], a[244:247], v[100:103]
    v_mfma_f32_16x16x32_bf16 v[100:103], v[204:207], v[140:143], v[100:103]
    v_mfma_f32_16x16x32_bf16 v[100:103], v[208:211], v[156:159], v[100:103]
    ds_read_b64_tr_b16 v[196:197], v178 offset:38912
    buffer_load_dwordx4 v170, s[8:11], s75 offen offset:2048  lds
    v_mfma_f32_16x16x32_bf16 v[96:99], v[208:211], v[152:155], v[96:99]
    ds_read_b64_tr_b16 v[198:199], v178 offset:39936
    v_mfma_f32_16x16x32_bf16 v[96:99], v[204:207], v[136:139], v[96:99]
    v_mfma_f32_16x16x32_bf16 v[96:99], v[200:203], a[240:243], v[96:99]
    s_add_u32 m0, s40, 3072
    s_waitcnt lgkmcnt(8)
    v_mfma_f32_16x16x32_bf16 v[8:11], v[212:215], a[0:3], 0
    ds_read_b64_tr_b16 v[200:201], v178 offset:40960
    s_waitcnt lgkmcnt(7)
    v_mfma_f32_16x16x32_bf16 v[8:11], v[216:219], a[16:19], v[8:11]
    ds_read_b64_tr_b16 v[202:203], v178 offset:41984
    s_waitcnt lgkmcnt(6)
    v_mfma_f32_16x16x32_bf16 v[8:11], v[220:223], a[32:35], v[8:11]
    s_add_u32 s75, s41, 1106176
    v_mfma_f32_16x16x32_bf16 v[12:15], v[220:223], a[36:39], 0
    buffer_load_dwordx4 v168, s[8:11], s75 offen offset:0  lds
    ds_read_b128 v[228:231], v180 offset:256
    v_mfma_f32_16x16x32_bf16 v[12:15], v[216:219], a[20:23], v[12:15]
    ds_read_b64_tr_b16 v[204:205], v178 offset:30720
    ds_read_b128 v[232:235], v180 offset:320
    v_mfma_f32_16x16x32_bf16 v[12:15], v[212:215], a[4:7], v[12:15]
    ds_read_b64_tr_b16 v[206:207], v178 offset:31744
    ds_read_b128 v[236:239], v180 offset:1536
    v_mfma_f32_16x16x32_bf16 v[16:19], v[212:215], a[8:11], 0
    ds_read_b128 v[240:243], v180 offset:1600
    v_mfma_f32_16x16x32_bf16 v[16:19], v[216:219], a[24:27], v[16:19]
    s_waitcnt lgkmcnt(0)
    v_fmac_f32 v72, v182, v228
    v_mfma_f32_16x16x32_bf16 v[16:19], v[220:223], a[40:43], v[16:19]
    ds_read_b64_tr_b16 v[208:209], v178 offset:32768
    v_fmac_f32 v73, v182, v229
    v_mfma_f32_16x16x32_bf16 v[20:23], v[220:223], a[44:47], 0
    ds_read_b64_tr_b16 v[210:211], v178 offset:33792
    v_fmac_f32 v74, v182, v230
    v_mfma_f32_16x16x32_bf16 v[20:23], v[216:219], a[28:31], v[20:23]
    buffer_load_dwordx4 v169, s[8:11], s75 offen offset:1024  lds
    v_fmac_f32 v75, v182, v231
    v_mfma_f32_16x16x32_bf16 v[20:23], v[212:215], a[12:15], v[20:23]
    v_fmac_f32 v80, v182, v232
    v_fmac_f32 v81, v182, v233
    v_mfma_f32_16x16x32_bf16 v[36:39], v[224:227], a[12:15], 0
    ds_read_b64_tr_b16 v[212:213], v178 offset:34816
    v_fmac_f32 v82, v182, v234
    v_mfma_f32_16x16x32_bf16 v[36:39], v[196:199], a[28:31], v[36:39]
    ds_read_b64_tr_b16 v[214:215], v178 offset:35840
    v_fmac_f32 v83, v182, v235
    v_mfma_f32_16x16x32_bf16 v[36:39], v[200:203], a[44:47], v[36:39]
    v_fmac_f32 v88, v182, v236
    v_fmac_f32 v89, v182, v237
    v_mfma_f32_16x16x32_bf16 v[32:35], v[200:203], a[40:43], 0
    v_fmac_f32 v90, v182, v238
    v_fmac_f32 v91, v182, v239
    v_mfma_f32_16x16x32_bf16 v[32:35], v[196:199], a[24:27], v[32:35]
    ds_read_b64_tr_b16 v[216:217], v178 offset:43008
    v_fmac_f32 v96, v182, v240
    v_mfma_f32_16x16x32_bf16 v[32:35], v[224:227], a[8:11], v[32:35]
    ds_read_b64_tr_b16 v[218:219], v178 offset:44032
    buffer_load_dwordx4 v170, s[8:11], s75 offen offset:2048  lds
    v_mfma_f32_16x16x32_bf16 v[28:31], v[224:227], a[4:7], 0
    v_fmac_f32 v97, v182, v241
    v_fmac_f32 v98, v182, v242
    v_mfma_f32_16x16x32_bf16 v[28:31], v[196:199], a[20:23], v[28:31]
    v_fmac_f32 v99, v182, v243
    v_max_f32 v72, 0, v72
    v_mfma_f32_16x16x32_bf16 v[28:31], v[200:203], a[36:39], v[28:31]
    ds_read_b64_tr_b16 v[220:221], v178 offset:45056
    v_max_f32 v73, 0, v73
    v_mfma_f32_16x16x32_bf16 v[24:27], v[200:203], a[32:35], 0
    ds_read_b64_tr_b16 v[222:223], v178 offset:46080
    v_max_f32 v74, 0, v74
    v_mfma_f32_16x16x32_bf16 v[24:27], v[196:199], a[16:19], v[24:27]
    v_max_f32 v75, 0, v75
    v_max_f32 v80, 0, v80
    v_mfma_f32_16x16x32_bf16 v[24:27], v[224:227], a[0:3], v[24:27]
    v_max_f32 v81, 0, v81
    v_max_f32 v82, 0, v82
    v_mfma_f32_16x16x32_bf16 v[8:11], v[204:207], a[48:51], v[8:11]
    ds_read_b64_tr_b16 v[224:225], v178 offset:47104
    s_waitcnt lgkmcnt(7)
    v_mfma_f32_16x16x32_bf16 v[8:11], v[208:211], a[64:67], v[8:11]
    ds_read_b64_tr_b16 v[226:227], v178 offset:48128
    s_waitcnt lgkmcnt(6)
    v_mfma_f32_16x16x32_bf16 v[8:11], v[212:215], a[80:83], v[8:11]
    s_add_u32 m0, s40, 122880
    s_add_u32 s75, s41, 1769728
    v_mfma_f32_16x16x32_bf16 v[12:15], v[212:215], a[84:87], v[12:15]
    v_max_f32 v83, 0, v83
    v_mul_f32 v72, v72, v88
    v_mfma_f32_16x16x32_bf16 v[12:15], v[208:211], a[68:71], v[12:15]
    v_mul_f32 v73, v73, v89
    v_mul_f32 v74, v74, v90
    v_mfma_f32_16x16x32_bf16 v[12:15], v[204:207], a[52:55], v[12:15]
    v_mul_f32 v75, v75, v91
    v_mul_f32 v80, v80, v96
    v_mfma_f32_16x16x32_bf16 v[16:19], v[204:207], a[56:59], v[16:19]
    s_waitcnt vmcnt(19)
    s_barrier
    ds_read_b64_tr_b16 v[196:197], v177 offset:24576
    v_mfma_f32_16x16x32_bf16 v[16:19], v[208:211], a[72:75], v[16:19]
    ds_read_b64_tr_b16 v[198:199], v177 offset:25600
    buffer_load_dwordx4 v168, s[8:11], s75 offen offset:0  lds
    v_mfma_f32_16x16x32_bf16 v[16:19], v[212:215], a[88:91], v[16:19]
    ds_read_b64_tr_b16 v[200:201], v177 offset:26624
    v_mul_f32 v81, v81, v97
    v_mfma_f32_16x16x32_bf16 v[20:23], v[212:215], a[92:95], v[20:23]
    ds_read_b64_tr_b16 v[202:203], v177 offset:27648
    v_mul_f32 v82, v82, v98
    v_mfma_f32_16x16x32_bf16 v[20:23], v[208:211], a[76:79], v[20:23]
    v_mul_f32 v83, v83, v99
    v_cvt_pk_bf16_f32 v244, v72, v73
    v_mfma_f32_16x16x32_bf16 v[20:23], v[204:207], a[60:63], v[20:23]
    v_cvt_pk_bf16_f32 v245, v74, v75
    s_waitcnt lgkmcnt(8)
    v_mfma_f32_16x16x32_bf16 v[36:39], v[216:219], a[60:63], v[36:39]
    ds_read_b64_tr_b16 v[204:205], v177 offset:28672
    s_waitcnt lgkmcnt(7)
    v_mfma_f32_16x16x32_bf16 v[36:39], v[220:223], a[76:79], v[36:39]
    ds_read_b64_tr_b16 v[206:207], v177 offset:29696
    s_waitcnt lgkmcnt(6)
    v_mfma_f32_16x16x32_bf16 v[36:39], v[224:227], a[92:95], v[36:39]
    buffer_load_dwordx4 v169, s[8:11], s75 offen offset:1024  lds
    v_cvt_pk_bf16_f32 v246, v80, v81
    v_mfma_f32_16x16x32_bf16 v[32:35], v[224:227], a[88:91], v[32:35]
    v_cvt_pk_bf16_f32 v247, v82, v83
    buffer_store_dwordx4 v[244:247], v3, s[24:27], s50 offen offset:2048 sc1
    v_mfma_f32_16x16x32_bf16 v[32:35], v[220:223], a[72:75], v[32:35]
    ds_read_b64_tr_b16 v[208:209], v177 offset:36864
    v_fmac_f32 v76, v183, v228
    v_mfma_f32_16x16x32_bf16 v[32:35], v[216:219], a[56:59], v[32:35]
    ds_read_b64_tr_b16 v[210:211], v177 offset:37888
    v_fmac_f32 v77, v183, v229
    v_mfma_f32_16x16x32_bf16 v[28:31], v[216:219], a[52:55], v[28:31]
    v_fmac_f32 v78, v183, v230
    v_fmac_f32 v79, v183, v231
    v_mfma_f32_16x16x32_bf16 v[28:31], v[220:223], a[68:71], v[28:31]
    v_fmac_f32 v84, v183, v232
    v_fmac_f32 v85, v183, v233
    v_mfma_f32_16x16x32_bf16 v[28:31], v[224:227], a[84:87], v[28:31]
    ds_read_b64_tr_b16 v[212:213], v177 offset:38912
    buffer_load_dwordx4 v170, s[8:11], s75 offen offset:2048  lds
    v_mfma_f32_16x16x32_bf16 v[24:27], v[224:227], a[80:83], v[24:27]
    ds_read_b64_tr_b16 v[214:215], v177 offset:39936
    v_fmac_f32 v86, v183, v234
    v_mfma_f32_16x16x32_bf16 v[24:27], v[220:223], a[64:67], v[24:27]
    v_fmac_f32 v87, v183, v235
    v_fmac_f32 v92, v183, v236
    v_mfma_f32_16x16x32_bf16 v[24:27], v[216:219], a[48:51], v[24:27]
    s_add_u32 m0, s40, 125952
    s_waitcnt lgkmcnt(8)
    v_mfma_f32_16x16x32_bf16 v[8:11], v[196:199], a[96:99], v[8:11]
    ds_read_b64_tr_b16 v[216:217], v177 offset:40960
    s_waitcnt lgkmcnt(7)
    v_mfma_f32_16x16x32_bf16 v[8:11], v[200:203], a[112:115], v[8:11]
    ds_read_b64_tr_b16 v[218:219], v177 offset:41984
    s_waitcnt lgkmcnt(6)
    v_mfma_f32_16x16x32_bf16 v[8:11], v[204:207], a[128:131], v[8:11]
    s_add_u32 s75, s41, 1990912
    v_fmac_f32 v93, v183, v237
    v_mfma_f32_16x16x32_bf16 v[12:15], v[204:207], a[132:135], v[12:15]
    buffer_load_dwordx4 v168, s[8:11], s75 offen offset:0  lds
    v_fmac_f32 v94, v183, v238
    v_mfma_f32_16x16x32_bf16 v[12:15], v[200:203], a[116:119], v[12:15]
    ds_read_b64_tr_b16 v[220:221], v177 offset:30720
    v_fmac_f32 v95, v183, v239
    v_mfma_f32_16x16x32_bf16 v[12:15], v[196:199], a[100:103], v[12:15]
    ds_read_b64_tr_b16 v[222:223], v177 offset:31744
    v_fmac_f32 v100, v183, v240
    v_mfma_f32_16x16x32_bf16 v[16:19], v[196:199], a[104:107], v[16:19]
    v_fmac_f32 v101, v183, v241
    v_fmac_f32 v102, v183, v242
    v_mfma_f32_16x16x32_bf16 v[16:19], v[200:203], a[120:123], v[16:19]
    v_fmac_f32 v103, v183, v243
    v_max_f32 v76, 0, v76
    v_mfma_f32_16x16x32_bf16 v[16:19], v[204:207], a[136:139], v[16:19]
    ds_read_b64_tr_b16 v[224:225], v177 offset:32768
    v_max_f32 v77, 0, v77
    v_mfma_f32_16x16x32_bf16 v[20:23], v[204:207], a[140:143], v[20:23]
    ds_read_b64_tr_b16 v[226:227], v177 offset:33792
    v_max_f32 v78, 0, v78
    v_mfma_f32_16x16x32_bf16 v[20:23], v[200:203], a[124:127], v[20:23]
    buffer_load_dwordx4 v169, s[8:11], s75 offen offset:1024  lds
    v_max_f32 v79, 0, v79
    v_mfma_f32_16x16x32_bf16 v[20:23], v[196:199], a[108:111], v[20:23]
    v_max_f32 v84, 0, v84
    s_waitcnt lgkmcnt(8)
    v_mfma_f32_16x16x32_bf16 v[36:39], v[208:211], a[108:111], v[36:39]
    ds_read_b64_tr_b16 v[196:197], v177 offset:34816
    s_waitcnt lgkmcnt(7)
    v_mfma_f32_16x16x32_bf16 v[36:39], v[212:215], a[124:127], v[36:39]
    ds_read_b64_tr_b16 v[198:199], v177 offset:35840
    s_waitcnt lgkmcnt(6)
    v_mfma_f32_16x16x32_bf16 v[36:39], v[216:219], a[140:143], v[36:39]
    v_max_f32 v85, 0, v85
    v_max_f32 v86, 0, v86
    v_mfma_f32_16x16x32_bf16 v[32:35], v[216:219], a[136:139], v[32:35]
    v_max_f32 v87, 0, v87
    v_mul_f32 v76, v76, v92
    v_mfma_f32_16x16x32_bf16 v[32:35], v[212:215], a[120:123], v[32:35]
    ds_read_b64_tr_b16 v[200:201], v177 offset:43008
    v_mul_f32 v77, v77, v93
    v_mfma_f32_16x16x32_bf16 v[32:35], v[208:211], a[104:107], v[32:35]
    ds_read_b64_tr_b16 v[202:203], v177 offset:44032
    buffer_load_dwordx4 v170, s[8:11], s75 offen offset:2048  lds
    v_mfma_f32_16x16x32_bf16 v[28:31], v[208:211], a[100:103], v[28:31]
    v_mul_f32 v78, v78, v94
    v_mul_f32 v79, v79, v95
    v_mfma_f32_16x16x32_bf16 v[28:31], v[212:215], a[116:119], v[28:31]
    v_mul_f32 v84, v84, v100
    v_mul_f32 v85, v85, v101
    v_mfma_f32_16x16x32_bf16 v[28:31], v[216:219], a[132:135], v[28:31]
    ds_read_b64_tr_b16 v[204:205], v177 offset:45056
    v_mul_f32 v86, v86, v102
    v_mfma_f32_16x16x32_bf16 v[24:27], v[216:219], a[128:131], v[24:27]
    ds_read_b64_tr_b16 v[206:207], v177 offset:46080
    v_mul_f32 v87, v87, v103
    v_mfma_f32_16x16x32_bf16 v[24:27], v[212:215], a[112:115], v[24:27]
    v_cvt_pk_bf16_f32 v248, v76, v77
    v_cvt_pk_bf16_f32 v249, v78, v79
    v_mfma_f32_16x16x32_bf16 v[24:27], v[208:211], a[96:99], v[24:27]
    v_cvt_pk_bf16_f32 v250, v84, v85
    s_waitcnt lgkmcnt(8)
    v_mfma_f32_16x16x32_bf16 v[8:11], v[220:223], a[144:147], v[8:11]
    ds_read_b64_tr_b16 v[208:209], v177 offset:47104
    s_waitcnt lgkmcnt(7)
    v_mfma_f32_16x16x32_bf16 v[8:11], v[224:227], a[160:163], v[8:11]
    ds_read_b64_tr_b16 v[210:211], v177 offset:48128
    s_waitcnt lgkmcnt(6)
    v_mfma_f32_16x16x32_bf16 v[8:11], v[196:199], a[176:179], v[8:11]
    s_add_u32 m0, s40, 73728
    s_add_u32 s75, s41, 2654464
    v_mfma_f32_16x16x32_bf16 v[12:15], v[196:199], a[180:183], v[12:15]
    v_cvt_pk_bf16_f32 v251, v86, v87
    buffer_store_dwordx4 v[248:251], v3, s[24:27], s51 offen offset:2048 sc1
    v_mfma_f32_16x16x32_bf16 v[12:15], v[224:227], a[164:167], v[12:15]
    v_fmac_f32 v104, v184, v228
    v_fmac_f32 v105, v184, v229
    v_mfma_f32_16x16x32_bf16 v[12:15], v[220:223], a[148:151], v[12:15]
    v_fmac_f32 v106, v184, v230
    v_fmac_f32 v107, v184, v231
    v_mfma_f32_16x16x32_bf16 v[16:19], v[220:223], a[152:155], v[16:19]
    s_waitcnt vmcnt(20)
    s_barrier
    ds_read_b64_tr_b16 v[212:213], v178 offset:0
    v_mfma_f32_16x16x32_bf16 v[16:19], v[224:227], a[168:171], v[16:19]
    ds_read_b64_tr_b16 v[214:215], v178 offset:1024
    buffer_load_dwordx4 v168, s[8:11], s75 offen offset:0  lds
    v_mfma_f32_16x16x32_bf16 v[16:19], v[196:199], a[184:187], v[16:19]
    ds_read_b64_tr_b16 v[216:217], v178 offset:2048
    v_fmac_f32 v112, v184, v232
    v_mfma_f32_16x16x32_bf16 v[20:23], v[196:199], a[188:191], v[20:23]
    ds_read_b64_tr_b16 v[218:219], v178 offset:3072
    v_fmac_f32 v113, v184, v233
    v_mfma_f32_16x16x32_bf16 v[20:23], v[224:227], a[172:175], v[20:23]
    v_fmac_f32 v114, v184, v234
    v_fmac_f32 v115, v184, v235
    v_mfma_f32_16x16x32_bf16 v[20:23], v[220:223], a[156:159], v[20:23]
    v_fmac_f32 v120, v184, v236
    s_waitcnt lgkmcnt(8)
    v_mfma_f32_16x16x32_bf16 v[36:39], v[200:203], a[156:159], v[36:39]
    ds_read_b64_tr_b16 v[220:221], v178 offset:4096
    s_waitcnt lgkmcnt(7)
    v_mfma_f32_16x16x32_bf16 v[36:39], v[204:207], a[172:175], v[36:39]
    ds_read_b64_tr_b16 v[222:223], v178 offset:5120
    s_waitcnt lgkmcnt(6)
    v_mfma_f32_16x16x32_bf16 v[36:39], v[208:211], a[188:191], v[36:39]
    buffer_load_dwordx4 v169, s[8:11], s75 offen offset:1024  lds
    v_fmac_f32 v121, v184, v237
    v_mfma_f32_16x16x32_bf16 v[32:35], v[208:211], a[184:187], v[32:35]
    v_fmac_f32 v122, v184, v238
    v_fmac_f32 v123, v184, v239
    v_mfma_f32_16x16x32_bf16 v[32:35], v[204:207], a[168:171], v[32:35]
    ds_read_b64_tr_b16 v[224:225], v178 offset:12288
    v_fmac_f32 v128, v184, v240
    v_mfma_f32_16x16x32_bf16 v[32:35], v[200:203], a[152:155], v[32:35]
    ds_read_b64_tr_b16 v[226:227], v178 offset:13312
    v_fmac_f32 v129, v184, v241
    v_mfma_f32_16x16x32_bf16 v[28:31], v[200:203], a[148:151], v[28:31]
    v_fmac_f32 v130, v184, v242
    v_fmac_f32 v131, v184, v243
    v_mfma_f32_16x16x32_bf16 v[28:31], v[204:207], a[164:167], v[28:31]
    v_max_f32 v104, 0, v104
    v_max_f32 v105, 0, v105
    v_mfma_f32_16x16x32_bf16 v[28:31], v[208:211], a[180:183], v[28:31]
    ds_read_b64_tr_b16 v[196:197], v178 offset:14336
    buffer_load_dwordx4 v170, s[8:11], s75 offen offset:2048  lds
    v_mfma_f32_16x16x32_bf16 v[24:27], v[208:211], a[176:179], v[24:27]
    ds_read_b64_tr_b16 v[198:199], v178 offset:15360
    v_max_f32 v106, 0, v106
    v_mfma_f32_16x16x32_bf16 v[24:27], v[204:207], a[160:163], v[24:27]
    v_max_f32 v107, 0, v107
    v_max_f32 v112, 0, v112
    v_mfma_f32_16x16x32_bf16 v[24:27], v[200:203], a[144:147], v[24:27]
    s_add_u32 m0, s40, 76800
    s_waitcnt lgkmcnt(8)
    v_mfma_f32_16x16x32_bf16 v[8:11], v[212:215], a[192:195], v[8:11]
    ds_read_b64_tr_b16 v[200:201], v178 offset:16384
    s_waitcnt lgkmcnt(7)
    v_mfma_f32_16x16x32_bf16 v[8:11], v[216:219], a[208:211], v[8:11]
    ds_read_b64_tr_b16 v[202:203], v178 offset:17408
    s_waitcnt lgkmcnt(6)
    v_mfma_f32_16x16x32_bf16 v[8:11], v[220:223], a[224:227], v[8:11]
    s_add_u32 s75, s41, 2875648
    v_max_f32 v113, 0, v113
    v_mfma_f32_16x16x32_bf16 v[12:15], v[220:223], a[228:231], v[12:15]
    buffer_load_dwordx4 v168, s[8:11], s75 offen offset:0  lds
    v_max_f32 v114, 0, v114
    v_mfma_f32_16x16x32_bf16 v[12:15], v[216:219], a[212:215], v[12:15]
    ds_read_b64_tr_b16 v[204:205], v178 offset:6144
    v_max_f32 v115, 0, v115
    v_mfma_f32_16x16x32_bf16 v[12:15], v[212:215], a[196:199], v[12:15]
    ds_read_b64_tr_b16 v[206:207], v178 offset:7168
    v_mul_f32 v104, v104, v120
    v_mfma_f32_16x16x32_bf16 v[16:19], v[212:215], a[200:203], v[16:19]
    v_mul_f32 v105, v105, v121
    v_mul_f32 v106, v106, v122
    v_mfma_f32_16x16x32_bf16 v[16:19], v[216:219], a[216:219], v[16:19]
    v_mul_f32 v107, v107, v123
    v_mul_f32 v112, v112, v128
    v_mfma_f32_16x16x32_bf16 v[16:19], v[220:223], a[232:235], v[16:19]
    ds_read_b64_tr_b16 v[208:209], v178 offset:8192
    v_mul_f32 v113, v113, v129
    v_mfma_f32_16x16x32_bf16 v[20:23], v[220:223], a[236:239], v[20:23]
    ds_read_b64_tr_b16 v[210:211], v178 offset:9216
    v_mul_f32 v114, v114, v130
    v_mfma_f32_16x16x32_bf16 v[20:23], v[216:219], a[220:223], v[20:23]
    buffer_load_dwordx4 v169, s[8:11], s75 offen offset:1024  lds
    v_mul_f32 v115, v115, v131
    v_mfma_f32_16x16x32_bf16 v[20:23], v[212:215], a[204:207], v[20:23]
    v_cvt_pk_bf16_f32 v244, v104, v105
    s_waitcnt lgkmcnt(8)
    v_mfma_f32_16x16x32_bf16 v[36:39], v[224:227], a[204:207], v[36:39]
    ds_read_b64_tr_b16 v[212:213], v178 offset:10240
    s_waitcnt lgkmcnt(7)
    v_mfma_f32_16x16x32_bf16 v[36:39], v[196:199], a[220:223], v[36:39]
    ds_read_b64_tr_b16 v[214:215], v178 offset:11264
    s_waitcnt lgkmcnt(6)
    v_mfma_f32_16x16x32_bf16 v[36:39], v[200:203], a[236:239], v[36:39]
    v_cvt_pk_bf16_f32 v245, v106, v107
    v_cvt_pk_bf16_f32 v246, v112, v113
    v_mfma_f32_16x16x32_bf16 v[32:35], v[200:203], a[232:235], v[32:35]
    v_cvt_pk_bf16_f32 v247, v114, v115
    buffer_store_dwordx4 v[244:247], v3, s[24:27], s52 offen offset:2048 sc1
    v_mfma_f32_16x16x32_bf16 v[32:35], v[196:199], a[216:219], v[32:35]
    ds_read_b64_tr_b16 v[216:217], v178 offset:18432
    v_fmac_f32 v108, v185, v228
    v_mfma_f32_16x16x32_bf16 v[32:35], v[224:227], a[200:203], v[32:35]
    ds_read_b64_tr_b16 v[218:219], v178 offset:19456
    buffer_load_dwordx4 v170, s[8:11], s75 offen offset:2048  lds
    v_mfma_f32_16x16x32_bf16 v[28:31], v[224:227], a[196:199], v[28:31]
    v_fmac_f32 v109, v185, v229
    v_fmac_f32 v110, v185, v230
    v_mfma_f32_16x16x32_bf16 v[28:31], v[196:199], a[212:215], v[28:31]
    v_fmac_f32 v111, v185, v231
    v_fmac_f32 v116, v185, v232
    v_mfma_f32_16x16x32_bf16 v[28:31], v[200:203], a[228:231], v[28:31]
    ds_read_b64_tr_b16 v[220:221], v178 offset:20480
    v_fmac_f32 v117, v185, v233
    v_mfma_f32_16x16x32_bf16 v[24:27], v[200:203], a[224:227], v[24:27]
    ds_read_b64_tr_b16 v[222:223], v178 offset:21504
    v_fmac_f32 v118, v185, v234
    v_mfma_f32_16x16x32_bf16 v[24:27], v[196:199], a[208:211], v[24:27]
    v_fmac_f32 v119, v185, v235
    v_fmac_f32 v124, v185, v236
    v_mfma_f32_16x16x32_bf16 v[24:27], v[224:227], a[192:195], v[24:27]
    v_fmac_f32 v125, v185, v237
    s_waitcnt lgkmcnt(8)
    v_mfma_f32_16x16x32_bf16 v[8:11], v[204:207], a[240:243], v[8:11]
    ds_read_b64_tr_b16 v[224:225], v178 offset:22528
    s_waitcnt lgkmcnt(7)
    v_mfma_f32_16x16x32_bf16 v[8:11], v[208:211], v[136:139], v[8:11]
    ds_read_b64_tr_b16 v[226:227], v178 offset:23552
    s_waitcnt lgkmcnt(6)
    v_mfma_f32_16x16x32_bf16 v[8:11], v[212:215], v[152:155], v[8:11]
    s_add_u32 m0, s40, 24576
    s_add_u32 s75, s41, 3539200
    v_mfma_f32_16x16x32_bf16 v[12:15], v[212:215], v[156:159], v[12:15]
    v_fmac_f32 v126, v185, v238
    v_fmac_f32 v127, v185, v239
    v_mfma_f32_16x16x32_bf16 v[12:15], v[208:211], v[140:143], v[12:15]
    v_fmac_f32 v132, v185, v240
    v_fmac_f32 v133, v185, v241
    v_mfma_f32_16x16x32_bf16 v[12:15], v[204:207], a[244:247], v[12:15]
    v_fmac_f32 v134, v185, v242
    v_fmac_f32 v135, v185, v243
    v_mfma_f32_16x16x32_bf16 v[16:19], v[204:207], a[248:251], v[16:19]
    s_waitcnt vmcnt(21)
    s_barrier
    ds_read_b64_tr_b16 v[196:197], v173 offset:0
    v_mfma_f32_16x16x32_bf16 v[16:19], v[208:211], v[144:147], v[16:19]
    ds_read_b64_tr_b16 v[198:199], v173 offset:2048
    buffer_load_dwordx4 v168, s[8:11], s75 offen offset:0  lds
    v_mfma_f32_16x16x32_bf16 v[16:19], v[212:215], v[160:163], v[16:19]
    ds_read_b64_tr_b16 v[200:201], v173 offset:4096
    v_max_f32 v108, 0, v108
    v_mfma_f32_16x16x32_bf16 v[20:23], v[212:215], v[164:167], v[20:23]
    ds_read_b64_tr_b16 v[202:203], v173 offset:6144
    v_max_f32 v109, 0, v109
    v_mfma_f32_16x16x32_bf16 v[20:23], v[208:211], v[148:151], v[20:23]
    v_max_f32 v110, 0, v110
    v_max_f32 v111, 0, v111
    v_mfma_f32_16x16x32_bf16 v[20:23], v[204:207], a[252:255], v[20:23]
    v_max_f32 v116, 0, v116
    s_waitcnt lgkmcnt(8)
    v_mfma_f32_16x16x32_bf16 v[36:39], v[216:219], a[252:255], v[36:39]
    ds_read_b64_tr_b16 v[204:205], v173 offset:8192
    s_waitcnt lgkmcnt(7)
    v_mfma_f32_16x16x32_bf16 v[36:39], v[220:223], v[148:151], v[36:39]
    ds_read_b64_tr_b16 v[206:207], v173 offset:10240
    s_waitcnt lgkmcnt(6)
    v_mfma_f32_16x16x32_bf16 v[36:39], v[224:227], v[164:167], v[36:39]
    buffer_load_dwordx4 v169, s[8:11], s75 offen offset:1024  lds
    v_max_f32 v117, 0, v117
    v_mfma_f32_16x16x32_bf16 v[32:35], v[224:227], v[160:163], v[32:35]
    v_max_f32 v118, 0, v118
    v_max_f32 v119, 0, v119
    v_mfma_f32_16x16x32_bf16 v[32:35], v[220:223], v[144:147], v[32:35]
    ds_read_b64_tr_b16 v[208:209], v176 offset:0
    v_mul_f32 v108, v108, v124
    v_mfma_f32_16x16x32_bf16 v[32:35], v[216:219], a[248:251], v[32:35]
    ds_read_b64_tr_b16 v[210:211], v176 offset:2048
    v_mul_f32 v109, v109, v125
    v_mfma_f32_16x16x32_bf16 v[28:31], v[216:219], a[244:247], v[28:31]
    v_mul_f32 v110, v110, v126
    v_mul_f32 v111, v111, v127
    v_mfma_f32_16x16x32_bf16 v[28:31], v[220:223], v[140:143], v[28:31]
    v_mul_f32 v116, v116, v132
    v_mul_f32 v117, v117, v133
    v_mfma_f32_16x16x32_bf16 v[28:31], v[224:227], v[156:159], v[28:31]
    ds_read_b64_tr_b16 v[212:213], v176 offset:4096
    buffer_load_dwordx4 v170, s[8:11], s75 offen offset:2048  lds
    v_mfma_f32_16x16x32_bf16 v[24:27], v[224:227], v[152:155], v[24:27]
    ds_read_b64_tr_b16 v[214:215], v176 offset:6144
    v_mul_f32 v118, v118, v134
    v_mfma_f32_16x16x32_bf16 v[24:27], v[220:223], v[136:139], v[24:27]
    v_mul_f32 v119, v119, v135
    v_cvt_pk_bf16_f32 v248, v108, v109
    v_mfma_f32_16x16x32_bf16 v[24:27], v[216:219], a[240:243], v[24:27]
    s_add_u32 m0, s40, 27648
    s_waitcnt lgkmcnt(8)
    v_mfma_f32_16x16x32_bf16 v[40:43], v[196:199], a[0:3], 0
    ds_read_b64_tr_b16 v[216:217], v176 offset:8192
    s_waitcnt lgkmcnt(7)
    v_mfma_f32_16x16x32_bf16 v[40:43], v[200:203], a[16:19], v[40:43]
    ds_read_b64_tr_b16 v[218:219], v176 offset:10240
    s_waitcnt lgkmcnt(6)
    v_mfma_f32_16x16x32_bf16 v[40:43], v[204:207], a[32:35], v[40:43]
    s_add_u32 s75, s41, 3760384
    v_cvt_pk_bf16_f32 v249, v110, v111
    v_mfma_f32_16x16x32_bf16 v[44:47], v[204:207], a[36:39], 0
    buffer_load_dwordx4 v168, s[8:11], s75 offen offset:0  lds
    v_cvt_pk_bf16_f32 v250, v116, v117
    v_mfma_f32_16x16x32_bf16 v[44:47], v[200:203], a[20:23], v[44:47]
    ds_read_b64_tr_b16 v[220:221], v173 offset:12288
    v_cvt_pk_bf16_f32 v251, v118, v119
    v_mfma_f32_16x16x32_bf16 v[44:47], v[196:199], a[4:7], v[44:47]
    ds_read_b64_tr_b16 v[222:223], v173 offset:14336
    buffer_store_dwordx4 v[248:251], v3, s[24:27], s53 offen offset:2048 sc1
    v_mfma_f32_16x16x32_bf16 v[72:75], v[196:199], a[8:11], 0
    ds_read_b128 v[228:231], v181 offset:0
    ds_read_b128 v[232:235], v181 offset:1280
    v_mfma_f32_16x16x32_bf16 v[72:75], v[200:203], a[24:27], v[72:75]
    s_waitcnt lgkmcnt(0)
    v_fmac_f32 v8, v182, v228
    v_mfma_f32_16x16x32_bf16 v[72:75], v[204:207], a[40:43], v[72:75]
    ds_read_b64_tr_b16 v[224:225], v173 offset:16384
    v_fmac_f32 v9, v182, v229
    v_mfma_f32_16x16x32_bf16 v[76:79], v[204:207], a[44:47], 0
    ds_read_b64_tr_b16 v[226:227], v173 offset:18432
    v_fmac_f32 v10, v182, v230
    v_mfma_f32_16x16x32_bf16 v[76:79], v[200:203], a[28:31], v[76:79]
    buffer_load_dwordx4 v169, s[8:11], s75 offen offset:1024  lds
    v_fmac_f32 v11, v182, v231
    v_mfma_f32_16x16x32_bf16 v[76:79], v[196:199], a[12:15], v[76:79]
    v_fmac_f32 v24, v182, v232
    v_fmac_f32 v25, v182, v233
    v_mfma_f32_16x16x32_bf16 v[84:87], v[208:211], a[12:15], 0
    ds_read_b64_tr_b16 v[196:197], v173 offset:20480
    v_fmac_f32 v26, v182, v234
    v_mfma_f32_16x16x32_bf16 v[84:87], v[212:215], a[28:31], v[84:87]
    ds_read_b64_tr_b16 v[198:199], v173 offset:22528
    v_fmac_f32 v27, v182, v235
    v_mfma_f32_16x16x32_bf16 v[84:87], v[216:219], a[44:47], v[84:87]
    v_max_f32 v8, 0, v8
    v_max_f32 v9, 0, v9
    v_mfma_f32_16x16x32_bf16 v[80:83], v[216:219], a[40:43], 0
    v_max_f32 v10, 0, v10
    v_max_f32 v11, 0, v11
    v_mfma_f32_16x16x32_bf16 v[80:83], v[212:215], a[24:27], v[80:83]
    ds_read_b64_tr_b16 v[200:201], v176 offset:12288
    v_mul_f32 v8, v8, v24
    v_mfma_f32_16x16x32_bf16 v[80:83], v[208:211], a[8:11], v[80:83]
    ds_read_b64_tr_b16 v[202:203], v176 offset:14336
    buffer_load_dwordx4 v170, s[8:11], s75 offen offset:2048  lds
    v_mfma_f32_16x16x32_bf16 v[52:55], v[208:211], a[4:7], 0
    v_mul_f32 v9, v9, v25
    v_mul_f32 v10, v10, v26
    v_mfma_f32_16x16x32_bf16 v[52:55], v[212:215], a[20:23], v[52:55]
    v_mul_f32 v11, v11, v27
    v_cvt_pk_bf16_f32 v244, v8, v9
    v_mfma_f32_16x16x32_bf16 v[52:55], v[216:219], a[36:39], v[52:55]
    ds_read_b64_tr_b16 v[204:205], v176 offset:16384
    v_cvt_pk_bf16_f32 v245, v10, v11
    v_mfma_f32_16x16x32_bf16 v[48:51], v[216:219], a[32:35], 0
    ds_read_b64_tr_b16 v[206:207], v176 offset:18432
    v_fmac_f32 v12, v183, v228
    v_mfma_f32_16x16x32_bf16 v[48:51], v[212:215], a[16:19], v[48:51]
    v_fmac_f32 v13, v183, v229
    v_fmac_f32 v14, v183, v230
    v_mfma_f32_16x16x32_bf16 v[48:51], v[208:211], a[0:3], v[48:51]
    v_fmac_f32 v15, v183, v231
    v_fmac_f32 v28, v183, v232
    v_mfma_f32_16x16x32_bf16 v[56:59], v[220:223], a[0:3], 0
    ds_read_b64_tr_b16 v[208:209], v176 offset:20480
    s_waitcnt lgkmcnt(7)
    v_mfma_f32_16x16x32_bf16 v[56:59], v[224:227], a[16:19], v[56:59]
    ds_read_b64_tr_b16 v[210:211], v176 offset:22528
    s_waitcnt lgkmcnt(6)
    v_mfma_f32_16x16x32_bf16 v[56:59], v[196:199], a[32:35], v[56:59]
    s_add_u32 m0, s40, 49152
    s_add_u32 s75, s41, 4423936
    v_mfma_f32_16x16x32_bf16 v[60:63], v[196:199], a[36:39], 0
    v_fmac_f32 v29, v183, v233
    v_fmac_f32 v30, v183, v234
    v_mfma_f32_16x16x32_bf16 v[60:63], v[224:227], a[20:23], v[60:63]
    v_fmac_f32 v31, v183, v235
    v_max_f32 v12, 0, v12
    v_mfma_f32_16x16x32_bf16 v[60:63], v[220:223], a[4:7], v[60:63]
    v_max_f32 v13, 0, v13
    v_max_f32 v14, 0, v14
    v_mfma_f32_16x16x32_bf16 v[88:91], v[220:223], a[8:11], 0
    s_waitcnt vmcnt(22)
    s_barrier
    ds_read_b64_tr_b16 v[212:213], v171 offset:0
    v_mfma_f32_16x16x32_bf16 v[88:91], v[224:227], a[24:27], v[88:91]
    ds_read_b64_tr_b16 v[214:215], v171 offset:2048
    buffer_load_dwordx4 v168, s[8:11], s75 offen offset:0  lds
    v_mfma_f32_16x16x32_bf16 v[88:91], v[196:199], a[40:43], v[88:91]
    ds_read_b64_tr_b16 v[216:217], v171 offset:4096
    v_max_f32 v15, 0, v15
    v_mfma_f32_16x16x32_bf16 v[92:95], v[196:199], a[44:47], 0
    ds_read_b64_tr_b16 v[218:219], v171 offset:6144
    v_mul_f32 v12, v12, v28
    v_mfma_f32_16x16x32_bf16 v[92:95], v[224:227], a[28:31], v[92:95]
    v_mul_f32 v13, v13, v29
    v_mul_f32 v14, v14, v30
    v_mfma_f32_16x16x32_bf16 v[92:95], v[220:223], a[12:15], v[92:95]
    v_mul_f32 v15, v15, v31
    s_waitcnt lgkmcnt(8)
    v_mfma_f32_16x16x32_bf16 v[100:103], v[200:203], a[12:15], 0
    ds_read_b64_tr_b16 v[220:221], v171 offset:8192
    s_waitcnt lgkmcnt(7)
    v_mfma_f32_16x16x32_bf16 v[100:103], v[204:207], a[28:31], v[100:103]
    ds_read_b64_tr_b16 v[222:223], v171 offset:10240
    s_waitcnt lgkmcnt(6)
    v_mfma_f32_16x16x32_bf16 v[100:103], v[208:211], a[44:47], v[100:103]
    buffer_load_dwordx4 v169, s[8:11], s75 offen offset:1024  lds
    v_cvt_pk_bf16_f32 v246, v12, v13
    v_mfma_f32_16x16x32_bf16 v[96:99], v[208:211], a[40:43], 0
    v_cvt_pk_bf16_f32 v247, v14, v15
    s_add_u32 s72, s50, s62
    v_mfma_f32_16x16x32_bf16 v[96:99], v[204:207], a[24:27], v[96:99]
    ds_read_b64_tr_b16 v[224:225], v174 offset:0
    v_permlane16_swap_b32 v244, v246
    v_mfma_f32_16x16x32_bf16 v[96:99], v[200:203], a[8:11], v[96:99]
    ds_read_b64_tr_b16 v[226:227], v174 offset:2048
    v_permlane16_swap_b32 v245, v247
    v_mfma_f32_16x16x32_bf16 v[68:71], v[200:203], a[4:7], 0
    buffer_store_dwordx4 v[244:247], v189, s[24:27], s72 offen sc1
    v_fmac_f32 v16, v184, v228
    v_mfma_f32_16x16x32_bf16 v[68:71], v[204:207], a[20:23], v[68:71]
    v_fmac_f32 v17, v184, v229
    v_fmac_f32 v18, v184, v230
    v_mfma_f32_16x16x32_bf16 v[68:71], v[208:211], a[36:39], v[68:71]
    ds_read_b64_tr_b16 v[196:197], v174 offset:4096
    buffer_load_dwordx4 v170, s[8:11], s75 offen offset:2048  lds
    v_mfma_f32_16x16x32_bf16 v[64:67], v[208:211], a[32:35], 0
    ds_read_b64_tr_b16 v[198:199], v174 offset:6144
    v_fmac_f32 v19, v184, v231
    v_mfma_f32_16x16x32_bf16 v[64:67], v[204:207], a[16:19], v[64:67]
    v_fmac_f32 v32, v184, v232
    v_fmac_f32 v33, v184, v233
    v_mfma_f32_16x16x32_bf16 v[64:67], v[200:203], a[0:3], v[64:67]
    s_add_u32 m0, s40, 52224
    s_waitcnt lgkmcnt(8)
    v_mfma_f32_16x16x32_bf16 v[40:43], v[212:215], a[48:51], v[40:43]
    ds_read_b64_tr_b16 v[200:201], v174 offset:8192
    s_waitcnt lgkmcnt(7)
    v_mfma_f32_16x16x32_bf16 v[40:43], v[216:219], a[64:67], v[40:43]
    ds_read_b64_tr_b16 v[202:203], v174 offset:10240
    s_waitcnt lgkmcnt(6)
    v_mfma_f32_16x16x32_bf16 v[40:43], v[220:223], a[80:83], v[40:43]
    s_add_u32 s75, s41, 4645120
    v_fmac_f32 v34, v184, v234
    v_mfma_f32_16x16x32_bf16 v[44:47], v[220:223], a[84:87], v[44:47]
    buffer_load_dwordx4 v168, s[8:11], s75 offen offset:0  lds
    v_fmac_f32 v35, v184, v235
    v_mfma_f32_16x16x32_bf16 v[44:47], v[216:219], a[68:71], v[44:47]
    ds_read_b64_tr_b16 v[204:205], v171 offset:12288
    v_max_f32 v16, 0, v16
    v_mfma_f32_16x16x32_bf16 v[44:47], v[212:215], a[52:55], v[44:47]
    ds_read_b64_tr_b16 v[206:207], v171 offset:14336
    v_max_f32 v17, 0, v17
    v_mfma_f32_16x16x32_bf16 v[72:75], v[212:215], a[56:59], v[72:75]
    v_max_f32 v18, 0, v18
    v_max_f32 v19, 0, v19
    v_mfma_f32_16x16x32_bf16 v[72:75], v[216:219], a[72:75], v[72:75]
    v_mul_f32 v16, v16, v32
    v_mul_f32 v17, v17, v33
    v_mfma_f32_16x16x32_bf16 v[72:75], v[220:223], a[88:91], v[72:75]
    ds_read_b64_tr_b16 v[208:209], v171 offset:16384
    v_mul_f32 v18, v18, v34
    v_mfma_f32_16x16x32_bf16 v[76:79], v[220:223], a[92:95], v[76:79]
    ds_read_b64_tr_b16 v[210:211], v171 offset:18432
    v_mul_f32 v19, v19, v35
    v_mfma_f32_16x16x32_bf16 v[76:79], v[216:219], a[76:79], v[76:79]
    buffer_load_dwordx4 v169, s[8:11], s75 offen offset:1024  lds
    v_cvt_pk_bf16_f32 v248, v16, v17
    v_mfma_f32_16x16x32_bf16 v[76:79], v[212:215], a[60:63], v[76:79]
    v_cvt_pk_bf16_f32 v249, v18, v19
    s_waitcnt lgkmcnt(8)
    v_mfma_f32_16x16x32_bf16 v[84:87], v[224:227], a[60:63], v[84:87]
    ds_read_b64_tr_b16 v[212:213], v171 offset:20480
    s_waitcnt lgkmcnt(7)
    v_mfma_f32_16x16x32_bf16 v[84:87], v[196:199], a[76:79], v[84:87]
    ds_read_b64_tr_b16 v[214:215], v171 offset:22528
    s_waitcnt lgkmcnt(6)
    v_mfma_f32_16x16x32_bf16 v[84:87], v[200:203], a[92:95], v[84:87]
    v_fmac_f32 v20, v185, v228
    v_fmac_f32 v21, v185, v229
    v_mfma_f32_16x16x32_bf16 v[80:83], v[200:203], a[88:91], v[80:83]
    v_fmac_f32 v22, v185, v230
    v_fmac_f32 v23, v185, v231
    v_mfma_f32_16x16x32_bf16 v[80:83], v[196:199], a[72:75], v[80:83]
    ds_read_b64_tr_b16 v[216:217], v174 offset:12288
    v_fmac_f32 v36, v185, v232
    v_mfma_f32_16x16x32_bf16 v[80:83], v[224:227], a[56:59], v[80:83]
    ds_read_b64_tr_b16 v[218:219], v174 offset:14336
    buffer_load_dwordx4 v170, s[8:11], s75 offen offset:2048  lds
    v_mfma_f32_16x16x32_bf16 v[52:55], v[224:227], a[52:55], v[52:55]
    v_fmac_f32 v37, v185, v233
    v_fmac_f32 v38, v185, v234
    v_mfma_f32_16x16x32_bf16 v[52:55], v[196:199], a[68:71], v[52:55]
    v_fmac_f32 v39, v185, v235
    v_max_f32 v20, 0, v20
    v_mfma_f32_16x16x32_bf16 v[52:55], v[200:203], a[84:87], v[52:55]
    ds_read_b64_tr_b16 v[220:221], v174 offset:16384
    v_max_f32 v21, 0, v21
    v_mfma_f32_16x16x32_bf16 v[48:51], v[200:203], a[80:83], v[48:51]
    ds_read_b64_tr_b16 v[222:223], v174 offset:18432
    v_max_f32 v22, 0, v22
    v_mfma_f32_16x16x32_bf16 v[48:51], v[196:199], a[64:67], v[48:51]
    v_max_f32 v23, 0, v23
    v_mul_f32 v20, v20, v36
    v_mfma_f32_16x16x32_bf16 v[48:51], v[224:227], a[48:51], v[48:51]
    v_mul_f32 v21, v21, v37
    s_waitcnt lgkmcnt(8)
    v_mfma_f32_16x16x32_bf16 v[56:59], v[204:207], a[48:51], v[56:59]
    ds_read_b64_tr_b16 v[224:225], v174 offset:20480
    s_waitcnt lgkmcnt(7)
    v_mfma_f32_16x16x32_bf16 v[56:59], v[208:211], a[64:67], v[56:59]
    ds_read_b64_tr_b16 v[226:227], v174 offset:22528
    s_waitcnt lgkmcnt(6)
    v_mfma_f32_16x16x32_bf16 v[56:59], v[212:215], a[80:83], v[56:59]
    s_add_u32 m0, s40, 98304
    s_add_u32 s75, s41, 384
    v_mfma_f32_16x16x32_bf16 v[60:63], v[212:215], a[84:87], v[60:63]
    v_mul_f32 v22, v22, v38
    v_mul_f32 v23, v23, v39
    v_mfma_f32_16x16x32_bf16 v[60:63], v[208:211], a[68:71], v[60:63]
    v_cvt_pk_bf16_f32 v250, v20, v21
    v_cvt_pk_bf16_f32 v251, v22, v23
    v_mfma_f32_16x16x32_bf16 v[60:63], v[204:207], a[52:55], v[60:63]
    s_add_u32 s72, s52, s62
    v_permlane16_swap_b32 v248, v250
    v_mfma_f32_16x16x32_bf16 v[88:91], v[204:207], a[56:59], v[88:91]
    s_waitcnt vmcnt(22)
    s_barrier
    ds_read_b64_tr_b16 v[196:197], v173 offset:24576
    v_mfma_f32_16x16x32_bf16 v[88:91], v[208:211], a[72:75], v[88:91]
    ds_read_b64_tr_b16 v[198:199], v173 offset:26624
    buffer_load_dwordx4 v168, s[8:11], s75 offen offset:0  lds
    v_mfma_f32_16x16x32_bf16 v[88:91], v[212:215], a[88:91], v[88:91]
    ds_read_b64_tr_b16 v[200:201], v173 offset:28672
    v_permlane16_swap_b32 v249, v251
    v_mfma_f32_16x16x32_bf16 v[92:95], v[212:215], a[92:95], v[92:95]
    ds_read_b64_tr_b16 v[202:203], v173 offset:30720
    buffer_store_dwordx4 v[248:251], v189, s[24:27], s72 offen sc1
    v_mfma_f32_16x16x32_bf16 v[92:95], v[208:211], a[76:79], v[92:95]
    v_mfma_f32_16x16x32_bf16 v[92:95], v[204:207], a[60:63], v[92:95]
    s_waitcnt lgkmcnt(8)
    v_mfma_f32_16x16x32_bf16 v[100:103], v[216:219], a[60:63], v[100:103]
    ds_read_b64_tr_b16 v[204:205], v173 offset:32768
    s_waitcnt lgkmcnt(7)
    v_mfma_f32_16x16x32_bf16 v[100:103], v[220:223], a[76:79], v[100:103]
    ds_read_b64_tr_b16 v[206:207], v173 offset:34816
    s_waitcnt lgkmcnt(6)
    v_mfma_f32_16x16x32_bf16 v[100:103], v[224:227], a[92:95], v[100:103]
    buffer_load_dwordx4 v169, s[8:11], s75 offen offset:1024  lds
    v_mfma_f32_16x16x32_bf16 v[96:99], v[224:227], a[88:91], v[96:99]
    v_mfma_f32_16x16x32_bf16 v[96:99], v[220:223], a[72:75], v[96:99]
    ds_read_b64_tr_b16 v[208:209], v176 offset:24576
    v_mfma_f32_16x16x32_bf16 v[96:99], v[216:219], a[56:59], v[96:99]
    ds_read_b64_tr_b16 v[210:211], v176 offset:26624
    v_mfma_f32_16x16x32_bf16 v[68:71], v[216:219], a[52:55], v[68:71]
    v_mfma_f32_16x16x32_bf16 v[68:71], v[220:223], a[68:71], v[68:71]
    v_mfma_f32_16x16x32_bf16 v[68:71], v[224:227], a[84:87], v[68:71]
    ds_read_b64_tr_b16 v[212:213], v176 offset:28672
    buffer_load_dwordx4 v170, s[8:11], s75 offen offset:2048  lds
    v_mfma_f32_16x16x32_bf16 v[64:67], v[224:227], a[80:83], v[64:67]
    ds_read_b64_tr_b16 v[214:215], v176 offset:30720
    v_mfma_f32_16x16x32_bf16 v[64:67], v[220:223], a[64:67], v[64:67]
    v_mfma_f32_16x16x32_bf16 v[64:67], v[216:219], a[48:51], v[64:67]
    s_add_u32 m0, s40, 101376
    s_waitcnt lgkmcnt(8)
    v_mfma_f32_16x16x32_bf16 v[40:43], v[196:199], a[96:99], v[40:43]
    ds_read_b64_tr_b16 v[216:217], v176 offset:32768
    s_waitcnt lgkmcnt(7)
    v_mfma_f32_16x16x32_bf16 v[40:43], v[200:203], a[112:115], v[40:43]
    ds_read_b64_tr_b16 v[218:219], v176 offset:34816
    s_waitcnt lgkmcnt(6)
    v_mfma_f32_16x16x32_bf16 v[40:43], v[204:207], a[128:131], v[40:43]
    s_add_u32 s75, s41, 221568
    v_mfma_f32_16x16x32_bf16 v[44:47], v[204:207], a[132:135], v[44:47]
    buffer_load_dwordx4 v168, s[8:11], s75 offen offset:0  lds
    v_mfma_f32_16x16x32_bf16 v[44:47], v[200:203], a[116:119], v[44:47]
    ds_read_b64_tr_b16 v[220:221], v173 offset:36864
    v_mfma_f32_16x16x32_bf16 v[44:47], v[196:199], a[100:103], v[44:47]
    ds_read_b64_tr_b16 v[222:223], v173 offset:38912
    v_mfma_f32_16x16x32_bf16 v[72:75], v[196:199], a[104:107], v[72:75]
    v_mfma_f32_16x16x32_bf16 v[72:75], v[200:203], a[120:123], v[72:75]
    v_mfma_f32_16x16x32_bf16 v[72:75], v[204:207], a[136:139], v[72:75]
    ds_read_b64_tr_b16 v[224:225], v173 offset:40960
    v_mfma_f32_16x16x32_bf16 v[76:79], v[204:207], a[140:143], v[76:79]
    ds_read_b64_tr_b16 v[226:227], v173 offset:43008
    v_mfma_f32_16x16x32_bf16 v[76:79], v[200:203], a[124:127], v[76:79]
    buffer_load_dwordx4 v169, s[8:11], s75 offen offset:1024  lds
    v_mfma_f32_16x16x32_bf16 v[76:79], v[196:199], a[108:111], v[76:79]
    s_waitcnt lgkmcnt(8)
    v_mfma_f32_16x16x32_bf16 v[84:87], v[208:211], a[108:111], v[84:87]
    ds_read_b64_tr_b16 v[196:197], v173 offset:45056
    s_waitcnt lgkmcnt(7)
    v_mfma_f32_16x16x32_bf16 v[84:87], v[212:215], a[124:127], v[84:87]
    ds_read_b64_tr_b16 v[198:199], v173 offset:47104
    s_waitcnt lgkmcnt(6)
    v_mfma_f32_16x16x32_bf16 v[84:87], v[216:219], a[140:143], v[84:87]
    v_mfma_f32_16x16x32_bf16 v[80:83], v[216:219], a[136:139], v[80:83]
    v_mfma_f32_16x16x32_bf16 v[80:83], v[212:215], a[120:123], v[80:83]
    ds_read_b64_tr_b16 v[200:201], v176 offset:36864
    v_mfma_f32_16x16x32_bf16 v[80:83], v[208:211], a[104:107], v[80:83]
    ds_read_b64_tr_b16 v[202:203], v176 offset:38912
    buffer_load_dwordx4 v170, s[8:11], s75 offen offset:2048  lds
    v_mfma_f32_16x16x32_bf16 v[52:55], v[208:211], a[100:103], v[52:55]
    v_mfma_f32_16x16x32_bf16 v[52:55], v[212:215], a[116:119], v[52:55]
    v_mfma_f32_16x16x32_bf16 v[52:55], v[216:219], a[132:135], v[52:55]
    ds_read_b64_tr_b16 v[204:205], v176 offset:40960
    v_mfma_f32_16x16x32_bf16 v[48:51], v[216:219], a[128:131], v[48:51]
    ds_read_b64_tr_b16 v[206:207], v176 offset:43008
    v_mfma_f32_16x16x32_bf16 v[48:51], v[212:215], a[112:115], v[48:51]
    v_mfma_f32_16x16x32_bf16 v[48:51], v[208:211], a[96:99], v[48:51]
    s_waitcnt lgkmcnt(8)
    v_mfma_f32_16x16x32_bf16 v[56:59], v[220:223], a[96:99], v[56:59]
    ds_read_b64_tr_b16 v[208:209], v176 offset:45056
    s_waitcnt lgkmcnt(7)
    v_mfma_f32_16x16x32_bf16 v[56:59], v[224:227], a[112:115], v[56:59]
    ds_read_b64_tr_b16 v[210:211], v176 offset:47104
    s_waitcnt lgkmcnt(6)
    v_mfma_f32_16x16x32_bf16 v[56:59], v[196:199], a[128:131], v[56:59]
    s_add_u32 m0, s40, 0
    s_add_u32 s75, s41, 885120
    v_mfma_f32_16x16x32_bf16 v[60:63], v[196:199], a[132:135], v[60:63]
    v_mfma_f32_16x16x32_bf16 v[60:63], v[224:227], a[116:119], v[60:63]
    v_mfma_f32_16x16x32_bf16 v[60:63], v[220:223], a[100:103], v[60:63]
    v_mfma_f32_16x16x32_bf16 v[88:91], v[220:223], a[104:107], v[88:91]
    s_waitcnt vmcnt(21)
    s_barrier
    ds_read_b64_tr_b16 v[212:213], v172 offset:24576
    v_mfma_f32_16x16x32_bf16 v[88:91], v[224:227], a[120:123], v[88:91]
    ds_read_b64_tr_b16 v[214:215], v172 offset:26624
    buffer_load_dwordx4 v168, s[8:11], s75 offen offset:0  lds
    v_mfma_f32_16x16x32_bf16 v[88:91], v[196:199], a[136:139], v[88:91]
    ds_read_b64_tr_b16 v[216:217], v172 offset:28672
    v_mfma_f32_16x16x32_bf16 v[92:95], v[196:199], a[140:143], v[92:95]
    ds_read_b64_tr_b16 v[218:219], v172 offset:30720
    v_mfma_f32_16x16x32_bf16 v[92:95], v[224:227], a[124:127], v[92:95]
    v_mfma_f32_16x16x32_bf16 v[92:95], v[220:223], a[108:111], v[92:95]
    s_waitcnt lgkmcnt(8)
    v_mfma_f32_16x16x32_bf16 v[100:103], v[200:203], a[108:111], v[100:103]
    ds_read_b64_tr_b16 v[220:221], v172 offset:32768
    s_waitcnt lgkmcnt(7)
    v_mfma_f32_16x16x32_bf16 v[100:103], v[204:207], a[124:127], v[100:103]
    ds_read_b64_tr_b16 v[222:223], v172 offset:34816
    s_waitcnt lgkmcnt(6)
    v_mfma_f32_16x16x32_bf16 v[100:103], v[208:211], a[140:143], v[100:103]
    buffer_load_dwordx4 v169, s[8:11], s75 offen offset:1024  lds
    v_mfma_f32_16x16x32_bf16 v[96:99], v[208:211], a[136:139], v[96:99]
    v_mfma_f32_16x16x32_bf16 v[96:99], v[204:207], a[120:123], v[96:99]
    ds_read_b64_tr_b16 v[224:225], v175 offset:24576
    v_mfma_f32_16x16x32_bf16 v[96:99], v[200:203], a[104:107], v[96:99]
    ds_read_b64_tr_b16 v[226:227], v175 offset:26624
    v_mfma_f32_16x16x32_bf16 v[68:71], v[200:203], a[100:103], v[68:71]
    v_mfma_f32_16x16x32_bf16 v[68:71], v[204:207], a[116:119], v[68:71]
    v_mfma_f32_16x16x32_bf16 v[68:71], v[208:211], a[132:135], v[68:71]
    ds_read_b64_tr_b16 v[196:197], v175 offset:28672
    buffer_load_dwordx4 v170, s[8:11], s75 offen offset:2048  lds
    v_mfma_f32_16x16x32_bf16 v[64:67], v[208:211], a[128:131], v[64:67]
    ds_read_b64_tr_b16 v[198:199], v175 offset:30720
    v_mfma_f32_16x16x32_bf16 v[64:67], v[204:207], a[112:115], v[64:67]
    v_mfma_f32_16x16x32_bf16 v[64:67], v[200:203], a[96:99], v[64:67]
    s_add_u32 m0, s40, 3072
    s_waitcnt lgkmcnt(8)
    v_mfma_f32_16x16x32_bf16 v[40:43], v[212:215], a[144:147], v[40:43]
    ds_read_b64_tr_b16 v[200:201], v175 offset:32768
    s_waitcnt lgkmcnt(7)
    v_mfma_f32_16x16x32_bf16 v[40:43], v[216:219], a[160:163], v[40:43]
    ds_read_b64_tr_b16 v[202:203], v175 offset:34816
    s_waitcnt lgkmcnt(6)
    v_mfma_f32_16x16x32_bf16 v[40:43], v[220:223], a[176:179], v[40:43]
    s_add_u32 s75, s41, 1106304
    v_mfma_f32_16x16x32_bf16 v[44:47], v[220:223], a[180:183], v[44:47]
    buffer_load_dwordx4 v168, s[8:11], s75 offen offset:0  lds
    v_mfma_f32_16x16x32_bf16 v[44:47], v[216:219], a[164:167], v[44:47]
    ds_read_b64_tr_b16 v[204:205], v172 offset:36864
    v_mfma_f32_16x16x32_bf16 v[44:47], v[212:215], a[148:151], v[44:47]
    ds_read_b64_tr_b16 v[206:207], v172 offset:38912
    v_mfma_f32_16x16x32_bf16 v[72:75], v[212:215], a[152:155], v[72:75]
    v_mfma_f32_16x16x32_bf16 v[72:75], v[216:219], a[168:171], v[72:75]
    v_mfma_f32_16x16x32_bf16 v[72:75], v[220:223], a[184:187], v[72:75]
    ds_read_b64_tr_b16 v[208:209], v172 offset:40960
    v_mfma_f32_16x16x32_bf16 v[76:79], v[220:223], a[188:191], v[76:79]
    ds_read_b64_tr_b16 v[210:211], v172 offset:43008
    v_mfma_f32_16x16x32_bf16 v[76:79], v[216:219], a[172:175], v[76:79]
    buffer_load_dwordx4 v169, s[8:11], s75 offen offset:1024  lds
    v_mfma_f32_16x16x32_bf16 v[76:79], v[212:215], a[156:159], v[76:79]
    s_waitcnt lgkmcnt(8)
    v_mfma_f32_16x16x32_bf16 v[84:87], v[224:227], a[156:159], v[84:87]
    ds_read_b64_tr_b16 v[212:213], v172 offset:45056
    s_waitcnt lgkmcnt(7)
    v_mfma_f32_16x16x32_bf16 v[84:87], v[196:199], a[172:175], v[84:87]
    ds_read_b64_tr_b16 v[214:215], v172 offset:47104
    s_waitcnt lgkmcnt(6)
    v_mfma_f32_16x16x32_bf16 v[84:87], v[200:203], a[188:191], v[84:87]
    v_mfma_f32_16x16x32_bf16 v[80:83], v[200:203], a[184:187], v[80:83]
    v_mfma_f32_16x16x32_bf16 v[80:83], v[196:199], a[168:171], v[80:83]
    ds_read_b64_tr_b16 v[216:217], v175 offset:36864
    v_mfma_f32_16x16x32_bf16 v[80:83], v[224:227], a[152:155], v[80:83]
    ds_read_b64_tr_b16 v[218:219], v175 offset:38912
    buffer_load_dwordx4 v170, s[8:11], s75 offen offset:2048  lds
    v_mfma_f32_16x16x32_bf16 v[52:55], v[224:227], a[148:151], v[52:55]
    v_mfma_f32_16x16x32_bf16 v[52:55], v[196:199], a[164:167], v[52:55]
    v_mfma_f32_16x16x32_bf16 v[52:55], v[200:203], a[180:183], v[52:55]
    ds_read_b64_tr_b16 v[220:221], v175 offset:40960
    v_mfma_f32_16x16x32_bf16 v[48:51], v[200:203], a[176:179], v[48:51]
    ds_read_b64_tr_b16 v[222:223], v175 offset:43008
    v_mfma_f32_16x16x32_bf16 v[48:51], v[196:199], a[160:163], v[48:51]
    v_mfma_f32_16x16x32_bf16 v[48:51], v[224:227], a[144:147], v[48:51]
    s_waitcnt lgkmcnt(8)
    v_mfma_f32_16x16x32_bf16 v[56:59], v[204:207], a[144:147], v[56:59]
    ds_read_b64_tr_b16 v[224:225], v175 offset:45056
    s_waitcnt lgkmcnt(7)
    v_mfma_f32_16x16x32_bf16 v[56:59], v[208:211], a[160:163], v[56:59]
    ds_read_b64_tr_b16 v[226:227], v175 offset:47104
    s_waitcnt lgkmcnt(6)
    v_mfma_f32_16x16x32_bf16 v[56:59], v[212:215], a[176:179], v[56:59]
    s_add_u32 m0, s40, 122880
    s_add_u32 s75, s41, 1769856
    v_mfma_f32_16x16x32_bf16 v[60:63], v[212:215], a[180:183], v[60:63]
    v_mfma_f32_16x16x32_bf16 v[60:63], v[208:211], a[164:167], v[60:63]
    v_mfma_f32_16x16x32_bf16 v[60:63], v[204:207], a[148:151], v[60:63]
    v_mfma_f32_16x16x32_bf16 v[88:91], v[204:207], a[152:155], v[88:91]
    s_waitcnt vmcnt(11)
    s_barrier
    s_cmp_lg_u32 s36, 0
    s_cbranch_scc1 PUB_34
    s_mov_b64 exec, 1
    v_mov_b32 v192, s3
    buffer_store_dword v192, v4, s[24:27], s66 offen offset:0 sc1
    s_mov_b64 exec, -1
PUB_34:
    ds_read_b64_tr_b16 v[196:197], v171 offset:24576
    v_mfma_f32_16x16x32_bf16 v[88:91], v[208:211], a[168:171], v[88:91]
    ds_read_b64_tr_b16 v[198:199], v171 offset:26624
    buffer_load_dwordx4 v168, s[8:11], s75 offen offset:0  lds
    v_mfma_f32_16x16x32_bf16 v[88:91], v[212:215], a[184:187], v[88:91]
    ds_read_b64_tr_b16 v[200:201], v171 offset:28672
    v_mfma_f32_16x16x32_bf16 v[92:95], v[212:215], a[188:191], v[92:95]
    ds_read_b64_tr_b16 v[202:203], v171 offset:30720
    v_mfma_f32_16x16x32_bf16 v[92:95], v[208:211], a[172:175], v[92:95]
    v_mfma_f32_16x16x32_bf16 v[92:95], v[204:207], a[156:159], v[92:95]
    s_waitcnt lgkmcnt(8)
    v_mfma_f32_16x16x32_bf16 v[100:103], v[216:219], a[156:159], v[100:103]
    ds_read_b64_tr_b16 v[204:205], v171 offset:32768
    s_waitcnt lgkmcnt(7)
    v_mfma_f32_16x16x32_bf16 v[100:103], v[220:223], a[172:175], v[100:103]
    ds_read_b64_tr_b16 v[206:207], v171 offset:34816
    s_waitcnt lgkmcnt(6)
    v_mfma_f32_16x16x32_bf16 v[100:103], v[224:227], a[188:191], v[100:103]
    buffer_load_dwordx4 v169, s[8:11], s75 offen offset:1024  lds
    v_mfma_f32_16x16x32_bf16 v[96:99], v[224:227], a[184:187], v[96:99]
    v_mfma_f32_16x16x32_bf16 v[96:99], v[220:223], a[168:171], v[96:99]
    ds_read_b64_tr_b16 v[208:209], v174 offset:24576
    v_mfma_f32_16x16x32_bf16 v[96:99], v[216:219], a[152:155], v[96:99]
    ds_read_b64_tr_b16 v[210:211], v174 offset:26624
    v_mfma_f32_16x16x32_bf16 v[68:71], v[216:219], a[148:151], v[68:71]
    v_mfma_f32_16x16x32_bf16 v[68:71], v[220:223], a[164:167], v[68:71]
    v_mfma_f32_16x16x32_bf16 v[68:71], v[224:227], a[180:183], v[68:71]
    ds_read_b64_tr_b16 v[212:213], v174 offset:28672
    buffer_load_dwordx4 v170, s[8:11], s75 offen offset:2048  lds
    v_mfma_f32_16x16x32_bf16 v[64:67], v[224:227], a[176:179], v[64:67]
    ds_read_b64_tr_b16 v[214:215], v174 offset:30720
    v_mfma_f32_16x16x32_bf16 v[64:67], v[220:223], a[160:163], v[64:67]
    v_mfma_f32_16x16x32_bf16 v[64:67], v[216:219], a[144:147], v[64:67]
    s_add_u32 m0, s40, 125952
    s_waitcnt lgkmcnt(8)
    v_mfma_f32_16x16x32_bf16 v[40:43], v[196:199], a[192:195], v[40:43]
    ds_read_b64_tr_b16 v[216:217], v174 offset:32768
    s_waitcnt lgkmcnt(7)
    v_mfma_f32_16x16x32_bf16 v[40:43], v[200:203], a[208:211], v[40:43]
    ds_read_b64_tr_b16 v[218:219], v174 offset:34816
    s_waitcnt lgkmcnt(6)
    v_mfma_f32_16x16x32_bf16 v[40:43], v[204:207], a[224:227], v[40:43]
    s_add_u32 s75, s41, 1991040
    v_mfma_f32_16x16x32_bf16 v[44:47], v[204:207], a[228:231], v[44:47]
    buffer_load_dwordx4 v168, s[8:11], s75 offen offset:0  lds
    v_mfma_f32_16x16x32_bf16 v[44:47], v[200:203], a[212:215], v[44:47]
    ds_read_b64_tr_b16 v[220:221], v171 offset:36864
    v_mfma_f32_16x16x32_bf16 v[44:47], v[196:199], a[196:199], v[44:47]
    ds_read_b64_tr_b16 v[222:223], v171 offset:38912
    v_mfma_f32_16x16x32_bf16 v[72:75], v[196:199], a[200:203], v[72:75]
    v_mfma_f32_16x16x32_bf16 v[72:75], v[200:203], a[216:219], v[72:75]
    v_mfma_f32_16x16x32_bf16 v[72:75], v[204:207], a[232:235], v[72:75]
    ds_read_b64_tr_b16 v[224:225], v171 offset:40960
    v_mfma_f32_16x16x32_bf16 v[76:79], v[204:207], a[236:239], v[76:79]
    ds_read_b64_tr_b16 v[226:227], v171 offset:43008
    v_mfma_f32_16x16x32_bf16 v[76:79], v[200:203], a[220:223], v[76:79]
    buffer_load_dwordx4 v169, s[8:11], s75 offen offset:1024  lds
    v_mfma_f32_16x16x32_bf16 v[76:79], v[196:199], a[204:207], v[76:79]
    s_waitcnt lgkmcnt(8)
    v_mfma_f32_16x16x32_bf16 v[84:87], v[208:211], a[204:207], v[84:87]
    ds_read_b64_tr_b16 v[196:197], v171 offset:45056
    s_waitcnt lgkmcnt(7)
    v_mfma_f32_16x16x32_bf16 v[84:87], v[212:215], a[220:223], v[84:87]
    ds_read_b64_tr_b16 v[198:199], v171 offset:47104
    s_waitcnt lgkmcnt(6)
    v_mfma_f32_16x16x32_bf16 v[84:87], v[216:219], a[236:239], v[84:87]
    v_mfma_f32_16x16x32_bf16 v[80:83], v[216:219], a[232:235], v[80:83]
    v_mfma_f32_16x16x32_bf16 v[80:83], v[212:215], a[216:219], v[80:83]
    ds_read_b64_tr_b16 v[200:201], v174 offset:36864
    v_mfma_f32_16x16x32_bf16 v[80:83], v[208:211], a[200:203], v[80:83]
    ds_read_b64_tr_b16 v[202:203], v174 offset:38912
    buffer_load_dwordx4 v170, s[8:11], s75 offen offset:2048  lds
    v_mfma_f32_16x16x32_bf16 v[52:55], v[208:211], a[196:199], v[52:55]
    v_mfma_f32_16x16x32_bf16 v[52:55], v[212:215], a[212:215], v[52:55]
    v_mfma_f32_16x16x32_bf16 v[52:55], v[216:219], a[228:231], v[52:55]
    ds_read_b64_tr_b16 v[204:205], v174 offset:40960
    v_mfma_f32_16x16x32_bf16 v[48:51], v[216:219], a[224:227], v[48:51]
    ds_read_b64_tr_b16 v[206:207], v174 offset:43008
    v_mfma_f32_16x16x32_bf16 v[48:51], v[212:215], a[208:211], v[48:51]
    v_mfma_f32_16x16x32_bf16 v[48:51], v[208:211], a[192:195], v[48:51]
    s_waitcnt lgkmcnt(8)
    v_mfma_f32_16x16x32_bf16 v[56:59], v[220:223], a[192:195], v[56:59]
    ds_read_b64_tr_b16 v[208:209], v174 offset:45056
    s_waitcnt lgkmcnt(7)
    v_mfma_f32_16x16x32_bf16 v[56:59], v[224:227], a[208:211], v[56:59]
    ds_read_b64_tr_b16 v[210:211], v174 offset:47104
    s_waitcnt lgkmcnt(6)
    v_mfma_f32_16x16x32_bf16 v[56:59], v[196:199], a[224:227], v[56:59]
    s_add_u32 m0, s40, 73728
    s_add_u32 s75, s41, 2654592
    v_mfma_f32_16x16x32_bf16 v[60:63], v[196:199], a[228:231], v[60:63]
    v_mfma_f32_16x16x32_bf16 v[60:63], v[224:227], a[212:215], v[60:63]
    v_mfma_f32_16x16x32_bf16 v[60:63], v[220:223], a[196:199], v[60:63]
    v_mfma_f32_16x16x32_bf16 v[88:91], v[220:223], a[200:203], v[88:91]
    s_barrier
    ds_read_b64_tr_b16 v[212:213], v172 offset:0
    v_mfma_f32_16x16x32_bf16 v[88:91], v[224:227], a[216:219], v[88:91]
    ds_read_b64_tr_b16 v[214:215], v172 offset:2048
    buffer_load_dwordx4 v168, s[8:11], s75 offen offset:0  lds
    v_mfma_f32_16x16x32_bf16 v[88:91], v[196:199], a[232:235], v[88:91]
    ds_read_b64_tr_b16 v[216:217], v172 offset:4096
    v_mfma_f32_16x16x32_bf16 v[92:95], v[196:199], a[236:239], v[92:95]
    ds_read_b64_tr_b16 v[218:219], v172 offset:6144
    v_mfma_f32_16x16x32_bf16 v[92:95], v[224:227], a[220:223], v[92:95]
    v_mfma_f32_16x16x32_bf16 v[92:95], v[220:223], a[204:207], v[92:95]
    s_waitcnt lgkmcnt(8)
    v_mfma_f32_16x16x32_bf16 v[100:103], v[200:203], a[204:207], v[100:103]
    ds_read_b64_tr_b16 v[220:221], v172 offset:8192
    s_waitcnt lgkmcnt(7)
    v_mfma_f32_16x16x32_bf16 v[100:103], v[204:207], a[220:223], v[100:103]
    ds_read_b64_tr_b16 v[222:223], v172 offset:10240
    s_waitcnt lgkmcnt(6)
    v_mfma_f32_16x16x32_bf16 v[100:103], v[208:211], a[236:239], v[100:103]
    buffer_load_dwordx4 v169, s[8:11], s75 offen offset:1024  lds
    v_mfma_f32_16x16x32_bf16 v[96:99], v[208:211], a[232:235], v[96:99]
    v_mfma_f32_16x16x32_bf16 v[96:99], v[204:207], a[216:219], v[96:99]
    ds_read_b64_tr_b16 v[224:225], v175 offset:0
    v_mfma_f32_16x16x32_bf16 v[96:99], v[200:203], a[200:203], v[96:99]
    ds_read_b64_tr_b16 v[226:227], v175 offset:2048
    v_mfma_f32_16x16x32_bf16 v[68:71], v[200:203], a[196:199], v[68:71]
    v_mfma_f32_16x16x32_bf16 v[68:71], v[204:207], a[212:215], v[68:71]
    v_mfma_f32_16x16x32_bf16 v[68:71], v[208:211], a[228:231], v[68:71]
    ds_read_b64_tr_b16 v[196:197], v175 offset:4096
    buffer_load_dwordx4 v170, s[8:11], s75 offen offset:2048  lds
    v_mfma_f32_16x16x32_bf16 v[64:67], v[208:211], a[224:227], v[64:67]
    ds_read_b64_tr_b16 v[198:199], v175 offset:6144
    v_mfma_f32_16x16x32_bf16 v[64:67], v[204:207], a[208:211], v[64:67]
    v_mfma_f32_16x16x32_bf16 v[64:67], v[200:203], a[192:195], v[64:67]
    s_add_u32 m0, s40, 76800
    s_waitcnt lgkmcnt(8)
    v_mfma_f32_16x16x32_bf16 v[40:43], v[212:215], a[240:243], v[40:43]
    ds_read_b64_tr_b16 v[200:201], v175 offset:8192
    s_waitcnt lgkmcnt(7)
    v_mfma_f32_16x16x32_bf16 v[40:43], v[216:219], v[136:139], v[40:43]
    ds_read_b64_tr_b16 v[202:203], v175 offset:10240
    s_waitcnt lgkmcnt(6)
    v_mfma_f32_16x16x32_bf16 v[40:43], v[220:223], v[152:155], v[40:43]
    s_add_u32 s75, s41, 2875776
    v_mfma_f32_16x16x32_bf16 v[44:47], v[220:223], v[156:159], v[44:47]
    buffer_load_dwordx4 v168, s[8:11], s75 offen offset:0  lds
    v_mfma_f32_16x16x32_bf16 v[44:47], v[216:219], v[140:143], v[44:47]
    ds_read_b64_tr_b16 v[204:205], v172 offset:12288
    v_mfma_f32_16x16x32_bf16 v[44:47], v[212:215], a[244:247], v[44:47]
    ds_read_b64_tr_b16 v[206:207], v172 offset:14336
    v_mfma_f32_16x16x32_bf16 v[72:75], v[212:215], a[248:251], v[72:75]
    v_mfma_f32_16x16x32_bf16 v[72:75], v[216:219], v[144:147], v[72:75]
    v_mfma_f32_16x16x32_bf16 v[72:75], v[220:223], v[160:163], v[72:75]
    ds_read_b64_tr_b16 v[208:209], v172 offset:16384
    v_mfma_f32_16x16x32_bf16 v[76:79], v[220:223], v[164:167], v[76:79]
    ds_read_b64_tr_b16 v[210:211], v172 offset:18432
    v_mfma_f32_16x16x32_bf16 v[76:79], v[216:219], v[148:151], v[76:79]
    buffer_load_dwordx4 v169, s[8:11], s75 offen offset:1024  lds
    v_mfma_f32_16x16x32_bf16 v[76:79], v[212:215], a[252:255], v[76:79]
    s_waitcnt lgkmcnt(8)
    v_mfma_f32_16x16x32_bf16 v[84:87], v[224:227], a[252:255], v[84:87]
    ds_read_b64_tr_b16 v[212:213], v172 offset:20480
    s_waitcnt lgkmcnt(7)
    v_mfma_f32_16x16x32_bf16 v[84:87], v[196:199], v[148:151], v[84:87]
    ds_read_b64_tr_b16 v[214:215], v172 offset:22528
    s_waitcnt lgkmcnt(6)
    v_mfma_f32_16x16x32_bf16 v[84:87], v[200:203], v[164:167], v[84:87]
    v_mfma_f32_16x16x32_bf16 v[80:83], v[200:203], v[160:163], v[80:83]
    v_mfma_f32_16x16x32_bf16 v[80:83], v[196:199], v[144:147], v[80:83]
    ds_read_b64_tr_b16 v[216:217], v175 offset:12288
    v_mfma_f32_16x16x32_bf16 v[80:83], v[224:227], a[248:251], v[80:83]
    ds_read_b64_tr_b16 v[218:219], v175 offset:14336
    buffer_load_dwordx4 v170, s[8:11], s75 offen offset:2048  lds
    v_mfma_f32_16x16x32_bf16 v[52:55], v[224:227], a[244:247], v[52:55]
    v_mfma_f32_16x16x32_bf16 v[52:55], v[196:199], v[140:143], v[52:55]
    v_mfma_f32_16x16x32_bf16 v[52:55], v[200:203], v[156:159], v[52:55]
    ds_read_b64_tr_b16 v[220:221], v175 offset:16384
    v_mfma_f32_16x16x32_bf16 v[48:51], v[200:203], v[152:155], v[48:51]
    ds_read_b64_tr_b16 v[222:223], v175 offset:18432
    v_mfma_f32_16x16x32_bf16 v[48:51], v[196:199], v[136:139], v[48:51]
    v_mfma_f32_16x16x32_bf16 v[48:51], v[224:227], a[240:243], v[48:51]
    s_waitcnt lgkmcnt(8)
    v_mfma_f32_16x16x32_bf16 v[56:59], v[204:207], a[240:243], v[56:59]
    ds_read_b64_tr_b16 v[224:225], v175 offset:20480
    s_waitcnt lgkmcnt(7)
    v_mfma_f32_16x16x32_bf16 v[56:59], v[208:211], v[136:139], v[56:59]
    ds_read_b64_tr_b16 v[226:227], v175 offset:22528
    s_waitcnt lgkmcnt(6)
    v_mfma_f32_16x16x32_bf16 v[56:59], v[212:215], v[152:155], v[56:59]
    s_add_u32 m0, s40, 24576
    s_add_u32 s75, s41, 3539328
    v_mfma_f32_16x16x32_bf16 v[60:63], v[212:215], v[156:159], v[60:63]
    v_mfma_f32_16x16x32_bf16 v[60:63], v[208:211], v[140:143], v[60:63]
    v_mfma_f32_16x16x32_bf16 v[60:63], v[204:207], a[244:247], v[60:63]
    v_mfma_f32_16x16x32_bf16 v[88:91], v[204:207], a[248:251], v[88:91]
    s_waitcnt vmcnt(18)
    s_barrier
    ds_read_b64_tr_b16 v[196:197], v173 offset:0
    v_mfma_f32_16x16x32_bf16 v[88:91], v[208:211], v[144:147], v[88:91]
    ds_read_b64_tr_b16 v[198:199], v173 offset:2048
    buffer_load_dwordx4 v168, s[8:11], s75 offen offset:0  lds
    v_mfma_f32_16x16x32_bf16 v[88:91], v[212:215], v[160:163], v[88:91]
    ds_read_b64_tr_b16 v[200:201], v173 offset:4096
    v_mfma_f32_16x16x32_bf16 v[92:95], v[212:215], v[164:167], v[92:95]
    ds_read_b64_tr_b16 v[202:203], v173 offset:6144
    v_mfma_f32_16x16x32_bf16 v[92:95], v[208:211], v[148:151], v[92:95]
    v_mfma_f32_16x16x32_bf16 v[92:95], v[204:207], a[252:255], v[92:95]
    s_waitcnt lgkmcnt(8)
    v_mfma_f32_16x16x32_bf16 v[100:103], v[216:219], a[252:255], v[100:103]
    ds_read_b64_tr_b16 v[204:205], v173 offset:8192
    s_waitcnt lgkmcnt(7)
    v_mfma_f32_16x16x32_bf16 v[100:103], v[220:223], v[148:151], v[100:103]
    ds_read_b64_tr_b16 v[206:207], v173 offset:10240
    v_add_u32 v252, 147456, v3
    s_waitcnt lgkmcnt(6)
    v_mfma_f32_16x16x32_bf16 v[100:103], v[224:227], v[164:167], v[100:103]
    buffer_load_dwordx4 v169, s[8:11], s75 offen offset:1024  lds
    v_mfma_f32_16x16x32_bf16 v[96:99], v[224:227], v[160:163], v[96:99]
    v_mfma_f32_16x16x32_bf16 v[96:99], v[220:223], v[144:147], v[96:99]
    ds_read_b64_tr_b16 v[208:209], v176 offset:0
    v_mfma_f32_16x16x32_bf16 v[96:99], v[216:219], a[248:251], v[96:99]
    ds_read_b64_tr_b16 v[210:211], v176 offset:2048
    v_mfma_f32_16x16x32_bf16 v[68:71], v[216:219], a[244:247], v[68:71]
    v_mfma_f32_16x16x32_bf16 v[68:71], v[220:223], v[140:143], v[68:71]
    v_mfma_f32_16x16x32_bf16 v[68:71], v[224:227], v[156:159], v[68:71]
    ds_read_b64_tr_b16 v[212:213], v176 offset:4096
    buffer_load_dwordx4 v170, s[8:11], s75 offen offset:2048  lds
    v_mfma_f32_16x16x32_bf16 v[64:67], v[224:227], v[152:155], v[64:67]
    ds_read_b64_tr_b16 v[214:215], v176 offset:6144
    v_mfma_f32_16x16x32_bf16 v[64:67], v[220:223], v[136:139], v[64:67]
    v_mfma_f32_16x16x32_bf16 v[64:67], v[216:219], a[240:243], v[64:67]
    s_add_u32 m0, s40, 27648
    s_waitcnt lgkmcnt(8)
    v_mfma_f32_16x16x32_bf16 v[104:107], v[196:199], a[0:3], 0
    ds_read_b64_tr_b16 v[216:217], v176 offset:8192
    s_waitcnt lgkmcnt(7)
    v_mfma_f32_16x16x32_bf16 v[104:107], v[200:203], a[16:19], v[104:107]
    ds_read_b64_tr_b16 v[218:219], v176 offset:10240
    s_waitcnt lgkmcnt(6)
    v_mfma_f32_16x16x32_bf16 v[104:107], v[204:207], a[32:35], v[104:107]
    s_add_u32 s75, s41, 3760512
    v_mfma_f32_16x16x32_bf16 v[108:111], v[204:207], a[36:39], 0
    buffer_load_dwordx4 v168, s[8:11], s75 offen offset:0  lds
    ds_read_b128 v[228:231], v180 offset:512
    ds_read_b128 v[232:235], v180 offset:576
    v_mfma_f32_16x16x32_bf16 v[108:111], v[200:203], a[20:23], v[108:111]
    ds_read_b64_tr_b16 v[220:221], v173 offset:12288
    ds_read_b128 v[236:239], v180 offset:1792
    ds_read_b128 v[240:243], v180 offset:1856
    v_mfma_f32_16x16x32_bf16 v[108:111], v[196:199], a[4:7], v[108:111]
    ds_read_b64_tr_b16 v[222:223], v173 offset:14336
    v_mfma_f32_16x16x32_bf16 v[8:11], v[196:199], a[8:11], 0
    v_mfma_f32_16x16x32_bf16 v[8:11], v[200:203], a[24:27], v[8:11]
    s_waitcnt lgkmcnt(1)
    v_fmac_f32 v40, v182, v228
    v_fmac_f32 v41, v182, v229
    v_mfma_f32_16x16x32_bf16 v[8:11], v[204:207], a[40:43], v[8:11]
    ds_read_b64_tr_b16 v[224:225], v173 offset:16384
    buffer_load_dword v193, v190, s[24:27], s65 offen offset:0 sc1
    v_fmac_f32 v42, v182, v230
    v_mfma_f32_16x16x32_bf16 v[12:15], v[204:207], a[44:47], 0
    ds_read_b64_tr_b16 v[226:227], v173 offset:18432
    v_fmac_f32 v43, v182, v231
    v_fmac_f32 v48, v182, v232
    v_mfma_f32_16x16x32_bf16 v[12:15], v[200:203], a[28:31], v[12:15]
    buffer_load_dwordx4 v169, s[8:11], s75 offen offset:1024  lds
    v_fmac_f32 v49, v182, v233
    v_fmac_f32 v50, v182, v234
    v_mfma_f32_16x16x32_bf16 v[12:15], v[196:199], a[12:15], v[12:15]
    v_fmac_f32 v51, v182, v235
    v_fmac_f32 v56, v182, v236
    v_fmac_f32 v57, v182, v237
    v_mfma_f32_16x16x32_bf16 v[20:23], v[208:211], a[12:15], 0
    ds_read_b64_tr_b16 v[196:197], v173 offset:20480
    v_fmac_f32 v58, v182, v238
    v_fmac_f32 v59, v182, v239
    v_mfma_f32_16x16x32_bf16 v[20:23], v[212:215], a[28:31], v[20:23]
    ds_read_b64_tr_b16 v[198:199], v173 offset:22528
    v_fmac_f32 v64, v182, v240
    v_fmac_f32 v65, v182, v241
    v_mfma_f32_16x16x32_bf16 v[20:23], v[216:219], a[44:47], v[20:23]
    v_fmac_f32 v66, v182, v242
    v_fmac_f32 v67, v182, v243
    v_max_f32 v40, 0, v40
    v_mfma_f32_16x16x32_bf16 v[16:19], v[216:219], a[40:43], 0
    v_max_f32 v41, 0, v41
    v_max_f32 v42, 0, v42
    v_max_f32 v43, 0, v43
    v_mfma_f32_16x16x32_bf16 v[16:19], v[212:215], a[24:27], v[16:19]
    ds_read_b64_tr_b16 v[200:201], v176 offset:12288
    v_max_f32 v48, 0, v48
    v_max_f32 v49, 0, v49
    v_mfma_f32_16x16x32_bf16 v[16:19], v[208:211], a[8:11], v[16:19]
    ds_read_b64_tr_b16 v[202:203], v176 offset:14336
    buffer_load_dwordx4 v170, s[8:11], s75 offen offset:2048  lds
    v_max_f32 v50, 0, v50
    v_mfma_f32_16x16x32_bf16 v[116:119], v[208:211], a[4:7], 0
    v_max_f32 v51, 0, v51
    v_mul_f32 v40, v40, v56
    v_mul_f32 v41, v41, v57
    v_mfma_f32_16x16x32_bf16 v[116:119], v[212:215], a[20:23], v[116:119]
    v_mul_f32 v42, v42, v58
    v_mul_f32 v43, v43, v59
    v_mul_f32 v48, v48, v64
    v_mfma_f32_16x16x32_bf16 v[116:119], v[216:219], a[36:39], v[116:119]
    ds_read_b64_tr_b16 v[204:205], v176 offset:16384
    v_mul_f32 v49, v49, v65
    v_mul_f32 v50, v50, v66
    v_mfma_f32_16x16x32_bf16 v[112:115], v[216:219], a[32:35], 0
    ds_read_b64_tr_b16 v[206:207], v176 offset:18432
    v_mul_f32 v51, v51, v67
    v_cvt_pk_bf16_f32 v244, v40, v41
    v_mfma_f32_16x16x32_bf16 v[112:115], v[212:215], a[16:19], v[112:115]
    v_cvt_pk_bf16_f32 v245, v42, v43
    v_cvt_pk_bf16_f32 v246, v48, v49
    v_cvt_pk_bf16_f32 v247, v50, v51
    v_mfma_f32_16x16x32_bf16 v[112:115], v[208:211], a[0:3], v[112:115]
    s_add_u32 s50, s50, 4096
    buffer_store_dwordx4 v[244:247], v3, s[24:27], s50 offen offset:0 sc1
    s_waitcnt lgkmcnt(8)
    v_mfma_f32_16x16x32_bf16 v[120:123], v[220:223], a[0:3], 0
    ds_read_b64_tr_b16 v[208:209], v176 offset:20480
    v_fmac_f32 v44, v183, v228
    s_waitcnt lgkmcnt(7)
    v_mfma_f32_16x16x32_bf16 v[120:123], v[224:227], a[16:19], v[120:123]
    ds_read_b64_tr_b16 v[210:211], v176 offset:22528
    v_fmac_f32 v45, v183, v229
    s_waitcnt lgkmcnt(6)
    v_mfma_f32_16x16x32_bf16 v[120:123], v[196:199], a[32:35], v[120:123]
    s_add_u32 m0, s40, 49152
    s_add_u32 s75, s41, 4424064
    v_fmac_f32 v46, v183, v230
    v_mfma_f32_16x16x32_bf16 v[124:127], v[196:199], a[36:39], 0
    v_fmac_f32 v47, v183, v231
    v_fmac_f32 v52, v183, v232
    v_fmac_f32 v53, v183, v233
    v_mfma_f32_16x16x32_bf16 v[124:127], v[224:227], a[20:23], v[124:127]
    v_fmac_f32 v54, v183, v234
    v_fmac_f32 v55, v183, v235
    v_fmac_f32 v60, v183, v236
    v_mfma_f32_16x16x32_bf16 v[124:127], v[220:223], a[4:7], v[124:127]
    v_fmac_f32 v61, v183, v237
    v_fmac_f32 v62, v183, v238
    v_fmac_f32 v63, v183, v239
    v_mfma_f32_16x16x32_bf16 v[24:27], v[220:223], a[8:11], 0
    s_waitcnt vmcnt(20)
    s_barrier
    ds_read_b64_tr_b16 v[212:213], v171 offset:0
    v_mfma_f32_16x16x32_bf16 v[24:27], v[224:227], a[24:27], v[24:27]
    ds_read_b64_tr_b16 v[214:215], v171 offset:2048
    buffer_load_dwordx4 v168, s[8:11], s75 offen offset:0  lds
    v_fmac_f32 v68, v183, v240
    v_mfma_f32_16x16x32_bf16 v[24:27], v[196:199], a[40:43], v[24:27]
    ds_read_b64_tr_b16 v[216:217], v171 offset:4096
    v_fmac_f32 v69, v183, v241
    v_fmac_f32 v70, v183, v242
    v_mfma_f32_16x16x32_bf16 v[28:31], v[196:199], a[44:47], 0
    ds_read_b64_tr_b16 v[218:219], v171 offset:6144
    v_fmac_f32 v71, v183, v243
    v_max_f32 v44, 0, v44
    v_mfma_f32_16x16x32_bf16 v[28:31], v[224:227], a[28:31], v[28:31]
    v_max_f32 v45, 0, v45
    v_max_f32 v46, 0, v46
    v_max_f32 v47, 0, v47
    v_mfma_f32_16x16x32_bf16 v[28:31], v[220:223], a[12:15], v[28:31]
    v_lshlrev_b32 v194, 2, v3
    v_max_f32 v52, 0, v52
    s_waitcnt lgkmcnt(8)
    v_mfma_f32_16x16x32_bf16 v[36:39], v[200:203], a[12:15], 0
    ds_read_b64_tr_b16 v[220:221], v171 offset:8192
    buffer_load_dword v193, v194, s[24:27], s18 offen offset:0 sc1
    s_waitcnt lgkmcnt(7)
    v_mfma_f32_16x16x32_bf16 v[36:39], v[204:207], a[28:31], v[36:39]
    ds_read_b64_tr_b16 v[222:223], v171 offset:10240
    v_max_f32 v53, 0, v53
    s_waitcnt lgkmcnt(6)
    v_mfma_f32_16x16x32_bf16 v[36:39], v[208:211], a[44:47], v[36:39]
    buffer_load_dwordx4 v169, s[8:11], s75 offen offset:1024  lds
    v_max_f32 v54, 0, v54
    v_max_f32 v55, 0, v55
    v_mfma_f32_16x16x32_bf16 v[32:35], v[208:211], a[40:43], 0
    v_mul_f32 v44, v44, v60
    v_mul_f32 v45, v45, v61
    v_mul_f32 v46, v46, v62
    v_mfma_f32_16x16x32_bf16 v[32:35], v[204:207], a[24:27], v[32:35]
    ds_read_b64_tr_b16 v[224:225], v174 offset:0
    v_mul_f32 v47, v47, v63
    v_mul_f32 v52, v52, v68
    v_mfma_f32_16x16x32_bf16 v[32:35], v[200:203], a[8:11], v[32:35]
    ds_read_b64_tr_b16 v[226:227], v174 offset:2048
    v_mul_f32 v53, v53, v69
    v_mul_f32 v54, v54, v70
    v_mfma_f32_16x16x32_bf16 v[132:135], v[200:203], a[4:7], 0
    v_mul_f32 v55, v55, v71
    v_cvt_pk_bf16_f32 v248, v44, v45
    v_cvt_pk_bf16_f32 v249, v46, v47
    v_mfma_f32_16x16x32_bf16 v[132:135], v[204:207], a[20:23], v[132:135]
    v_cvt_pk_bf16_f32 v250, v52, v53
    v_cvt_pk_bf16_f32 v251, v54, v55
    s_add_u32 s51, s51, 4096
    buffer_store_dwordx4 v[248:251], v3, s[24:27], s51 offen offset:0 sc1
    v_mfma_f32_16x16x32_bf16 v[132:135], v[208:211], a[36:39], v[132:135]
    ds_read_b64_tr_b16 v[196:197], v174 offset:4096
    buffer_load_dwordx4 v170, s[8:11], s75 offen offset:2048  lds
    v_fmac_f32 v72, v184, v228
    v_mfma_f32_16x16x32_bf16 v[128:131], v[208:211], a[32:35], 0
    ds_read_b64_tr_b16 v[198:199], v174 offset:6144
    s_add_u32 s73, s63, 0
    v_fmac_f32 v73, v184, v229
    v_mfma_f32_16x16x32_bf16 v[128:131], v[204:207], a[16:19], v[128:131]
    v_fmac_f32 v74, v184, v230
    v_fmac_f32 v75, v184, v231
    v_fmac_f32 v80, v184, v232
    v_mfma_f32_16x16x32_bf16 v[128:131], v[200:203], a[0:3], v[128:131]
    s_waitcnt vmcnt(8)
    v_cmp_ne_u32 vcc, s3, v193
    s_cbranch_vccnz SLOW_35
BACK_36:
    s_waitcnt lgkmcnt(8)
    v_mfma_f32_16x16x32_bf16 v[104:107], v[212:215], a[48:51], v[104:107]
    ds_read_b64_tr_b16 v[200:201], v174 offset:8192
    v_fmac_f32 v81, v184, v233
    s_waitcnt lgkmcnt(7)
    v_mfma_f32_16x16x32_bf16 v[104:107], v[216:219], a[64:67], v[104:107]
    ds_read_b64_tr_b16 v[202:203], v174 offset:10240
    v_fmac_f32 v82, v184, v234
    s_waitcnt lgkmcnt(6)
    v_mfma_f32_16x16x32_bf16 v[104:107], v[220:223], a[80:83], v[104:107]
    s_add_u32 m0, s40, 52224
    s_add_u32 s75, s41, 4645248
    v_fmac_f32 v83, v184, v235
    v_mfma_f32_16x16x32_bf16 v[108:111], v[220:223], a[84:87], v[108:111]
    buffer_load_dwordx4 v168, s[8:11], s75 offen offset:0  lds
    buffer_load_dwordx4 a[0:3], v3, s[24:27], s73 offen offset:0 sc1
    v_fmac_f32 v88, v184, v236
    v_mfma_f32_16x16x32_bf16 v[108:111], v[216:219], a[68:71], v[108:111]
    ds_read_b64_tr_b16 v[204:205], v171 offset:12288
    v_fmac_f32 v89, v184, v237
    v_fmac_f32 v90, v184, v238
    v_mfma_f32_16x16x32_bf16 v[108:111], v[212:215], a[52:55], v[108:111]
    ds_read_b64_tr_b16 v[206:207], v171 offset:14336
    v_fmac_f32 v91, v184, v239
    v_fmac_f32 v96, v184, v240
    v_mfma_f32_16x16x32_bf16 v[8:11], v[212:215], a[56:59], v[8:11]
    v_fmac_f32 v97, v184, v241
    v_fmac_f32 v98, v184, v242
    v_fmac_f32 v99, v184, v243
    v_mfma_f32_16x16x32_bf16 v[8:11], v[216:219], a[72:75], v[8:11]
    v_max_f32 v72, 0, v72
    v_max_f32 v73, 0, v73
    v_max_f32 v74, 0, v74
    v_mfma_f32_16x16x32_bf16 v[8:11], v[220:223], a[88:91], v[8:11]
    ds_read_b64_tr_b16 v[208:209], v171 offset:16384
    buffer_load_dwordx4 a[4:7], v252, s[24:27], s73 offen offset:0 sc1
    v_max_f32 v75, 0, v75
    v_mfma_f32_16x16x32_bf16 v[12:15], v[220:223], a[92:95], v[12:15]
    ds_read_b64_tr_b16 v[210:211], v171 offset:18432
    v_max_f32 v80, 0, v80
    v_max_f32 v81, 0, v81
    v_mfma_f32_16x16x32_bf16 v[12:15], v[216:219], a[76:79], v[12:15]
    buffer_load_dwordx4 v169, s[8:11], s75 offen offset:1024  lds
    v_max_f32 v82, 0, v82
    v_max_f32 v83, 0, v83
    v_mfma_f32_16x16x32_bf16 v[12:15], v[212:215], a[60:63], v[12:15]
    v_mul_f32 v72, v72, v88
    v_mul_f32 v73, v73, v89
    s_waitcnt lgkmcnt(8)
    v_mfma_f32_16x16x32_bf16 v[20:23], v[224:227], a[60:63], v[20:23]
    ds_read_b64_tr_b16 v[212:213], v171 offset:20480
    v_mul_f32 v74, v74, v90
    s_waitcnt lgkmcnt(7)
    v_mfma_f32_16x16x32_bf16 v[20:23], v[196:199], a[76:79], v[20:23]
    ds_read_b64_tr_b16 v[214:215], v171 offset:22528
    v_mul_f32 v75, v75, v91
    s_waitcnt lgkmcnt(6)
    v_mfma_f32_16x16x32_bf16 v[20:23], v[200:203], a[92:95], v[20:23]
    v_mul_f32 v80, v80, v96
    v_mul_f32 v81, v81, v97
    v_mul_f32 v82, v82, v98
    v_mfma_f32_16x16x32_bf16 v[16:19], v[200:203], a[88:91], v[16:19]
    buffer_load_dwordx4 a[8:11], v3, s[24:27], s73 offen offset:1024 sc1
    v_mul_f32 v83, v83, v99
    v_cvt_pk_bf16_f32 v244, v72, v73
    v_mfma_f32_16x16x32_bf16 v[16:19], v[196:199], a[72:75], v[16:19]
    ds_read_b64_tr_b16 v[216:217], v174 offset:12288
    v_cvt_pk_bf16_f32 v245, v74, v75
    v_cvt_pk_bf16_f32 v246, v80, v81
    v_mfma_f32_16x16x32_bf16 v[16:19], v[224:227], a[56:59], v[16:19]
    ds_read_b64_tr_b16 v[218:219], v174 offset:14336
    buffer_load_dwordx4 v170, s[8:11], s75 offen offset:2048  lds
    v_cvt_pk_bf16_f32 v247, v82, v83
    v_mfma_f32_16x16x32_bf16 v[116:119], v[224:227], a[52:55], v[116:119]
    s_add_u32 s52, s52, 4096
    buffer_store_dwordx4 v[244:247], v3, s[24:27], s52 offen offset:0 sc1
    v_fmac_f32 v76, v185, v228
    v_mfma_f32_16x16x32_bf16 v[116:119], v[196:199], a[68:71], v[116:119]
    v_fmac_f32 v77, v185, v229
    v_fmac_f32 v78, v185, v230
    v_fmac_f32 v79, v185, v231
    v_mfma_f32_16x16x32_bf16 v[116:119], v[200:203], a[84:87], v[116:119]
    ds_read_b64_tr_b16 v[220:221], v174 offset:16384
    v_fmac_f32 v84, v185, v232
    v_fmac_f32 v85, v185, v233
    v_mfma_f32_16x16x32_bf16 v[112:115], v[200:203], a[80:83], v[112:115]
    ds_read_b64_tr_b16 v[222:223], v174 offset:18432
    v_fmac_f32 v86, v185, v234
    v_fmac_f32 v87, v185, v235
    v_mfma_f32_16x16x32_bf16 v[112:115], v[196:199], a[64:67], v[112:115]
    buffer_load_dwordx4 a[12:15], v252, s[24:27], s73 offen offset:1024 sc1
    v_fmac_f32 v92, v185, v236
    v_fmac_f32 v93, v185, v237
    v_mfma_f32_16x16x32_bf16 v[112:115], v[224:227], a[48:51], v[112:115]
    v_fmac_f32 v94, v185, v238
    v_fmac_f32 v95, v185, v239
    s_waitcnt lgkmcnt(8)
    v_mfma_f32_16x16x32_bf16 v[120:123], v[204:207], a[48:51], v[120:123]
    ds_read_b64_tr_b16 v[224:225], v174 offset:20480
    v_fmac_f32 v100, v185, v240
    s_waitcnt lgkmcnt(7)
    v_mfma_f32_16x16x32_bf16 v[120:123], v[208:211], a[64:67], v[120:123]
    ds_read_b64_tr_b16 v[226:227], v174 offset:22528
    v_fmac_f32 v101, v185, v241
    s_waitcnt lgkmcnt(6)
    v_mfma_f32_16x16x32_bf16 v[120:123], v[212:215], a[80:83], v[120:123]
    s_add_u32 m0, s40, 98304
    s_add_u32 s75, s49, 0
    v_fmac_f32 v102, v185, v242
    v_mfma_f32_16x16x32_bf16 v[124:127], v[212:215], a[84:87], v[124:127]
    s_add_u32 s73, s63, 10240
    v_fmac_f32 v103, v185, v243
    v_max_f32 v76, 0, v76
    v_mfma_f32_16x16x32_bf16 v[124:127], v[208:211], a[68:71], v[124:127]
    v_max_f32 v77, 0, v77
    v_max_f32 v78, 0, v78
    v_max_f32 v79, 0, v79
    v_mfma_f32_16x16x32_bf16 v[124:127], v[204:207], a[52:55], v[124:127]
    s_waitcnt vmcnt(11)
    v_cmp_ne_u32 vcc, s3, v193
    s_cbranch_vccnz SLOW_39
BACK_40:
    v_mfma_f32_16x16x32_bf16 v[24:27], v[204:207], a[56:59], v[24:27]
    s_barrier
    ds_read_b64_tr_b16 v[196:197], v173 offset:24576
    v_max_f32 v84, 0, v84
    v_mfma_f32_16x16x32_bf16 v[24:27], v[208:211], a[72:75], v[24:27]
    ds_read_b64_tr_b16 v[198:199], v173 offset:26624
    buffer_load_dwordx4 v3, s[24:27], s75 offen offset:0 sc1 lds
    v_max_f32 v85, 0, v85
    v_mfma_f32_16x16x32_bf16 v[24:27], v[212:215], a[88:91], v[24:27]
    ds_read_b64_tr_b16 v[200:201], v173 offset:28672
    buffer_load_dwordx4 a[16:19], v3, s[24:27], s73 offen offset:0 sc1
    v_max_f32 v86, 0, v86
    v_mfma_f32_16x16x32_bf16 v[28:31], v[212:215], a[92:95], v[28:31]
    ds_read_b64_tr_b16 v[202:203], v173 offset:30720
    v_max_f32 v87, 0, v87
    v_mul_f32 v76, v76, v92
    v_mfma_f32_16x16x32_bf16 v[28:31], v[208:211], a[76:79], v[28:31]
    v_mul_f32 v77, v77, v93
    v_mul_f32 v78, v78, v94
    v_mul_f32 v79, v79, v95
    v_mfma_f32_16x16x32_bf16 v[28:31], v[204:207], a[60:63], v[28:31]
    v_mul_f32 v84, v84, v100
    v_mul_f32 v85, v85, v101
    s_waitcnt lgkmcnt(8)
    v_mfma_f32_16x16x32_bf16 v[36:39], v[216:219], a[60:63], v[36:39]
    ds_read_b64_tr_b16 v[204:205], v173 offset:32768
    v_mul_f32 v86, v86, v102
    s_waitcnt lgkmcnt(7)
    v_mfma_f32_16x16x32_bf16 v[36:39], v[220:223], a[76:79], v[36:39]
    ds_read_b64_tr_b16 v[206:207], v173 offset:34816
    v_mul_f32 v87, v87, v103
    s_waitcnt lgkmcnt(6)
    v_mfma_f32_16x16x32_bf16 v[36:39], v[224:227], a[92:95], v[36:39]
    buffer_load_dwordx4 v3, s[24:27], s75 offen offset:1024 sc1 lds
    buffer_load_dwordx4 a[20:23], v252, s[24:27], s73 offen offset:0 sc1
    v_cvt_pk_bf16_f32 v248, v76, v77
    v_mfma_f32_16x16x32_bf16 v[32:35], v[224:227], a[88:91], v[32:35]
    v_cvt_pk_bf16_f32 v249, v78, v79
    v_cvt_pk_bf16_f32 v250, v84, v85
    v_cvt_pk_bf16_f32 v251, v86, v87
    v_mfma_f32_16x16x32_bf16 v[32:35], v[220:223], a[72:75], v[32:35]
    ds_read_b64_tr_b16 v[208:209], v176 offset:24576
    s_add_u32 s53, s53, 4096
    buffer_store_dwordx4 v[248:251], v3, s[24:27], s53 offen offset:0 sc1
    v_mfma_f32_16x16x32_bf16 v[32:35], v[216:219], a[56:59], v[32:35]
    ds_read_b64_tr_b16 v[210:211], v176 offset:26624
    v_mfma_f32_16x16x32_bf16 v[132:135], v[216:219], a[52:55], v[132:135]
    v_mfma_f32_16x16x32_bf16 v[132:135], v[220:223], a[68:71], v[132:135]
    buffer_load_dwordx4 a[24:27], v3, s[24:27], s73 offen offset:1024 sc1
    v_mfma_f32_16x16x32_bf16 v[132:135], v[224:227], a[84:87], v[132:135]
    ds_read_b64_tr_b16 v[212:213], v176 offset:28672
    buffer_load_dwordx4 v3, s[24:27], s75 offen offset:2048 sc1 lds
    v_mfma_f32_16x16x32_bf16 v[128:131], v[224:227], a[80:83], v[128:131]
    ds_read_b64_tr_b16 v[214:215], v176 offset:30720
    v_mfma_f32_16x16x32_bf16 v[128:131], v[220:223], a[64:67], v[128:131]
    v_mfma_f32_16x16x32_bf16 v[128:131], v[216:219], a[48:51], v[128:131]
    s_add_u32 m0, s40, 101376
    s_waitcnt lgkmcnt(8)
    v_mfma_f32_16x16x32_bf16 v[104:107], v[196:199], a[96:99], v[104:107]
    ds_read_b64_tr_b16 v[216:217], v176 offset:32768
    s_waitcnt lgkmcnt(7)
    v_mfma_f32_16x16x32_bf16 v[104:107], v[200:203], a[112:115], v[104:107]
    ds_read_b64_tr_b16 v[218:219], v176 offset:34816
    s_waitcnt lgkmcnt(6)
    v_mfma_f32_16x16x32_bf16 v[104:107], v[204:207], a[128:131], v[104:107]
    s_add_u32 s75, s49, 3072
    buffer_load_dwordx4 a[28:31], v252, s[24:27], s73 offen offset:1024 sc1
    v_mfma_f32_16x16x32_bf16 v[108:111], v[204:207], a[132:135], v[108:111]
    buffer_load_dwordx4 v3, s[24:27], s75 offen offset:0 sc1 lds
    v_mfma_f32_16x16x32_bf16 v[108:111], v[200:203], a[116:119], v[108:111]
    ds_read_b64_tr_b16 v[220:221], v173 offset:36864
    s_add_u32 s73, s63, 18432
    v_mfma_f32_16x16x32_bf16 v[108:111], v[196:199], a[100:103], v[108:111]
    ds_read_b64_tr_b16 v[222:223], v173 offset:38912
    v_mfma_f32_16x16x32_bf16 v[8:11], v[196:199], a[104:107], v[8:11]
    v_mfma_f32_16x16x32_bf16 v[8:11], v[200:203], a[120:123], v[8:11]
    v_mfma_f32_16x16x32_bf16 v[8:11], v[204:207], a[136:139], v[8:11]
    ds_read_b64_tr_b16 v[224:225], v173 offset:40960
    v_mfma_f32_16x16x32_bf16 v[12:15], v[204:207], a[140:143], v[12:15]
    ds_read_b64_tr_b16 v[226:227], v173 offset:43008
    buffer_load_dwordx4 a[32:35], v3, s[24:27], s73 offen offset:0 sc1
    v_mfma_f32_16x16x32_bf16 v[12:15], v[200:203], a[124:127], v[12:15]
    buffer_load_dwordx4 v3, s[24:27], s75 offen offset:1024 sc1 lds
    v_mfma_f32_16x16x32_bf16 v[12:15], v[196:199], a[108:111], v[12:15]
    s_waitcnt lgkmcnt(8)
    v_mfma_f32_16x16x32_bf16 v[20:23], v[208:211], a[108:111], v[20:23]
    ds_read_b64_tr_b16 v[196:197], v173 offset:45056
    s_waitcnt lgkmcnt(7)
    v_mfma_f32_16x16x32_bf16 v[20:23], v[212:215], a[124:127], v[20:23]
    ds_read_b64_tr_b16 v[198:199], v173 offset:47104
    s_waitcnt lgkmcnt(6)
    v_mfma_f32_16x16x32_bf16 v[20:23], v[216:219], a[140:143], v[20:23]
    v_mfma_f32_16x16x32_bf16 v[16:19], v[216:219], a[136:139], v[16:19]
    v_mfma_f32_16x16x32_bf16 v[16:19], v[212:215], a[120:123], v[16:19]
    ds_read_b64_tr_b16 v[200:201], v176 offset:36864
    buffer_load_dwordx4 a[36:39], v252, s[24:27], s73 offen offset:0 sc1
    v_mfma_f32_16x16x32_bf16 v[16:19], v[208:211], a[104:107], v[16:19]
    ds_read_b64_tr_b16 v[202:203], v176 offset:38912
    buffer_load_dwordx4 v3, s[24:27], s75 offen offset:2048 sc1 lds
    v_mfma_f32_16x16x32_bf16 v[116:119], v[208:211], a[100:103], v[116:119]
    v_mfma_f32_16x16x32_bf16 v[116:119], v[212:215], a[116:119], v[116:119]
    v_mfma_f32_16x16x32_bf16 v[116:119], v[216:219], a[132:135], v[116:119]
    ds_read_b64_tr_b16 v[204:205], v176 offset:40960
    v_mfma_f32_16x16x32_bf16 v[112:115], v[216:219], a[128:131], v[112:115]
    ds_read_b64_tr_b16 v[206:207], v176 offset:43008
    v_mfma_f32_16x16x32_bf16 v[112:115], v[212:215], a[112:115], v[112:115]
    v_mfma_f32_16x16x32_bf16 v[112:115], v[208:211], a[96:99], v[112:115]
    buffer_load_dwordx4 a[40:43], v3, s[24:27], s73 offen offset:1024 sc1
    s_waitcnt lgkmcnt(8)
    v_mfma_f32_16x16x32_bf16 v[120:123], v[220:223], a[96:99], v[120:123]
    ds_read_b64_tr_b16 v[208:209], v176 offset:45056
    s_waitcnt lgkmcnt(7)
    v_mfma_f32_16x16x32_bf16 v[120:123], v[224:227], a[112:115], v[120:123]
    ds_read_b64_tr_b16 v[210:211], v176 offset:47104
    s_waitcnt lgkmcnt(6)
    v_mfma_f32_16x16x32_bf16 v[120:123], v[196:199], a[128:131], v[120:123]
    s_add_u32 m0, s40, 0
    s_add_u32 s75, s49, 24576
    v_mfma_f32_16x16x32_bf16 v[124:127], v[196:199], a[132:135], v[124:127]
    v_mfma_f32_16x16x32_bf16 v[124:127], v[224:227], a[116:119], v[124:127]
    v_mfma_f32_16x16x32_bf16 v[124:127], v[220:223], a[100:103], v[124:127]
    v_mfma_f32_16x16x32_bf16 v[24:27], v[220:223], a[104:107], v[24:27]
    s_barrier
    ds_read_b64_tr_b16 v[212:213], v172 offset:24576
    v_mfma_f32_16x16x32_bf16 v[24:27], v[224:227], a[120:123], v[24:27]
    ds_read_b64_tr_b16 v[214:215], v172 offset:26624
    buffer_load_dwordx4 v3, s[24:27], s75 offen offset:0 sc1 lds
    v_mfma_f32_16x16x32_bf16 v[24:27], v[196:199], a[136:139], v[24:27]
    ds_read_b64_tr_b16 v[216:217], v172 offset:28672
    buffer_load_dwordx4 a[44:47], v252, s[24:27], s73 offen offset:1024 sc1
    v_mfma_f32_16x16x32_bf16 v[28:31], v[196:199], a[140:143], v[28:31]
    ds_read_b64_tr_b16 v[218:219], v172 offset:30720
    s_add_u32 s73, s63, 28672
    v_mfma_f32_16x16x32_bf16 v[28:31], v[224:227], a[124:127], v[28:31]
    v_mfma_f32_16x16x32_bf16 v[28:31], v[220:223], a[108:111], v[28:31]
    s_waitcnt lgkmcnt(8)
    v_mfma_f32_16x16x32_bf16 v[36:39], v[200:203], a[108:111], v[36:39]
    ds_read_b64_tr_b16 v[220:221], v172 offset:32768
    s_waitcnt lgkmcnt(7)
    v_mfma_f32_16x16x32_bf16 v[36:39], v[204:207], a[124:127], v[36:39]
    ds_read_b64_tr_b16 v[222:223], v172 offset:34816
    s_waitcnt lgkmcnt(6)
    v_mfma_f32_16x16x32_bf16 v[36:39], v[208:211], a[140:143], v[36:39]
    buffer_load_dwordx4 v3, s[24:27], s75 offen offset:1024 sc1 lds
    buffer_load_dwordx4 a[48:51], v3, s[24:27], s73 offen offset:0 sc1
    v_mfma_f32_16x16x32_bf16 v[32:35], v[208:211], a[136:139], v[32:35]
    v_mfma_f32_16x16x32_bf16 v[32:35], v[204:207], a[120:123], v[32:35]
    ds_read_b64_tr_b16 v[224:225], v175 offset:24576
    v_mfma_f32_16x16x32_bf16 v[32:35], v[200:203], a[104:107], v[32:35]
    ds_read_b64_tr_b16 v[226:227], v175 offset:26624
    v_mfma_f32_16x16x32_bf16 v[132:135], v[200:203], a[100:103], v[132:135]
    v_mfma_f32_16x16x32_bf16 v[132:135], v[204:207], a[116:119], v[132:135]
    v_mfma_f32_16x16x32_bf16 v[132:135], v[208:211], a[132:135], v[132:135]
    ds_read_b64_tr_b16 v[196:197], v175 offset:28672
    buffer_load_dwordx4 v3, s[24:27], s75 offen offset:2048 sc1 lds
    v_mfma_f32_16x16x32_bf16 v[128:131], v[208:211], a[128:131], v[128:131]
    ds_read_b64_tr_b16 v[198:199], v175 offset:30720
    buffer_load_dwordx4 a[52:55], v252, s[24:27], s73 offen offset:0 sc1
    v_mfma_f32_16x16x32_bf16 v[128:131], v[204:207], a[112:115], v[128:131]
    v_mfma_f32_16x16x32_bf16 v[128:131], v[200:203], a[96:99], v[128:131]
    s_add_u32 m0, s40, 3072
    s_waitcnt lgkmcnt(8)
    v_mfma_f32_16x16x32_bf16 v[104:107], v[212:215], a[144:147], v[104:107]
    ds_read_b64_tr_b16 v[200:201], v175 offset:32768
    s_waitcnt lgkmcnt(7)
    v_mfma_f32_16x16x32_bf16 v[104:107], v[216:219], a[160:163], v[104:107]
    ds_read_b64_tr_b16 v[202:203], v175 offset:34816
    s_waitcnt lgkmcnt(6)
    v_mfma_f32_16x16x32_bf16 v[104:107], v[220:223], a[176:179], v[104:107]
    s_add_u32 s75, s49, 27648
    v_mfma_f32_16x16x32_bf16 v[108:111], v[220:223], a[180:183], v[108:111]
    buffer_load_dwordx4 v3, s[24:27], s75 offen offset:0 sc1 lds
    buffer_load_dwordx4 a[56:59], v3, s[24:27], s73 offen offset:1024 sc1
    v_mfma_f32_16x16x32_bf16 v[108:111], v[216:219], a[164:167], v[108:111]
    ds_read_b64_tr_b16 v[204:205], v172 offset:36864
    v_mfma_f32_16x16x32_bf16 v[108:111], v[212:215], a[148:151], v[108:111]
    ds_read_b64_tr_b16 v[206:207], v172 offset:38912
    v_mfma_f32_16x16x32_bf16 v[8:11], v[212:215], a[152:155], v[8:11]
    v_mfma_f32_16x16x32_bf16 v[8:11], v[216:219], a[168:171], v[8:11]
    v_mfma_f32_16x16x32_bf16 v[8:11], v[220:223], a[184:187], v[8:11]
    ds_read_b64_tr_b16 v[208:209], v172 offset:40960
    v_mfma_f32_16x16x32_bf16 v[12:15], v[220:223], a[188:191], v[12:15]
    ds_read_b64_tr_b16 v[210:211], v172 offset:43008
    v_mfma_f32_16x16x32_bf16 v[12:15], v[216:219], a[172:175], v[12:15]
    buffer_load_dwordx4 v3, s[24:27], s75 offen offset:1024 sc1 lds
    buffer_load_dwordx4 a[60:63], v252, s[24:27], s73 offen offset:1024 sc1
    v_mfma_f32_16x16x32_bf16 v[12:15], v[212:215], a[156:159], v[12:15]
    s_waitcnt lgkmcnt(8)
    v_mfma_f32_16x16x32_bf16 v[20:23], v[224:227], a[156:159], v[20:23]
    ds_read_b64_tr_b16 v[212:213], v172 offset:45056
    s_waitcnt lgkmcnt(7)
    v_mfma_f32_16x16x32_bf16 v[20:23], v[196:199], a[172:175], v[20:23]
    ds_read_b64_tr_b16 v[214:215], v172 offset:47104
    s_waitcnt lgkmcnt(6)
    v_mfma_f32_16x16x32_bf16 v[20:23], v[200:203], a[188:191], v[20:23]
    s_add_u32 s73, s63, 2048
    v_mfma_f32_16x16x32_bf16 v[16:19], v[200:203], a[184:187], v[16:19]
    v_mfma_f32_16x16x32_bf16 v[16:19], v[196:199], a[168:171], v[16:19]
    ds_read_b64_tr_b16 v[216:217], v175 offset:36864
    v_mfma_f32_16x16x32_bf16 v[16:19], v[224:227], a[152:155], v[16:19]
    ds_read_b64_tr_b16 v[218:219], v175 offset:38912
    buffer_load_dwordx4 v3, s[24:27], s75 offen offset:2048 sc1 lds
    v_mfma_f32_16x16x32_bf16 v[116:119], v[224:227], a[148:151], v[116:119]
    buffer_load_dwordx4 a[64:67], v3, s[24:27], s73 offen offset:0 sc1
    v_mfma_f32_16x16x32_bf16 v[116:119], v[196:199], a[164:167], v[116:119]
    v_mfma_f32_16x16x32_bf16 v[116:119], v[200:203], a[180:183], v[116:119]
    ds_read_b64_tr_b16 v[220:221], v175 offset:40960
    v_mfma_f32_16x16x32_bf16 v[112:115], v[200:203], a[176:179], v[112:115]
    ds_read_b64_tr_b16 v[222:223], v175 offset:43008
    v_mfma_f32_16x16x32_bf16 v[112:115], v[196:199], a[160:163], v[112:115]
    v_mfma_f32_16x16x32_bf16 v[112:115], v[224:227], a[144:147], v[112:115]
    s_waitcnt lgkmcnt(8)
    v_mfma_f32_16x16x32_bf16 v[120:123], v[204:207], a[144:147], v[120:123]
    ds_read_b64_tr_b16 v[224:225], v175 offset:45056
    s_waitcnt lgkmcnt(7)
    v_mfma_f32_16x16x32_bf16 v[120:123], v[208:211], a[160:163], v[120:123]
    ds_read_b64_tr_b16 v[226:227], v175 offset:47104
    s_waitcnt lgkmcnt(6)
    v_mfma_f32_16x16x32_bf16 v[120:123], v[212:215], a[176:179], v[120:123]
    s_add_u32 m0, s40, 122880
    s_add_u32 s75, s49, 49152
    v_mfma_f32_16x16x32_bf16 v[124:127], v[212:215], a[180:183], v[124:127]
    buffer_load_dwordx4 a[68:71], v252, s[24:27], s73 offen offset:0 sc1
    v_mfma_f32_16x16x32_bf16 v[124:127], v[208:211], a[164:167], v[124:127]
    v_mfma_f32_16x16x32_bf16 v[124:127], v[204:207], a[148:151], v[124:127]
    v_mfma_f32_16x16x32_bf16 v[24:27], v[204:207], a[152:155], v[24:27]
    s_waitcnt vmcnt(22)
    s_barrier
    s_cmp_lg_u32 s36, 0
    s_cbranch_scc1 PUB_43
    s_mov_b64 exec, 1
    v_mov_b32 v192, s3
    buffer_store_dword v192, v4, s[24:27], s66 offen offset:64 sc1
    s_mov_b64 exec, -1
PUB_43:
    ds_read_b64_tr_b16 v[196:197], v171 offset:24576
    v_mfma_f32_16x16x32_bf16 v[24:27], v[208:211], a[168:171], v[24:27]
    ds_read_b64_tr_b16 v[198:199], v171 offset:26624
    buffer_load_dwordx4 v3, s[24:27], s75 offen offset:0 sc1 lds
    v_mfma_f32_16x16x32_bf16 v[24:27], v[212:215], a[184:187], v[24:27]
    ds_read_b64_tr_b16 v[200:201], v171 offset:28672
    buffer_load_dwordx4 a[72:75], v3, s[24:27], s73 offen offset:1024 sc1
    v_mfma_f32_16x16x32_bf16 v[28:31], v[212:215], a[188:191], v[28:31]
    ds_read_b64_tr_b16 v[202:203], v171 offset:30720
    v_mfma_f32_16x16x32_bf16 v[28:31], v[208:211], a[172:175], v[28:31]
    v_mfma_f32_16x16x32_bf16 v[28:31], v[204:207], a[156:159], v[28:31]
    s_waitcnt lgkmcnt(8)
    v_mfma_f32_16x16x32_bf16 v[36:39], v[216:219], a[156:159], v[36:39]
    ds_read_b64_tr_b16 v[204:205], v171 offset:32768
    s_waitcnt lgkmcnt(7)
    v_mfma_f32_16x16x32_bf16 v[36:39], v[220:223], a[172:175], v[36:39]
    ds_read_b64_tr_b16 v[206:207], v171 offset:34816
    s_waitcnt lgkmcnt(6)
    v_mfma_f32_16x16x32_bf16 v[36:39], v[224:227], a[188:191], v[36:39]
    buffer_load_dwordx4 v3, s[24:27], s75 offen offset:1024 sc1 lds
    buffer_load_dwordx4 a[76:79], v252, s[24:27], s73 offen offset:1024 sc1
    v_mfma_f32_16x16x32_bf16 v[32:35], v[224:227], a[184:187], v[32:35]
    v_mfma_f32_16x16x32_bf16 v[32:35], v[220:223], a[168:171], v[32:35]
    ds_read_b64_tr_b16 v[208:209], v174 offset:24576
    s_add_u32 s73, s63, 12288
    v_mfma_f32_16x16x32_bf16 v[32:35], v[216:219], a[152:155], v[32:35]
    ds_read_b64_tr_b16 v[210:211], v174 offset:26624
    v_mfma_f32_16x16x32_bf16 v[132:135], v[216:219], a[148:151], v[132:135]
    v_mfma_f32_16x16x32_bf16 v[132:135], v[220:223], a[164:167], v[132:135]
    v_mfma_f32_16x16x32_bf16 v[132:135], v[224:227], a[180:183], v[132:135]
    ds_read_b64_tr_b16 v[212:213], v174 offset:28672
    buffer_load_dwordx4 v3, s[24:27], s75 offen offset:2048 sc1 lds
    v_mfma_f32_16x16x32_bf16 v[128:131], v[224:227], a[176:179], v[128:131]
    ds_read_b64_tr_b16 v[214:215], v174 offset:30720
    buffer_load_dwordx4 a[80:83], v3, s[24:27], s73 offen offset:0 sc1
    v_mfma_f32_16x16x32_bf16 v[128:131], v[220:223], a[160:163], v[128:131]
    v_mfma_f32_16x16x32_bf16 v[128:131], v[216:219], a[144:147], v[128:131]
    s_add_u32 m0, s40, 125952
    s_waitcnt lgkmcnt(8)
    v_mfma_f32_16x16x32_bf16 v[104:107], v[196:199], a[192:195], v[104:107]
    ds_read_b64_tr_b16 v[216:217], v174 offset:32768
    s_waitcnt lgkmcnt(7)
    v_mfma_f32_16x16x32_bf16 v[104:107], v[200:203], a[208:211], v[104:107]
    ds_read_b64_tr_b16 v[218:219], v174 offset:34816
    s_waitcnt lgkmcnt(6)
    v_mfma_f32_16x16x32_bf16 v[104:107], v[204:207], a[224:227], v[104:107]
    s_add_u32 s75, s49, 52224
    v_mfma_f32_16x16x32_bf16 v[108:111], v[204:207], a[228:231], v[108:111]
    buffer_load_dwordx4 v3, s[24:27], s75 offen offset:0 sc1 lds
    v_mfma_f32_16x16x32_bf16 v[108:111], v[200:203], a[212:215], v[108:111]
    ds_read_b64_tr_b16 v[220:221], v171 offset:36864
    buffer_load_dwordx4 a[84:87], v252, s[24:27], s73 offen offset:0 sc1
    v_mfma_f32_16x16x32_bf16 v[108:111], v[196:199], a[196:199], v[108:111]
    ds_read_b64_tr_b16 v[222:223], v171 offset:38912
    v_mfma_f32_16x16x32_bf16 v[8:11], v[196:199], a[200:203], v[8:11]
    v_mfma_f32_16x16x32_bf16 v[8:11], v[200:203], a[216:219], v[8:11]
    v_mfma_f32_16x16x32_bf16 v[8:11], v[204:207], a[232:235], v[8:11]
    ds_read_b64_tr_b16 v[224:225], v171 offset:40960
    v_mfma_f32_16x16x32_bf16 v[12:15], v[204:207], a[236:239], v[12:15]
    ds_read_b64_tr_b16 v[226:227], v171 offset:43008
    v_mfma_f32_16x16x32_bf16 v[12:15], v[200:203], a[220:223], v[12:15]
    buffer_load_dwordx4 v3, s[24:27], s75 offen offset:1024 sc1 lds
    v_mfma_f32_16x16x32_bf16 v[12:15], v[196:199], a[204:207], v[12:15]
    buffer_load_dwordx4 a[88:91], v3, s[24:27], s73 offen offset:1024 sc1
    s_waitcnt lgkmcnt(8)
    v_mfma_f32_16x16x32_bf16 v[20:23], v[208:211], a[204:207], v[20:23]
    ds_read_b64_tr_b16 v[196:197], v171 offset:45056
    s_waitcnt lgkmcnt(7)
    v_mfma_f32_16x16x32_bf16 v[20:23], v[212:215], a[220:223], v[20:23]
    ds_read_b64_tr_b16 v[198:199], v171 offset:47104
    s_waitcnt lgkmcnt(6)
    v_mfma_f32_16x16x32_bf16 v[20:23], v[216:219], a[236:239], v[20:23]
    v_mfma_f32_16x16x32_bf16 v[16:19], v[216:219], a[232:235], v[16:19]
    v_mfma_f32_16x16x32_bf16 v[16:19], v[212:215], a[216:219], v[16:19]
    ds_read_b64_tr_b16 v[200:201], v174 offset:36864
    v_mfma_f32_16x16x32_bf16 v[16:19], v[208:211], a[200:203], v[16:19]
    ds_read_b64_tr_b16 v[202:203], v174 offset:38912
    buffer_load_dwordx4 v3, s[24:27], s75 offen offset:2048 sc1 lds
    v_mfma_f32_16x16x32_bf16 v[116:119], v[208:211], a[196:199], v[116:119]
    buffer_load_dwordx4 a[92:95], v252, s[24:27], s73 offen offset:1024 sc1
    v_mfma_f32_16x16x32_bf16 v[116:119], v[212:215], a[212:215], v[116:119]
    v_mfma_f32_16x16x32_bf16 v[116:119], v[216:219], a[228:231], v[116:119]
    ds_read_b64_tr_b16 v[204:205], v174 offset:40960
    s_add_u32 s73, s63, 20480
    v_mfma_f32_16x16x32_bf16 v[112:115], v[216:219], a[224:227], v[112:115]
    ds_read_b64_tr_b16 v[206:207], v174 offset:43008
    v_mfma_f32_16x16x32_bf16 v[112:115], v[212:215], a[208:211], v[112:115]
    v_mfma_f32_16x16x32_bf16 v[112:115], v[208:211], a[192:195], v[112:115]
    s_waitcnt lgkmcnt(8)
    v_mfma_f32_16x16x32_bf16 v[120:123], v[220:223], a[192:195], v[120:123]
    ds_read_b64_tr_b16 v[208:209], v174 offset:45056
    s_waitcnt lgkmcnt(7)
    v_mfma_f32_16x16x32_bf16 v[120:123], v[224:227], a[208:211], v[120:123]
    ds_read_b64_tr_b16 v[210:211], v174 offset:47104
    s_waitcnt lgkmcnt(6)
    v_mfma_f32_16x16x32_bf16 v[120:123], v[196:199], a[224:227], v[120:123]
    s_add_u32 m0, s40, 73728
    s_add_u32 s75, s49, 73728
    v_mfma_f32_16x16x32_bf16 v[124:127], v[196:199], a[228:231], v[124:127]
    buffer_load_dwordx4 a[96:99], v3, s[24:27], s73 offen offset:0 sc1
    v_mfma_f32_16x16x32_bf16 v[124:127], v[224:227], a[212:215], v[124:127]
    s_lshl_b32 s6, s29, 11
    v_lshl_add_u32 v6, v0, 3, s6
    v_min_u32 v6, CODE_END-CPF0-8, v6
    global_load_dwordx2 v[6:7], v6, s[92:93]
    v_mfma_f32_16x16x32_bf16 v[124:127], v[220:223], a[196:199], v[124:127]
    v_mfma_f32_16x16x32_bf16 v[24:27], v[220:223], a[200:203], v[24:27]
    s_barrier
    ds_read_b64_tr_b16 v[212:213], v172 offset:0
    v_mfma_f32_16x16x32_bf16 v[24:27], v[224:227], a[216:219], v[24:27]
    ds_read_b64_tr_b16 v[214:215], v172 offset:2048
    buffer_load_dwordx4 v3, s[24:27], s75 offen offset:0 sc1 lds
    v_mfma_f32_16x16x32_bf16 v[24:27], v[196:199], a[232:235], v[24:27]
    ds_read_b64_tr_b16 v[216:217], v172 offset:4096
    buffer_load_dwordx4 a[100:103], v252, s[24:27], s73 offen offset:0 sc1
    v_mfma_f32_16x16x32_bf16 v[28:31], v[196:199], a[236:239], v[28:31]
    ds_read_b64_tr_b16 v[218:219], v172 offset:6144
    v_mfma_f32_16x16x32_bf16 v[28:31], v[224:227], a[220:223], v[28:31]
    v_mfma_f32_16x16x32_bf16 v[28:31], v[220:223], a[204:207], v[28:31]
    s_waitcnt lgkmcnt(8)
    v_mfma_f32_16x16x32_bf16 v[36:39], v[200:203], a[204:207], v[36:39]
    ds_read_b64_tr_b16 v[220:221], v172 offset:8192
    s_waitcnt lgkmcnt(7)
    v_mfma_f32_16x16x32_bf16 v[36:39], v[204:207], a[220:223], v[36:39]
    ds_read_b64_tr_b16 v[222:223], v172 offset:10240
    s_waitcnt lgkmcnt(6)
    v_mfma_f32_16x16x32_bf16 v[36:39], v[208:211], a[236:239], v[36:39]
    buffer_load_dwordx4 v3, s[24:27], s75 offen offset:1024 sc1 lds
    v_mfma_f32_16x16x32_bf16 v[32:35], v[208:211], a[232:235], v[32:35]
    buffer_load_dwordx4 a[104:107], v3, s[24:27], s73 offen offset:1024 sc1
    v_mfma_f32_16x16x32_bf16 v[32:35], v[204:207], a[216:219], v[32:35]
    ds_read_b64_tr_b16 v[224:225], v175 offset:0
    v_mfma_f32_16x16x32_bf16 v[32:35], v[200:203], a[200:203], v[32:35]
    ds_read_b64_tr_b16 v[226:227], v175 offset:2048
    v_mfma_f32_16x16x32_bf16 v[132:135], v[200:203], a[196:199], v[132:135]
    v_mfma_f32_16x16x32_bf16 v[132:135], v[204:207], a[212:215], v[132:135]
    v_mfma_f32_16x16x32_bf16 v[132:135], v[208:211], a[228:231], v[132:135]
    ds_read_b64_tr_b16 v[196:197], v175 offset:4096
    buffer_load_dwordx4 v3, s[24:27], s75 offen offset:2048 sc1 lds
    v_mfma_f32_16x16x32_bf16 v[128:131], v[208:211], a[224:227], v[128:131]
    ds_read_b64_tr_b16 v[198:199], v175 offset:6144
    v_mfma_f32_16x16x32_bf16 v[128:131], v[204:207], a[208:211], v[128:131]
    buffer_load_dwordx4 a[108:111], v252, s[24:27], s73 offen offset:1024 sc1
    v_mfma_f32_16x16x32_bf16 v[128:131], v[200:203], a[192:195], v[128:131]
    s_add_u32 m0, s40, 76800
    s_waitcnt lgkmcnt(8)
    v_mfma_f32_16x16x32_bf16 v[104:107], v[212:215], a[240:243], v[104:107]
    ds_read_b64_tr_b16 v[200:201], v175 offset:8192
    s_waitcnt lgkmcnt(7)
    v_mfma_f32_16x16x32_bf16 v[104:107], v[216:219], v[136:139], v[104:107]
    ds_read_b64_tr_b16 v[202:203], v175 offset:10240
    s_waitcnt lgkmcnt(6)
    v_mfma_f32_16x16x32_bf16 v[104:107], v[220:223], v[152:155], v[104:107]
    s_add_u32 s75, s49, 76800
    s_add_u32 s73, s63, 30720
    v_mfma_f32_16x16x32_bf16 v[108:111], v[220:223], v[156:159], v[108:111]
    buffer_load_dwordx4 v3, s[24:27], s75 offen offset:0 sc1 lds
    v_mfma_f32_16x16x32_bf16 v[108:111], v[216:219], v[140:143], v[108:111]
    ds_read_b64_tr_b16 v[204:205], v172 offset:12288
    v_mfma_f32_16x16x32_bf16 v[108:111], v[212:215], a[244:247], v[108:111]
    ds_read_b64_tr_b16 v[206:207], v172 offset:14336
    buffer_load_dwordx4 a[112:115], v3, s[24:27], s73 offen offset:0 sc1
    v_mfma_f32_16x16x32_bf16 v[8:11], v[212:215], a[248:251], v[8:11]
    v_mfma_f32_16x16x32_bf16 v[8:11], v[216:219], v[144:147], v[8:11]
    v_mfma_f32_16x16x32_bf16 v[8:11], v[220:223], v[160:163], v[8:11]
    ds_read_b64_tr_b16 v[208:209], v172 offset:16384
    v_mfma_f32_16x16x32_bf16 v[12:15], v[220:223], v[164:167], v[12:15]
    ds_read_b64_tr_b16 v[210:211], v172 offset:18432
    v_mfma_f32_16x16x32_bf16 v[12:15], v[216:219], v[148:151], v[12:15]
    buffer_load_dwordx4 v3, s[24:27], s75 offen offset:1024 sc1 lds
    v_mfma_f32_16x16x32_bf16 v[12:15], v[212:215], a[252:255], v[12:15]
    s_waitcnt lgkmcnt(8)
    v_mfma_f32_16x16x32_bf16 v[20:23], v[224:227], a[252:255], v[20:23]
    ds_read_b64_tr_b16 v[212:213], v172 offset:20480
    s_waitcnt lgkmcnt(7)
    v_mfma_f32_16x16x32_bf16 v[20:23], v[196:199], v[148:151], v[20:23]
    ds_read_b64_tr_b16 v[214:215], v172 offset:22528
    s_waitcnt lgkmcnt(6)
    v_mfma_f32_16x16x32_bf16 v[20:23], v[200:203], v[164:167], v[20:23]
    buffer_load_dwordx4 a[116:119], v252, s[24:27], s73 offen offset:0 sc1
    v_mfma_f32_16x16x32_bf16 v[16:19], v[200:203], v[160:163], v[16:19]
    v_mfma_f32_16x16x32_bf16 v[16:19], v[196:199], v[144:147], v[16:19]
    ds_read_b64_tr_b16 v[216:217], v175 offset:12288
    v_mfma_f32_16x16x32_bf16 v[16:19], v[224:227], a[248:251], v[16:19]
    ds_read_b64_tr_b16 v[218:219], v175 offset:14336
    buffer_load_dwordx4 v3, s[24:27], s75 offen offset:2048 sc1 lds
    v_mfma_f32_16x16x32_bf16 v[116:119], v[224:227], a[244:247], v[116:119]
    v_mfma_f32_16x16x32_bf16 v[116:119], v[196:199], v[140:143], v[116:119]
    buffer_load_dwordx4 a[120:123], v3, s[24:27], s73 offen offset:1024 sc1
    v_mfma_f32_16x16x32_bf16 v[116:119], v[200:203], v[156:159], v[116:119]
    ds_read_b64_tr_b16 v[220:221], v175 offset:16384
    v_mfma_f32_16x16x32_bf16 v[112:115], v[200:203], v[152:155], v[112:115]
    ds_read_b64_tr_b16 v[222:223], v175 offset:18432
    v_mfma_f32_16x16x32_bf16 v[112:115], v[196:199], v[136:139], v[112:115]
    v_mfma_f32_16x16x32_bf16 v[112:115], v[224:227], a[240:243], v[112:115]
    s_waitcnt lgkmcnt(8)
    v_mfma_f32_16x16x32_bf16 v[120:123], v[204:207], a[240:243], v[120:123]
    ds_read_b64_tr_b16 v[224:225], v175 offset:20480
    s_waitcnt lgkmcnt(7)
    v_mfma_f32_16x16x32_bf16 v[120:123], v[208:211], v[136:139], v[120:123]
    ds_read_b64_tr_b16 v[226:227], v175 offset:22528
    s_waitcnt lgkmcnt(6)
    v_mfma_f32_16x16x32_bf16 v[120:123], v[212:215], v[152:155], v[120:123]
    buffer_load_dwordx4 a[124:127], v252, s[24:27], s73 offen offset:1024 sc1
    v_mfma_f32_16x16x32_bf16 v[124:127], v[212:215], v[156:159], v[124:127]
    v_mfma_f32_16x16x32_bf16 v[124:127], v[208:211], v[140:143], v[124:127]
    s_add_u32 s73, s63, 8192
    v_mfma_f32_16x16x32_bf16 v[124:127], v[204:207], a[244:247], v[124:127]
    v_mfma_f32_16x16x32_bf16 v[24:27], v[204:207], a[248:251], v[24:27]
    s_waitcnt vmcnt(41)
    s_barrier
    ds_read_b128 v[196:199], v188 offset:0
    ds_read_b128 v[200:203], v188 offset:7168
    v_mfma_f32_16x16x32_bf16 v[24:27], v[208:211], v[144:147], v[24:27]
    v_mfma_f32_16x16x32_bf16 v[24:27], v[212:215], v[160:163], v[24:27]
    v_mfma_f32_16x16x32_bf16 v[28:31], v[212:215], v[164:167], v[28:31]
    buffer_load_dwordx4 a[128:131], v3, s[24:27], s73 offen offset:0 sc1
    v_mfma_f32_16x16x32_bf16 v[28:31], v[208:211], v[148:151], v[28:31]
    v_mfma_f32_16x16x32_bf16 v[28:31], v[204:207], a[252:255], v[28:31]
    ds_read_b128 v[204:207], v188 offset:1024
    s_waitcnt lgkmcnt(7)
    v_mfma_f32_16x16x32_bf16 v[36:39], v[216:219], a[252:255], v[36:39]
    ds_read_b128 v[208:211], v188 offset:8192
    s_waitcnt lgkmcnt(6)
    v_mfma_f32_16x16x32_bf16 v[36:39], v[220:223], v[148:151], v[36:39]
    s_waitcnt lgkmcnt(4)
    v_mfma_f32_16x16x32_bf16 v[36:39], v[224:227], v[164:167], v[36:39]
    v_mfma_f32_16x16x32_bf16 v[32:35], v[224:227], v[160:163], v[32:35]
    v_mfma_f32_16x16x32_bf16 v[32:35], v[220:223], v[144:147], v[32:35]
    ds_read_b128 v[212:215], v188 offset:2048
    buffer_load_dwordx4 a[132:135], v252, s[24:27], s73 offen offset:0 sc1
    v_mfma_f32_16x16x32_bf16 v[32:35], v[216:219], a[248:251], v[32:35]
    v_mfma_f32_16x16x32_bf16 v[132:135], v[216:219], a[244:247], v[132:135]
    v_mfma_f32_16x16x32_bf16 v[132:135], v[220:223], v[140:143], v[132:135]
    v_mfma_f32_16x16x32_bf16 v[132:135], v[224:227], v[156:159], v[132:135]
    v_mfma_f32_16x16x32_bf16 v[128:131], v[224:227], v[152:155], v[128:131]
    v_mfma_f32_16x16x32_bf16 v[128:131], v[220:223], v[136:139], v[128:131]
    v_mfma_f32_16x16x32_bf16 v[128:131], v[216:219], a[240:243], v[128:131]
    ds_read_b128 v[216:219], v188 offset:9216
    s_waitcnt lgkmcnt(4)
    v_mfma_f32_16x16x32_bf16 v[40:43], v[196:199], a[0:3], 0
    ds_read_b128 v[220:223], v188 offset:3072
    buffer_load_dwordx4 a[136:139], v3, s[24:27], s73 offen offset:1024 sc1
    v_mfma_f32_16x16x32_bf16 v[40:43], v[200:203], a[8:11], v[40:43]
    v_mfma_f32_16x16x32_bf16 v[44:47], v[200:203], a[12:15], 0
    ds_read_b128 v[224:227], v188 offset:10240
    v_mfma_f32_16x16x32_bf16 v[44:47], v[196:199], a[4:7], v[44:47]
    ds_read_b128 v[228:231], v180 offset:768
    ds_read_b128 v[232:235], v180 offset:832
    ds_read_b128 v[236:239], v180 offset:2048
    ds_read_b128 v[240:243], v180 offset:2112
    s_waitcnt lgkmcnt(8)
    v_mfma_f32_16x16x32_bf16 v[52:55], v[204:207], a[4:7], 0
    ds_read_b128 v[196:199], v188 offset:4096
    v_mfma_f32_16x16x32_bf16 v[52:55], v[208:211], a[12:15], v[52:55]
    v_mfma_f32_16x16x32_bf16 v[48:51], v[208:211], a[8:11], 0
    ds_read_b128 v[200:203], v188 offset:11264
    buffer_load_dwordx4 a[140:143], v252, s[24:27], s73 offen offset:1024 sc1
    v_mfma_f32_16x16x32_bf16 v[48:51], v[204:207], a[0:3], v[48:51]
    s_waitcnt lgkmcnt(2)
    v_fmac_f32 v104, v182, v228
    v_fmac_f32 v105, v182, v229
    v_fmac_f32 v106, v182, v230
    v_mfma_f32_16x16x32_bf16 v[56:59], v[212:215], a[0:3], 0
    ds_read_b128 v[204:207], v188 offset:5120
    s_add_u32 s73, s63, 26624
    v_fmac_f32 v107, v182, v231
    v_fmac_f32 v112, v182, v232
    v_fmac_f32 v113, v182, v233
    v_mfma_f32_16x16x32_bf16 v[56:59], v[216:219], a[8:11], v[56:59]
    buffer_load_dword v193, v190, s[24:27], s65 offen offset:64 sc1
    v_fmac_f32 v114, v182, v234
    v_fmac_f32 v115, v182, v235
    v_fmac_f32 v120, v182, v236
    v_fmac_f32 v121, v182, v237
    v_mfma_f32_16x16x32_bf16 v[60:63], v[216:219], a[12:15], 0
    ds_read_b128 v[208:211], v188 offset:12288
    v_fmac_f32 v122, v182, v238
    v_fmac_f32 v123, v182, v239
    v_fmac_f32 v128, v182, v240
    v_fmac_f32 v129, v182, v241
    v_mfma_f32_16x16x32_bf16 v[60:63], v[212:215], a[4:7], v[60:63]
    v_fmac_f32 v130, v182, v242
    v_fmac_f32 v131, v182, v243
    v_max_f32 v104, 0, v104
    v_max_f32 v105, 0, v105
    v_max_f32 v106, 0, v106
    v_mfma_f32_16x16x32_bf16 v[68:71], v[220:223], a[4:7], 0
    ds_read_b128 v[212:215], v188 offset:6144
    v_max_f32 v107, 0, v107
    v_max_f32 v112, 0, v112
    v_max_f32 v113, 0, v113
    v_max_f32 v114, 0, v114
    v_mfma_f32_16x16x32_bf16 v[68:71], v[224:227], a[12:15], v[68:71]
    buffer_load_dwordx4 a[144:147], v3, s[24:27], s73 offen offset:0 sc1
    v_max_f32 v115, 0, v115
    v_mul_f32 v104, v104, v120
    v_mul_f32 v105, v105, v121
    v_mul_f32 v106, v106, v122
    v_mfma_f32_16x16x32_bf16 v[64:67], v[224:227], a[8:11], 0
    ds_read_b128 v[216:219], v188 offset:13312
    v_mul_f32 v107, v107, v123
    v_mul_f32 v112, v112, v128
    v_mul_f32 v113, v113, v129
    v_mul_f32 v114, v114, v130
    v_mfma_f32_16x16x32_bf16 v[64:67], v[220:223], a[0:3], v[64:67]
    v_mul_f32 v115, v115, v131
    v_cvt_pk_bf16_f32 v244, v104, v105
    v_cvt_pk_bf16_f32 v245, v106, v107
    v_cvt_pk_bf16_f32 v246, v112, v113
    s_waitcnt lgkmcnt(4)
    v_mfma_f32_16x16x32_bf16 v[80:83], v[196:199], a[0:3], 0
    ds_read_b128 v[220:223], v188 offset:14336
    v_cvt_pk_bf16_f32 v247, v114, v115
    buffer_store_dwordx4 v[244:247], v3, s[24:27], s50 offen offset:2048 sc1
    v_fmac_f32 v108, v183, v228
    v_fmac_f32 v109, v183, v229
    v_mfma_f32_16x16x32_bf16 v[80:83], v[200:203], a[8:11], v[80:83]
    v_fmac_f32 v110, v183, v230
    v_fmac_f32 v111, v183, v231
    v_fmac_f32 v116, v183, v232
    v_fmac_f32 v117, v183, v233
    v_fmac_f32 v118, v183, v234
    v_mfma_f32_16x16x32_bf16 v[84:87], v[200:203], a[12:15], 0
    ds_read_b128 v[224:227], v188 offset:21504
    s_add_u32 m0, s40, 24576
    v_fmac_f32 v119, v183, v235
    v_fmac_f32 v124, v183, v236
    v_fmac_f32 v125, v183, v237
    v_mfma_f32_16x16x32_bf16 v[84:87], v[196:199], a[4:7], v[84:87]
    s_add_u32 s75, s49, 98304
    v_fmac_f32 v126, v183, v238
    v_fmac_f32 v127, v183, v239
    v_fmac_f32 v132, v183, v240
    s_waitcnt lgkmcnt(4)
    v_mfma_f32_16x16x32_bf16 v[92:95], v[204:207], a[4:7], 0
    ds_read_b128 v[196:199], v188 offset:15360
    buffer_load_dwordx4 a[148:151], v252, s[24:27], s73 offen offset:0 sc1
    v_fmac_f32 v133, v183, v241
    v_fmac_f32 v134, v183, v242
    v_fmac_f32 v135, v183, v243
    v_mfma_f32_16x16x32_bf16 v[92:95], v[208:211], a[12:15], v[92:95]
    v_max_f32 v108, 0, v108
    v_max_f32 v109, 0, v109
    v_max_f32 v110, 0, v110
    v_max_f32 v111, 0, v111
    v_max_f32 v116, 0, v116
    v_mfma_f32_16x16x32_bf16 v[88:91], v[208:211], a[8:11], 0
    s_waitcnt vmcnt(37)
    s_barrier
    ds_read_b128 v[200:203], v188 offset:22528
    v_max_f32 v117, 0, v117
    v_max_f32 v118, 0, v118
    v_mfma_f32_16x16x32_bf16 v[88:91], v[204:207], a[0:3], v[88:91]
    buffer_load_dwordx4 v3, s[24:27], s75 offen offset:0 sc1 lds
    v_max_f32 v119, 0, v119
    v_mul_f32 v108, v108, v124
    v_mul_f32 v109, v109, v125
    s_waitcnt lgkmcnt(4)
    v_mfma_f32_16x16x32_bf16 v[72:75], v[212:215], a[0:3], 0
    ds_read_b128 v[204:207], v188 offset:16384
    v_mul_f32 v110, v110, v126
    v_mul_f32 v111, v111, v127
    v_mul_f32 v116, v116, v132
    v_mul_f32 v117, v117, v133
    v_mfma_f32_16x16x32_bf16 v[72:75], v[216:219], a[8:11], v[72:75]
    v_mul_f32 v118, v118, v134
    v_mul_f32 v119, v119, v135
    v_cvt_pk_bf16_f32 v248, v108, v109
    v_cvt_pk_bf16_f32 v249, v110, v111
    v_cvt_pk_bf16_f32 v250, v116, v117
    v_mfma_f32_16x16x32_bf16 v[76:79], v[216:219], a[12:15], 0
    ds_read_b128 v[208:211], v188 offset:23552
    v_cvt_pk_bf16_f32 v251, v118, v119
    buffer_store_dwordx4 v[248:251], v3, s[24:27], s51 offen offset:2048 sc1
    v_fmac_f32 v8, v184, v228
    v_fmac_f32 v9, v184, v229
    v_mfma_f32_16x16x32_bf16 v[76:79], v[212:215], a[4:7], v[76:79]
    buffer_load_dwordx4 a[152:155], v3, s[24:27], s73 offen offset:1024 sc1
    v_fmac_f32 v10, v184, v230
    v_fmac_f32 v11, v184, v231
    v_fmac_f32 v16, v184, v232
    s_waitcnt lgkmcnt(4)
    v_mfma_f32_16x16x32_bf16 v[44:47], v[220:223], a[20:23], v[44:47]
    ds_read_b128 v[212:215], v188 offset:17408
    v_fmac_f32 v17, v184, v233
    v_fmac_f32 v18, v184, v234
    v_fmac_f32 v19, v184, v235
    v_fmac_f32 v24, v184, v236
    v_mfma_f32_16x16x32_bf16 v[44:47], v[224:227], a[28:31], v[44:47]
    buffer_load_dwordx4 v3, s[24:27], s75 offen offset:1024 sc1 lds
    v_fmac_f32 v25, v184, v237
    v_fmac_f32 v26, v184, v238
    v_fmac_f32 v27, v184, v239
    v_fmac_f32 v32, v184, v240
    v_mfma_f32_16x16x32_bf16 v[40:43], v[224:227], a[24:27], v[40:43]
    ds_read_b128 v[216:219], v186 offset:0
    v_fmac_f32 v33, v184, v241
    v_fmac_f32 v34, v184, v242
    v_fmac_f32 v35, v184, v243
    v_max_f32 v8, 0, v8
    v_mfma_f32_16x16x32_bf16 v[40:43], v[220:223], a[16:19], v[40:43]
    v_max_f32 v9, 0, v9
    v_max_f32 v10, 0, v10
    v_max_f32 v11, 0, v11
    v_max_f32 v16, 0, v16
    s_waitcnt lgkmcnt(4)
    v_mfma_f32_16x16x32_bf16 v[48:51], v[196:199], a[16:19], v[48:51]
    ds_read_b128 v[220:223], v188 offset:18432
    v_max_f32 v17, 0, v17
    v_max_f32 v18, 0, v18
    v_max_f32 v19, 0, v19
    v_mul_f32 v8, v8, v24
    v_mfma_f32_16x16x32_bf16 v[48:51], v[200:203], a[24:27], v[48:51]
    v_mul_f32 v9, v9, v25
    v_mul_f32 v10, v10, v26
    v_mul_f32 v11, v11, v27
    v_mul_f32 v16, v16, v32
    v_mul_f32 v17, v17, v33
    v_mfma_f32_16x16x32_bf16 v[52:55], v[200:203], a[28:31], v[52:55]
    ds_read_b128 v[224:227], v186 offset:1024
    buffer_load_dwordx4 a[156:159], v252, s[24:27], s73 offen offset:1024 sc1
    v_mul_f32 v18, v18, v34
    v_mul_f32 v19, v19, v35
    v_cvt_pk_bf16_f32 v244, v8, v9
    v_mfma_f32_16x16x32_bf16 v[52:55], v[196:199], a[20:23], v[52:55]
    v_cvt_pk_bf16_f32 v245, v10, v11
    v_cvt_pk_bf16_f32 v246, v16, v17
    v_cvt_pk_bf16_f32 v247, v18, v19
    buffer_store_dwordx4 v[244:247], v3, s[24:27], s52 offen offset:2048 sc1
    s_waitcnt lgkmcnt(4)
    v_mfma_f32_16x16x32_bf16 v[60:63], v[204:207], a[20:23], v[60:63]
    ds_read_b128 v[196:199], v188 offset:19456
    buffer_load_dwordx4 v3, s[24:27], s75 offen offset:2048 sc1 lds
    v_fmac_f32 v12, v185, v228
    v_fmac_f32 v13, v185, v229
    v_fmac_f32 v14, v185, v230
    v_mfma_f32_16x16x32_bf16 v[60:63], v[208:211], a[28:31], v[60:63]
    v_fmac_f32 v15, v185, v231
    v_fmac_f32 v20, v185, v232
    v_fmac_f32 v21, v185, v233
    v_fmac_f32 v22, v185, v234
    v_fmac_f32 v23, v185, v235
    v_mfma_f32_16x16x32_bf16 v[56:59], v[208:211], a[24:27], v[56:59]
    ds_read_b128 v[200:203], v186 offset:2048
    v_fmac_f32 v28, v185, v236
    v_fmac_f32 v29, v185, v237
    v_fmac_f32 v30, v185, v238
    v_fmac_f32 v31, v185, v239
    v_mfma_f32_16x16x32_bf16 v[56:59], v[204:207], a[16:19], v[56:59]
    s_add_u32 m0, s40, 27648
    v_fmac_f32 v36, v185, v240
    v_fmac_f32 v37, v185, v241
    v_fmac_f32 v38, v185, v242
    s_waitcnt lgkmcnt(4)
    v_mfma_f32_16x16x32_bf16 v[64:67], v[212:215], a[16:19], v[64:67]
    ds_read_b128 v[204:207], v188 offset:20480
    s_add_u32 s75, s49, 101376
    v_fmac_f32 v39, v185, v243
    v_max_f32 v12, 0, v12
    v_max_f32 v13, 0, v13
    v_mfma_f32_16x16x32_bf16 v[64:67], v[216:219], a[24:27], v[64:67]
    v_max_f32 v14, 0, v14
    v_max_f32 v15, 0, v15
    v_max_f32 v20, 0, v20
    v_max_f32 v21, 0, v21
    v_max_f32 v22, 0, v22
    v_mfma_f32_16x16x32_bf16 v[68:71], v[216:219], a[28:31], v[68:71]
    ds_read_b128 v[208:211], v186 offset:3072
    v_max_f32 v23, 0, v23
    v_mul_f32 v12, v12, v28
    v_mul_f32 v13, v13, v29
    v_mul_f32 v14, v14, v30
    v_mfma_f32_16x16x32_bf16 v[68:71], v[212:215], a[20:23], v[68:71]
    buffer_load_dwordx4 v3, s[24:27], s75 offen offset:0 sc1 lds
    v_mul_f32 v15, v15, v31
    v_mul_f32 v20, v20, v36
    v_mul_f32 v21, v21, v37
    s_waitcnt lgkmcnt(4)
    v_mfma_f32_16x16x32_bf16 v[84:87], v[220:223], a[20:23], v[84:87]
    ds_read_b128 v[212:215], v186 offset:4096
    v_mul_f32 v22, v22, v38
    v_mul_f32 v23, v23, v39
    v_cvt_pk_bf16_f32 v248, v12, v13
    v_cvt_pk_bf16_f32 v249, v14, v15
    v_mfma_f32_16x16x32_bf16 v[84:87], v[224:227], a[28:31], v[84:87]
    s_add_u32 s73, s63, 4096
    v_cvt_pk_bf16_f32 v250, v20, v21
    v_cvt_pk_bf16_f32 v251, v22, v23
    buffer_store_dwordx4 v[248:251], v3, s[24:27], s53 offen offset:2048 sc1
    v_mfma_f32_16x16x32_bf16 v[80:83], v[224:227], a[24:27], v[80:83]
    ds_read_b128 v[216:219], v186 offset:10240
    v_mfma_f32_16x16x32_bf16 v[80:83], v[220:223], a[16:19], v[80:83]
    s_waitcnt lgkmcnt(4)
    v_mfma_f32_16x16x32_bf16 v[88:91], v[196:199], a[16:19], v[88:91]
    ds_read_b128 v[220:223], v186 offset:5120
    s_waitcnt vmcnt(12)
    v_cmp_ne_u32 vcc, s3, v193
    s_cbranch_vccnz SLOW_44
BACK_45:
    v_mfma_f32_16x16x32_bf16 v[88:91], v[200:203], a[24:27], v[88:91]
    v_mfma_f32_16x16x32_bf16 v[92:95], v[200:203], a[28:31], v[92:95]
    ds_read_b128 v[224:227], v186 offset:11264
    buffer_load_dwordx4 v3, s[24:27], s75 offen offset:1024 sc1 lds
    s_lshl_b32 s68, s45, 2
    s_add_u32 s68, s68, s44
    s_lshl_b32 s69, s68, 2
    v_mfma_f32_16x16x32_bf16 v[92:95], v[196:199], a[20:23], v[92:95]
    buffer_load_dwordx4 a[160:163], v3, s[24:27], s73 offen offset:0 sc1
    s_add_u32 s69, s69, s36
    s_lshl_b32 s69, s69, 13
    s_add_u32 s69, s69, 46137344
    s_waitcnt lgkmcnt(4)
    v_mfma_f32_16x16x32_bf16 v[76:79], v[204:207], a[20:23], v[76:79]
    ds_read_b128 v[196:199], v186 offset:6144
    s_lshl_b32 s35, s68, 10
    s_lshl_b32 s71, s36, 6
    s_add_u32 s35, s35, s71
    s_add_u32 s35, s35, 51445760
    v_mfma_f32_16x16x32_bf16 v[76:79], v[208:211], a[28:31], v[76:79]
    s_lshl_b32 s71, s43, 8
    s_add_u32 s70, s35, s71
    s_mul_i32 s68, s68, 98304
    s_lshl_b32 s71, s36, 11
    s_add_u32 s68, s68, s71
    v_mfma_f32_16x16x32_bf16 v[72:75], v[208:211], a[24:27], v[72:75]
    ds_read_b128 v[200:203], v186 offset:12288
    s_add_u32 s68, s68, 33554432
    s_add_u32 s16, s43, 1
    s_and_b32 s16, s16, 3
    s_mul_i32 s16, s16, 24576
    v_mfma_f32_16x16x32_bf16 v[72:75], v[204:207], a[16:19], v[72:75]
    s_add_u32 s16, s16, s68
    s_add_u32 s17, s43, 2
    s_and_b32 s17, s17, 3
    s_mul_i32 s17, s17, 24576
    s_waitcnt lgkmcnt(4)
    v_mfma_f32_16x16x32_bf16 v[40:43], v[212:215], a[32:35], v[40:43]
    ds_read_b128 v[204:207], v186 offset:7168
    s_add_u32 s17, s17, s68
    s_add_u32 s17, s17, 8192
    s_add_u32 s18, s43, 3
    s_and_b32 s18, s18, 3
    v_mfma_f32_16x16x32_bf16 v[40:43], v[216:219], a[40:43], v[40:43]
    buffer_load_dwordx4 v3, s[24:27], s75 offen offset:2048 sc1 lds
    s_mul_i32 s18, s18, 24576
    s_add_u32 s18, s18, s68
    s_add_u32 s18, s18, 16384
    s_sub_u32 s19, s43, s36
    v_mfma_f32_16x16x32_bf16 v[44:47], v[216:219], a[44:47], v[44:47]
    ds_read_b128 v[208:211], v186 offset:13312
    buffer_load_dwordx4 a[164:167], v252, s[24:27], s73 offen offset:0 sc1
    s_and_b32 s19, s19, 3
    s_lshl_b32 s19, s19, 11
    s_add_u32 s19, s19, s69
    v_mfma_f32_16x16x32_bf16 v[44:47], v[212:215], a[36:39], v[44:47]
    s_mul_i32 s20, s43, 24576
    s_add_u32 s20, s20, s68
    s_add_u32 s21, s20, 8192
    s_add_u32 s22, s20, 16384
    s_waitcnt lgkmcnt(4)
    v_mfma_f32_16x16x32_bf16 v[52:55], v[220:223], a[36:39], v[52:55]
    ds_read_b128 v[212:215], v186 offset:8192
    s_add_u32 s23, s69, 4096
    v_mov_b32 v177, 0xff
    v_add_u32 v5, s43, v2
    v_and_b32 v5, 3, v5
    v_mfma_f32_16x16x32_bf16 v[52:55], v[224:227], a[44:47], v[52:55]
    v_lshlrev_b32 v6, 2, v2
    v_lshl_add_u32 v169, v5, 8, v6
    v_and_b32 v170, 4, v6
    s_cmp_eq_u32 s36, s43
    s_cselect_b32 s6, 0xff, 0
    s_cselect_b32 s4, 0, 0x40000000
    s_cselect_b32 s5, 0x40000000, 0
    v_mfma_f32_16x16x32_bf16 v[48:51], v[224:227], a[40:43], v[48:51]
    ds_read_b128 v[216:219], v186 offset:14336
    v_or_b32 v179, s4, v3
    v_or_b32 v168, s5, v3
    v_lshrrev_b32 v5, 4, v2
    v_and_b32 v6, 15, v2
    v_mfma_f32_16x16x32_bf16 v[48:51], v[220:223], a[32:35], v[48:51]
    v_lshrrev_b32 v7, 2, v2
    v_mul_u32_u24 v171, 4032, v7
    v_add_u32 v171, v171, v3
    s_mul_i32 s37, s44, 144
    s_waitcnt lgkmcnt(4)
    v_mfma_f32_16x16x32_bf16 v[56:59], v[196:199], a[32:35], v[56:59]
    ds_read_b128 v[220:223], v186 offset:9216
    s_lshl_b32 s38, s43, 5
    s_add_u32 s38, s38, s37
    s_lshl_b32 s39, s46, 4
    s_add_u32 s38, s38, s39
    v_mfma_f32_16x16x32_bf16 v[56:59], v[200:203], a[40:43], v[56:59]
    s_lshl_b32 s39, s39, 3
    s_xor_b32 s39, s39, 128
    s_add_u32 s37, s37, s39
    s_lshl_b32 s39, s45, 6
    s_lshl_b32 s71, s30, 5
    v_mfma_f32_16x16x32_bf16 v[60:63], v[200:203], a[44:47], v[60:63]
    ds_read_b128 v[224:227], v186 offset:15360
    s_add_u32 m0, s40, 49152
    s_add_u32 s39, s39, s71
    s_lshl_b32 s71, s31, 10
    s_add_u32 s39, s39, s71
    v_mfma_f32_16x16x32_bf16 v[60:63], v[196:199], a[36:39], v[60:63]
    s_add_u32 s75, s49, 122880
    s_lshl_b32 s71, s39, 1
    s_add_u32 s71, s71, 4718592
    s_lshl_b32 s32, s38, 12
    s_waitcnt lgkmcnt(4)
    v_mfma_f32_16x16x32_bf16 v[68:71], v[204:207], a[36:39], v[68:71]
    ds_read_b128 v[196:199], v186 offset:16384
    buffer_load_dwordx4 a[168:171], v3, s[24:27], s73 offen offset:1024 sc1
    s_add_u32 s32, s32, s71
    s_lshl_b32 s33, s37, 12
    s_add_u32 s33, s33, s71
    v_mfma_f32_16x16x32_bf16 v[68:71], v[208:211], a[44:47], v[68:71]
    s_sub_u32 s33, s33, 2048
    v_add_u32 v7, s39, v6
    v_mul_u32_u24 v7, 1152, v7
    s_lshl_b32 s38, s38, 1
    s_lshl_b32 s37, s37, 1
    v_mfma_f32_16x16x32_bf16 v[64:67], v[208:211], a[40:43], v[64:67]
    s_barrier
    ds_read_b128 v[200:203], v186 offset:22528
    s_or_b32 s37, s37, s4
    v_lshl_add_u32 v175, v5, 4, v7
    v_add_u32 v175, s38, v175
    v_mfma_f32_16x16x32_bf16 v[64:67], v[204:207], a[32:35], v[64:67]
    buffer_load_dwordx4 v3, s[24:27], s75 offen offset:0 sc1 lds
    v_lshl_add_u32 v176, v5, 3, v7
    v_add_u32 v176, s37, v176
    s_lshl_b32 s71, s36, 8
    s_waitcnt lgkmcnt(4)
    v_mfma_f32_16x16x32_bf16 v[80:83], v[212:215], a[32:35], v[80:83]
    ds_read_b128 v[204:207], v186 offset:17408
    s_add_u32 s71, s71, 2564
    v_lshl_add_u32 v7, v6, 3, s71
    ds_read_b32 v173, v7
    ds_read_b32 v174, v7 offset:128
    v_mfma_f32_16x16x32_bf16 v[80:83], v[216:219], a[40:43], v[80:83]
    s_mov_b32 s12, s60
    s_mov_b32 s13, s61
    s_mov_b32 s14, 2359296
    s_mov_b32 s15, 0x00020000
    s_mov_b32 s34, 18432
    v_mfma_f32_16x16x32_bf16 v[84:87], v[216:219], a[44:47], v[84:87]
    ds_read_b128 v[208:211], v186 offset:23552
    buffer_load_dwordx4 a[172:175], v252, s[24:27], s73 offen offset:1024 sc1
    s_mov_b32 s4, 0x3f80
    s_mov_b32 s5, 0x3f800000
    s_add_u32 s39, s32, 64512
    v_mfma_f32_16x16x32_bf16 v[84:87], v[212:215], a[36:39], v[84:87]
    s_mul_i32 s71, s36, 3072
    s_add_u32 s71, s71, 4096
    v_and_b32 v6, 3, v2
    v_lshlrev_b32 v6, 3, v6
    s_waitcnt lgkmcnt(6)
    v_mfma_f32_16x16x32_bf16 v[92:95], v[220:223], a[36:39], v[92:95]
    ds_read_b128 v[212:215], v186 offset:18432
    v_sub_u32 v6, v3, v6
    v_lshl_add_u32 v172, v5, 8, v6
    v_add_u32 v172, s71, v172
    v_add_u32 v7, s71, v6
    v_mfma_f32_16x16x32_bf16 v[92:95], v[224:227], a[44:47], v[92:95]
    buffer_load_dwordx4 v3, s[24:27], s75 offen offset:1024 sc1 lds
    s_add_u32 s73, s63, 14336
    v_mfma_f32_16x16x32_bf16 v[88:91], v[224:227], a[40:43], v[88:91]
    ds_read_b128 v[216:219], v188 offset:24576
    v_mfma_f32_16x16x32_bf16 v[88:91], v[220:223], a[32:35], v[88:91]
    s_waitcnt lgkmcnt(6)
    v_mfma_f32_16x16x32_bf16 v[40:43], v[196:199], a[48:51], v[40:43]
    ds_read_b128 v[220:223], v186 offset:19456
    v_mfma_f32_16x16x32_bf16 v[40:43], v[200:203], a[56:59], v[40:43]
    v_mfma_f32_16x16x32_bf16 v[44:47], v[200:203], a[60:63], v[44:47]
    ds_read_b128 v[224:227], v188 offset:25600
    buffer_load_dwordx4 a[176:179], v3, s[24:27], s73 offen offset:0 sc1
    v_mfma_f32_16x16x32_bf16 v[44:47], v[196:199], a[52:55], v[44:47]
    s_waitcnt lgkmcnt(4)
    v_mfma_f32_16x16x32_bf16 v[52:55], v[204:207], a[52:55], v[52:55]
    ds_read_b128 v[196:199], v186 offset:20480
    buffer_load_dwordx4 v3, s[24:27], s75 offen offset:2048 sc1 lds
    v_mfma_f32_16x16x32_bf16 v[52:55], v[208:211], a[60:63], v[52:55]
    s_waitcnt vmcnt(10)
    s_lshl_b32 s74, s36, 4
    s_add_u32 s74, s74, s66
    s_mov_b64 exec, 1
    v_mov_b32 v192, s3
    buffer_store_dword v192, v4, s[24:27], s74 offen offset:128 sc1
    s_mov_b64 exec, -1
    v_mfma_f32_16x16x32_bf16 v[48:51], v[208:211], a[56:59], v[48:51]
    ds_read_b128 v[200:203], v188 offset:26624
    v_mfma_f32_16x16x32_bf16 v[48:51], v[204:207], a[48:51], v[48:51]
    s_add_u32 m0, s40, 52224
    s_waitcnt lgkmcnt(4)
    v_mfma_f32_16x16x32_bf16 v[56:59], v[212:215], a[48:51], v[56:59]
    ds_read_b128 v[204:207], v186 offset:21504
    s_add_u32 s75, s49, 125952
    v_mfma_f32_16x16x32_bf16 v[56:59], v[216:219], a[56:59], v[56:59]
    v_mfma_f32_16x16x32_bf16 v[60:63], v[216:219], a[60:63], v[60:63]
    ds_read_b128 v[208:211], v188 offset:27648
    buffer_load_dwordx4 a[180:183], v252, s[24:27], s73 offen offset:0 sc1
    v_mfma_f32_16x16x32_bf16 v[60:63], v[212:215], a[52:55], v[60:63]
    buffer_load_dwordx4 v3, s[24:27], s75 offen offset:0 sc1 lds
    s_waitcnt lgkmcnt(4)
    v_mfma_f32_16x16x32_bf16 v[68:71], v[220:223], a[52:55], v[68:71]
    ds_read_b128 v[212:215], v188 offset:28672
    v_mfma_f32_16x16x32_bf16 v[68:71], v[224:227], a[60:63], v[68:71]
    v_mfma_f32_16x16x32_bf16 v[64:67], v[224:227], a[56:59], v[64:67]
    ds_read_b128 v[216:219], v188 offset:34816
    v_mfma_f32_16x16x32_bf16 v[64:67], v[220:223], a[48:51], v[64:67]
    s_waitcnt lgkmcnt(4)
    v_mfma_f32_16x16x32_bf16 v[80:83], v[196:199], a[48:51], v[80:83]
    ds_read_b128 v[220:223], v188 offset:29696
    v_mfma_f32_16x16x32_bf16 v[80:83], v[200:203], a[56:59], v[80:83]
    v_mfma_f32_16x16x32_bf16 v[84:87], v[200:203], a[60:63], v[84:87]
    ds_read_b128 v[224:227], v188 offset:35840
    buffer_load_dwordx4 v3, s[24:27], s75 offen offset:1024 sc1 lds
    v_mfma_f32_16x16x32_bf16 v[84:87], v[196:199], a[52:55], v[84:87]
    buffer_load_dwordx4 a[184:187], v3, s[24:27], s73 offen offset:1024 sc1
    s_waitcnt lgkmcnt(4)
    v_mfma_f32_16x16x32_bf16 v[92:95], v[204:207], a[52:55], v[92:95]
    ds_read_b128 v[196:199], v188 offset:30720
    v_mfma_f32_16x16x32_bf16 v[92:95], v[208:211], a[60:63], v[92:95]
    v_mfma_f32_16x16x32_bf16 v[88:91], v[208:211], a[56:59], v[88:91]
    ds_read_b128 v[200:203], v188 offset:36864
    v_mfma_f32_16x16x32_bf16 v[88:91], v[204:207], a[48:51], v[88:91]
    s_waitcnt lgkmcnt(4)
    v_mfma_f32_16x16x32_bf16 v[40:43], v[212:215], a[64:67], v[40:43]
    ds_read_b128 v[204:207], v188 offset:31744
    v_mfma_f32_16x16x32_bf16 v[40:43], v[216:219], a[72:75], v[40:43]
    buffer_load_dwordx4 v3, s[24:27], s75 offen offset:2048 sc1 lds
    v_mfma_f32_16x16x32_bf16 v[44:47], v[216:219], a[76:79], v[44:47]
    ds_read_b128 v[208:211], v188 offset:37888
    buffer_load_dwordx4 a[188:191], v252, s[24:27], s73 offen offset:1024 sc1
    v_mfma_f32_16x16x32_bf16 v[44:47], v[212:215], a[68:71], v[44:47]
    s_waitcnt lgkmcnt(4)
    v_mfma_f32_16x16x32_bf16 v[52:55], v[220:223], a[68:71], v[52:55]
    ds_read_b128 v[212:215], v188 offset:32768
    v_mfma_f32_16x16x32_bf16 v[52:55], v[224:227], a[76:79], v[52:55]
    s_add_u32 s73, s63, 22528
    v_mfma_f32_16x16x32_bf16 v[48:51], v[224:227], a[72:75], v[48:51]
    ds_read_b128 v[216:219], v188 offset:38912
    v_mfma_f32_16x16x32_bf16 v[48:51], v[220:223], a[64:67], v[48:51]
    s_waitcnt lgkmcnt(4)
    v_mfma_f32_16x16x32_bf16 v[56:59], v[196:199], a[64:67], v[56:59]
    ds_read_b128 v[220:223], v188 offset:33792
    v_mfma_f32_16x16x32_bf16 v[56:59], v[200:203], a[72:75], v[56:59]
    v_mfma_f32_16x16x32_bf16 v[60:63], v[200:203], a[76:79], v[60:63]
    ds_read_b128 v[224:227], v188 offset:39936
    s_add_u32 m0, s40, 98304
    v_mfma_f32_16x16x32_bf16 v[60:63], v[196:199], a[68:71], v[60:63]
    s_add_u32 s75, s49, 147456
    s_waitcnt lgkmcnt(4)
    v_mfma_f32_16x16x32_bf16 v[68:71], v[204:207], a[68:71], v[68:71]
    ds_read_b128 v[196:199], v188 offset:40960
    buffer_load_dwordx4 a[192:195], v3, s[24:27], s73 offen offset:0 sc1
    v_mfma_f32_16x16x32_bf16 v[68:71], v[208:211], a[76:79], v[68:71]
    v_mfma_f32_16x16x32_bf16 v[64:67], v[208:211], a[72:75], v[64:67]
    s_barrier
    ds_read_b128 v[200:203], v188 offset:47104
    v_mfma_f32_16x16x32_bf16 v[64:67], v[204:207], a[64:67], v[64:67]
    buffer_load_dwordx4 v3, s[24:27], s75 offen offset:0 sc1 lds
    s_waitcnt lgkmcnt(4)
    v_mfma_f32_16x16x32_bf16 v[80:83], v[212:215], a[64:67], v[80:83]
    ds_read_b128 v[204:207], v188 offset:41984
    v_mfma_f32_16x16x32_bf16 v[80:83], v[216:219], a[72:75], v[80:83]
    v_mfma_f32_16x16x32_bf16 v[84:87], v[216:219], a[76:79], v[84:87]
    ds_read_b128 v[208:211], v188 offset:48128
    buffer_load_dwordx4 a[196:199], v252, s[24:27], s73 offen offset:0 sc1
    v_mfma_f32_16x16x32_bf16 v[84:87], v[212:215], a[68:71], v[84:87]
    s_waitcnt lgkmcnt(4)
    v_mfma_f32_16x16x32_bf16 v[92:95], v[220:223], a[68:71], v[92:95]
    ds_read_b128 v[212:215], v188 offset:43008
    v_mfma_f32_16x16x32_bf16 v[92:95], v[224:227], a[76:79], v[92:95]
    buffer_load_dwordx4 v3, s[24:27], s75 offen offset:1024 sc1 lds
    v_mfma_f32_16x16x32_bf16 v[88:91], v[224:227], a[72:75], v[88:91]
    ds_read_b128 v[216:219], v187 offset:24576
    v_mfma_f32_16x16x32_bf16 v[88:91], v[220:223], a[64:67], v[88:91]
    s_waitcnt lgkmcnt(4)
    v_mfma_f32_16x16x32_bf16 v[40:43], v[196:199], a[80:83], v[40:43]
    ds_read_b128 v[220:223], v188 offset:44032
    v_mfma_f32_16x16x32_bf16 v[40:43], v[200:203], a[88:91], v[40:43]
    v_mfma_f32_16x16x32_bf16 v[44:47], v[200:203], a[92:95], v[44:47]
    ds_read_b128 v[224:227], v187 offset:25600
    buffer_load_dwordx4 a[200:203], v3, s[24:27], s73 offen offset:1024 sc1
    v_mfma_f32_16x16x32_bf16 v[44:47], v[196:199], a[84:87], v[44:47]
    s_waitcnt lgkmcnt(4)
    v_mfma_f32_16x16x32_bf16 v[52:55], v[204:207], a[84:87], v[52:55]
    ds_read_b128 v[196:199], v188 offset:45056
    buffer_load_dwordx4 v3, s[24:27], s75 offen offset:2048 sc1 lds
    v_mfma_f32_16x16x32_bf16 v[52:55], v[208:211], a[92:95], v[52:55]
    v_mfma_f32_16x16x32_bf16 v[48:51], v[208:211], a[88:91], v[48:51]
    ds_read_b128 v[200:203], v187 offset:26624
    v_mfma_f32_16x16x32_bf16 v[48:51], v[204:207], a[80:83], v[48:51]
    s_add_u32 m0, s40, 101376
    s_waitcnt lgkmcnt(4)
    v_mfma_f32_16x16x32_bf16 v[56:59], v[212:215], a[80:83], v[56:59]
    ds_read_b128 v[204:207], v188 offset:46080
    s_add_u32 s75, s49, 150528
    v_mfma_f32_16x16x32_bf16 v[56:59], v[216:219], a[88:91], v[56:59]
    v_mfma_f32_16x16x32_bf16 v[60:63], v[216:219], a[92:95], v[60:63]
    ds_read_b128 v[208:211], v187 offset:27648
    buffer_load_dwordx4 a[204:207], v252, s[24:27], s73 offen offset:1024 sc1
    v_mfma_f32_16x16x32_bf16 v[60:63], v[212:215], a[84:87], v[60:63]
    buffer_load_dwordx4 v3, s[24:27], s75 offen offset:0 sc1 lds
    s_waitcnt lgkmcnt(4)
    v_mfma_f32_16x16x32_bf16 v[68:71], v[220:223], a[84:87], v[68:71]
    ds_read_b128 v[212:215], v187 offset:28672
    v_mfma_f32_16x16x32_bf16 v[68:71], v[224:227], a[92:95], v[68:71]
    s_add_u32 s73, s63, 32768
    v_mfma_f32_16x16x32_bf16 v[64:67], v[224:227], a[88:91], v[64:67]
    ds_read_b128 v[216:219], v187 offset:32768
    v_mfma_f32_16x16x32_bf16 v[64:67], v[220:223], a[80:83], v[64:67]
    s_waitcnt lgkmcnt(4)
    v_mfma_f32_16x16x32_bf16 v[80:83], v[196:199], a[80:83], v[80:83]
    ds_read_b128 v[220:223], v187 offset:29696
    v_mfma_f32_16x16x32_bf16 v[80:83], v[200:203], a[88:91], v[80:83]
    v_mfma_f32_16x16x32_bf16 v[84:87], v[200:203], a[92:95], v[84:87]
    ds_read_b128 v[224:227], v187 offset:33792
    buffer_load_dwordx4 v3, s[24:27], s75 offen offset:1024 sc1 lds
    v_mfma_f32_16x16x32_bf16 v[84:87], v[196:199], a[84:87], v[84:87]
    buffer_load_dwordx4 a[208:211], v3, s[24:27], s73 offen offset:0 sc1
    s_waitcnt lgkmcnt(4)
    v_mfma_f32_16x16x32_bf16 v[92:95], v[204:207], a[84:87], v[92:95]
    ds_read_b128 v[196:199], v187 offset:30720
    v_mfma_f32_16x16x32_bf16 v[92:95], v[208:211], a[92:95], v[92:95]
    buffer_load_dword v193, v191, s[24:27], s65 offen offset:128 sc1
    v_mfma_f32_16x16x32_bf16 v[88:91], v[208:211], a[88:91], v[88:91]
    ds_read_b128 v[200:203], v187 offset:34816
    v_mfma_f32_16x16x32_bf16 v[88:91], v[204:207], a[80:83], v[88:91]
    s_waitcnt lgkmcnt(4)
    v_mfma_f32_16x16x32_bf16 v[40:43], v[212:215], a[96:99], v[40:43]
    ds_read_b128 v[204:207], v187 offset:31744
    v_mfma_f32_16x16x32_bf16 v[40:43], v[216:219], a[104:107], v[40:43]
    buffer_load_dwordx4 v3, s[24:27], s75 offen offset:2048 sc1 lds
    v_mfma_f32_16x16x32_bf16 v[44:47], v[216:219], a[108:111], v[44:47]
    ds_read_b128 v[208:211], v187 offset:35840
    buffer_load_dwordx4 a[212:215], v252, s[24:27], s73 offen offset:0 sc1
    v_mfma_f32_16x16x32_bf16 v[44:47], v[212:215], a[100:103], v[44:47]
    s_waitcnt lgkmcnt(4)
    v_mfma_f32_16x16x32_bf16 v[52:55], v[220:223], a[100:103], v[52:55]
    ds_read_b128 v[212:215], v187 offset:36864
    v_mfma_f32_16x16x32_bf16 v[52:55], v[224:227], a[108:111], v[52:55]
    v_mfma_f32_16x16x32_bf16 v[48:51], v[224:227], a[104:107], v[48:51]
    ds_read_b128 v[216:219], v187 offset:40960
    v_mfma_f32_16x16x32_bf16 v[48:51], v[220:223], a[96:99], v[48:51]
    s_waitcnt lgkmcnt(4)
    v_mfma_f32_16x16x32_bf16 v[56:59], v[196:199], a[96:99], v[56:59]
    ds_read_b128 v[220:223], v187 offset:37888
    v_mfma_f32_16x16x32_bf16 v[56:59], v[200:203], a[104:107], v[56:59]
    v_mfma_f32_16x16x32_bf16 v[60:63], v[200:203], a[108:111], v[60:63]
    ds_read_b128 v[224:227], v187 offset:41984
    s_add_u32 m0, s40, 0
    v_mfma_f32_16x16x32_bf16 v[60:63], v[196:199], a[100:103], v[60:63]
    s_add_u32 s75, s49, 172032
    s_waitcnt lgkmcnt(4)
    v_mfma_f32_16x16x32_bf16 v[68:71], v[204:207], a[100:103], v[68:71]
    ds_read_b128 v[196:199], v187 offset:38912
    buffer_load_dwordx4 a[216:219], v3, s[24:27], s73 offen offset:1024 sc1
    v_mfma_f32_16x16x32_bf16 v[68:71], v[208:211], a[108:111], v[68:71]
    v_mfma_f32_16x16x32_bf16 v[64:67], v[208:211], a[104:107], v[64:67]
    s_waitcnt vmcnt(28)
    s_barrier
    ds_read_b128 v[200:203], v187 offset:43008
    v_mfma_f32_16x16x32_bf16 v[64:67], v[204:207], a[96:99], v[64:67]
    buffer_load_dwordx4 v3, s[24:27], s75 offen offset:0 sc1 lds
    s_waitcnt lgkmcnt(4)
    v_mfma_f32_16x16x32_bf16 v[40:43], v[212:215], a[112:115], v[40:43]
    ds_read_b128 v[204:207], v187 offset:39936
    v_mfma_f32_16x16x32_bf16 v[40:43], v[216:219], a[120:123], v[40:43]
    v_mfma_f32_16x16x32_bf16 v[44:47], v[216:219], a[124:127], v[44:47]
    ds_read_b128 v[208:211], v187 offset:44032
    buffer_load_dwordx4 a[220:223], v252, s[24:27], s73 offen offset:1024 sc1
    v_mfma_f32_16x16x32_bf16 v[44:47], v[212:215], a[116:119], v[44:47]
    s_waitcnt lgkmcnt(4)
    v_mfma_f32_16x16x32_bf16 v[52:55], v[220:223], a[116:119], v[52:55]
    ds_read_b128 v[212:215], v187 offset:45056
    v_mfma_f32_16x16x32_bf16 v[52:55], v[224:227], a[124:127], v[52:55]
    buffer_load_dwordx4 v3, s[24:27], s75 offen offset:1024 sc1 lds
    v_mfma_f32_16x16x32_bf16 v[48:51], v[224:227], a[120:123], v[48:51]
    ds_read_b128 v[216:219], v186 offset:24576
    v_mfma_f32_16x16x32_bf16 v[48:51], v[220:223], a[112:115], v[48:51]
    s_waitcnt lgkmcnt(4)
    v_mfma_f32_16x16x32_bf16 v[56:59], v[196:199], a[112:115], v[56:59]
    ds_read_b128 v[220:223], v187 offset:46080
    v_mfma_f32_16x16x32_bf16 v[56:59], v[200:203], a[120:123], v[56:59]
    v_mfma_f32_16x16x32_bf16 v[60:63], v[200:203], a[124:127], v[60:63]
    ds_read_b128 v[224:227], v186 offset:25600
    v_mfma_f32_16x16x32_bf16 v[60:63], v[196:199], a[116:119], v[60:63]
    s_waitcnt lgkmcnt(4)
    v_mfma_f32_16x16x32_bf16 v[68:71], v[204:207], a[116:119], v[68:71]
    ds_read_b128 v[196:199], v187 offset:47104
    buffer_load_dwordx4 v3, s[24:27], s75 offen offset:2048 sc1 lds
    v_mfma_f32_16x16x32_bf16 v[68:71], v[208:211], a[124:127], v[68:71]
    v_mfma_f32_16x16x32_bf16 v[64:67], v[208:211], a[120:123], v[64:67]
    ds_read_b128 v[200:203], v186 offset:26624
    v_mfma_f32_16x16x32_bf16 v[64:67], v[204:207], a[112:115], v[64:67]
    s_add_u32 m0, s40, 3072
    s_waitcnt lgkmcnt(4)
    v_mfma_f32_16x16x32_bf16 v[40:43], v[212:215], a[128:131], v[40:43]
    ds_read_b128 v[204:207], v187 offset:48128
    s_add_u32 s75, s49, 175104
    v_mfma_f32_16x16x32_bf16 v[40:43], v[216:219], a[136:139], v[40:43]
    s_add_u32 s73, s63, 6144
    v_mfma_f32_16x16x32_bf16 v[44:47], v[216:219], a[140:143], v[44:47]
    ds_read_b128 v[208:211], v186 offset:27648
    v_mfma_f32_16x16x32_bf16 v[44:47], v[212:215], a[132:135], v[44:47]
    buffer_load_dwordx4 v3, s[24:27], s75 offen offset:0 sc1 lds
    s_waitcnt lgkmcnt(4)
    v_mfma_f32_16x16x32_bf16 v[52:55], v[220:223], a[132:135], v[52:55]
    ds_read_b128 v[212:215], v186 offset:28672
    s_waitcnt vmcnt(8)
    v_cmp_ne_u32 vcc, s3, v193
    s_cbranch_vccnz SLOW_48
BACK_49:
    v_mfma_f32_16x16x32_bf16 v[52:55], v[224:227], a[140:143], v[52:55]
    v_mfma_f32_16x16x32_bf16 v[48:51], v[224:227], a[136:139], v[48:51]
    ds_read_b128 v[216:219], v186 offset:32768
    buffer_load_dwordx4 a[224:227], v3, s[24:27], s73 offen offset:0 sc1
    v_mfma_f32_16x16x32_bf16 v[48:51], v[220:223], a[128:131], v[48:51]
    s_waitcnt lgkmcnt(4)
    v_mfma_f32_16x16x32_bf16 v[56:59], v[196:199], a[128:131], v[56:59]
    ds_read_b128 v[220:223], v186 offset:29696
    v_mfma_f32_16x16x32_bf16 v[56:59], v[200:203], a[136:139], v[56:59]
    v_mfma_f32_16x16x32_bf16 v[60:63], v[200:203], a[140:143], v[60:63]
    ds_read_b128 v[224:227], v186 offset:33792
    buffer_load_dwordx4 v3, s[24:27], s75 offen offset:1024 sc1 lds
    v_mfma_f32_16x16x32_bf16 v[60:63], v[196:199], a[132:135], v[60:63]
    buffer_load_dwordx4 a[228:231], v252, s[24:27], s73 offen offset:0 sc1
    s_waitcnt lgkmcnt(4)
    v_mfma_f32_16x16x32_bf16 v[68:71], v[204:207], a[132:135], v[68:71]
    ds_read_b128 v[196:199], v186 offset:30720
    v_mfma_f32_16x16x32_bf16 v[68:71], v[208:211], a[140:143], v[68:71]
    v_mfma_f32_16x16x32_bf16 v[64:67], v[208:211], a[136:139], v[64:67]
    ds_read_b128 v[200:203], v186 offset:34816
    buffer_load_dwordx4 a[232:235], v3, s[24:27], s73 offen offset:1024 sc1
    v_mfma_f32_16x16x32_bf16 v[64:67], v[204:207], a[128:131], v[64:67]
    s_waitcnt lgkmcnt(4)
    v_mfma_f32_16x16x32_bf16 v[40:43], v[212:215], a[144:147], v[40:43]
    ds_read_b128 v[204:207], v186 offset:31744
    v_mfma_f32_16x16x32_bf16 v[40:43], v[216:219], a[152:155], v[40:43]
    buffer_load_dwordx4 v3, s[24:27], s75 offen offset:2048 sc1 lds
    v_mfma_f32_16x16x32_bf16 v[44:47], v[216:219], a[156:159], v[44:47]
    ds_read_b128 v[208:211], v186 offset:35840
    buffer_load_dwordx4 a[236:239], v252, s[24:27], s73 offen offset:1024 sc1
    v_mfma_f32_16x16x32_bf16 v[44:47], v[212:215], a[148:151], v[44:47]
    s_add_u32 s73, s63, 16384
    s_waitcnt lgkmcnt(4)
    v_mfma_f32_16x16x32_bf16 v[52:55], v[220:223], a[148:151], v[52:55]
    ds_read_b128 v[212:215], v186 offset:36864
    v_mfma_f32_16x16x32_bf16 v[52:55], v[224:227], a[156:159], v[52:55]
    v_mfma_f32_16x16x32_bf16 v[48:51], v[224:227], a[152:155], v[48:51]
    ds_read_b128 v[216:219], v186 offset:40960
    buffer_load_dwordx4 a[240:243], v3, s[24:27], s73 offen offset:0 sc1
    v_mfma_f32_16x16x32_bf16 v[48:51], v[220:223], a[144:147], v[48:51]
    s_waitcnt lgkmcnt(4)
    v_mfma_f32_16x16x32_bf16 v[56:59], v[196:199], a[144:147], v[56:59]
    ds_read_b128 v[220:223], v186 offset:37888
    v_mfma_f32_16x16x32_bf16 v[56:59], v[200:203], a[152:155], v[56:59]
    v_mfma_f32_16x16x32_bf16 v[60:63], v[200:203], a[156:159], v[60:63]
    ds_read_b128 v[224:227], v186 offset:41984
    s_add_u32 m0, s40, 122880
    v_mfma_f32_16x16x32_bf16 v[60:63], v[196:199], a[148:151], v[60:63]
    s_add_u32 s75, s49, 196608
    s_waitcnt lgkmcnt(4)
    v_mfma_f32_16x16x32_bf16 v[68:71], v[204:207], a[148:151], v[68:71]
    ds_read_b128 v[196:199], v186 offset:38912
    buffer_load_dwordx4 a[244:247], v252, s[24:27], s73 offen offset:0 sc1
    v_mfma_f32_16x16x32_bf16 v[68:71], v[208:211], a[156:159], v[68:71]
    v_mfma_f32_16x16x32_bf16 v[64:67], v[208:211], a[152:155], v[64:67]
    s_barrier
    ds_read_b128 v[200:203], v186 offset:43008
    v_mfma_f32_16x16x32_bf16 v[64:67], v[204:207], a[144:147], v[64:67]
    buffer_load_dwordx4 v3, s[24:27], s75 offen offset:0 sc1 lds
    s_waitcnt lgkmcnt(4)
    v_mfma_f32_16x16x32_bf16 v[40:43], v[212:215], a[160:163], v[40:43]
    ds_read_b128 v[204:207], v186 offset:39936
    buffer_load_dwordx4 a[248:251], v3, s[24:27], s73 offen offset:1024 sc1
    v_mfma_f32_16x16x32_bf16 v[40:43], v[216:219], a[168:171], v[40:43]
    v_mfma_f32_16x16x32_bf16 v[44:47], v[216:219], a[172:175], v[44:47]
    ds_read_b128 v[208:211], v186 offset:44032
    buffer_load_dwordx4 a[252:255], v252, s[24:27], s73 offen offset:1024 sc1
    v_mfma_f32_16x16x32_bf16 v[44:47], v[212:215], a[164:167], v[44:47]
    s_add_u32 s73, s63, 24576
    s_waitcnt lgkmcnt(4)
    v_mfma_f32_16x16x32_bf16 v[52:55], v[220:223], a[164:167], v[52:55]
    ds_read_b128 v[212:215], v186 offset:45056
    v_mfma_f32_16x16x32_bf16 v[52:55], v[224:227], a[172:175], v[52:55]
    buffer_load_dwordx4 v3, s[24:27], s75 offen offset:1024 sc1 lds
    v_mfma_f32_16x16x32_bf16 v[48:51], v[224:227], a[168:171], v[48:51]
    ds_read_b128 v[216:219], v187 offset:0
    buffer_load_dwordx4 v[136:139], v3, s[24:27], s73 offen offset:0 sc1
    v_mfma_f32_16x16x32_bf16 v[48:51], v[220:223], a[160:163], v[48:51]
    s_waitcnt lgkmcnt(4)
    v_mfma_f32_16x16x32_bf16 v[56:59], v[196:199], a[160:163], v[56:59]
    ds_read_b128 v[220:223], v186 offset:46080
    v_mfma_f32_16x16x32_bf16 v[56:59], v[200:203], a[168:171], v[56:59]
    v_mfma_f32_16x16x32_bf16 v[60:63], v[200:203], a[172:175], v[60:63]
    ds_read_b128 v[224:227], v187 offset:1024
    buffer_load_dwordx4 v[140:143], v252, s[24:27], s73 offen offset:0 sc1
    v_mfma_f32_16x16x32_bf16 v[60:63], v[196:199], a[164:167], v[60:63]
    s_waitcnt lgkmcnt(4)
    v_mfma_f32_16x16x32_bf16 v[68:71], v[204:207], a[164:167], v[68:71]
    ds_read_b128 v[196:199], v186 offset:47104
    buffer_load_dwordx4 v3, s[24:27], s75 offen offset:2048 sc1 lds
    v_mfma_f32_16x16x32_bf16 v[68:71], v[208:211], a[172:175], v[68:71]
    v_mfma_f32_16x16x32_bf16 v[64:67], v[208:211], a[168:171], v[64:67]
    ds_read_b128 v[200:203], v187 offset:2048
    buffer_load_dwordx4 v[144:147], v3, s[24:27], s73 offen offset:1024 sc1
    v_mfma_f32_16x16x32_bf16 v[64:67], v[204:207], a[160:163], v[64:67]
    s_add_u32 m0, s40, 125952
    s_waitcnt lgkmcnt(4)
    v_mfma_f32_16x16x32_bf16 v[40:43], v[212:215], a[176:179], v[40:43]
    ds_read_b128 v[204:207], v186 offset:48128
    s_add_u32 s75, s49, 199680
    v_mfma_f32_16x16x32_bf16 v[40:43], v[216:219], a[184:187], v[40:43]
    v_mfma_f32_16x16x32_bf16 v[44:47], v[216:219], a[188:191], v[44:47]
    ds_read_b128 v[208:211], v187 offset:3072
    buffer_load_dwordx4 v[148:151], v252, s[24:27], s73 offen offset:1024 sc1
    v_mfma_f32_16x16x32_bf16 v[44:47], v[212:215], a[180:183], v[44:47]
    buffer_load_dwordx4 v3, s[24:27], s75 offen offset:0 sc1 lds
    s_waitcnt lgkmcnt(4)
    v_mfma_f32_16x16x32_bf16 v[52:55], v[220:223], a[180:183], v[52:55]
    ds_read_b128 v[212:215], v187 offset:4096
    s_add_u32 s73, s63, 34816
    v_mfma_f32_16x16x32_bf16 v[52:55], v[224:227], a[188:191], v[52:55]
    v_mfma_f32_16x16x32_bf16 v[48:51], v[224:227], a[184:187], v[48:51]
    ds_read_b128 v[216:219], v187 offset:8192
    buffer_load_dwordx4 v[152:155], v3, s[24:27], s73 offen offset:0 sc1
    v_mfma_f32_16x16x32_bf16 v[48:51], v[220:223], a[176:179], v[48:51]
    s_waitcnt lgkmcnt(4)
    v_mfma_f32_16x16x32_bf16 v[56:59], v[196:199], a[176:179], v[56:59]
    ds_read_b128 v[220:223], v187 offset:5120
    v_mfma_f32_16x16x32_bf16 v[56:59], v[200:203], a[184:187], v[56:59]
    v_mfma_f32_16x16x32_bf16 v[60:63], v[200:203], a[188:191], v[60:63]
    ds_read_b128 v[224:227], v187 offset:9216
    buffer_load_dwordx4 v3, s[24:27], s75 offen offset:1024 sc1 lds
    v_mfma_f32_16x16x32_bf16 v[60:63], v[196:199], a[180:183], v[60:63]
    buffer_load_dwordx4 v[156:159], v252, s[24:27], s73 offen offset:0 sc1
    s_waitcnt lgkmcnt(4)
    v_mfma_f32_16x16x32_bf16 v[68:71], v[204:207], a[180:183], v[68:71]
    ds_read_b128 v[196:199], v187 offset:6144
    v_mfma_f32_16x16x32_bf16 v[68:71], v[208:211], a[188:191], v[68:71]
    v_mfma_f32_16x16x32_bf16 v[64:67], v[208:211], a[184:187], v[64:67]
    ds_read_b128 v[200:203], v187 offset:10240
    buffer_load_dwordx4 v[160:163], v3, s[24:27], s73 offen offset:1024 sc1
    v_mfma_f32_16x16x32_bf16 v[64:67], v[204:207], a[176:179], v[64:67]
    s_waitcnt lgkmcnt(4)
    v_mfma_f32_16x16x32_bf16 v[40:43], v[212:215], a[192:195], v[40:43]
    ds_read_b128 v[204:207], v187 offset:7168
    v_mfma_f32_16x16x32_bf16 v[40:43], v[216:219], a[200:203], v[40:43]
    buffer_load_dwordx4 v3, s[24:27], s75 offen offset:2048 sc1 lds
    v_mfma_f32_16x16x32_bf16 v[44:47], v[216:219], a[204:207], v[44:47]
    ds_read_b128 v[208:211], v187 offset:11264
    buffer_load_dwordx4 v[164:167], v252, s[24:27], s73 offen offset:1024 sc1
    v_mfma_f32_16x16x32_bf16 v[44:47], v[212:215], a[196:199], v[44:47]
    s_waitcnt lgkmcnt(4)
    v_mfma_f32_16x16x32_bf16 v[52:55], v[220:223], a[196:199], v[52:55]
    ds_read_b128 v[212:215], v187 offset:12288
    v_mfma_f32_16x16x32_bf16 v[52:55], v[224:227], a[204:207], v[52:55]
    v_mfma_f32_16x16x32_bf16 v[48:51], v[224:227], a[200:203], v[48:51]
    ds_read_b128 v[216:219], v187 offset:16384
    v_mfma_f32_16x16x32_bf16 v[48:51], v[220:223], a[192:195], v[48:51]
    s_waitcnt lgkmcnt(4)
    v_mfma_f32_16x16x32_bf16 v[56:59], v[196:199], a[192:195], v[56:59]
    ds_read_b128 v[220:223], v187 offset:13312
    v_mfma_f32_16x16x32_bf16 v[56:59], v[200:203], a[200:203], v[56:59]
    v_mfma_f32_16x16x32_bf16 v[60:63], v[200:203], a[204:207], v[60:63]
    ds_read_b128 v[224:227], v187 offset:17408
    v_mfma_f32_16x16x32_bf16 v[60:63], v[196:199], a[196:199], v[60:63]
    s_waitcnt lgkmcnt(4)
    v_mfma_f32_16x16x32_bf16 v[68:71], v[204:207], a[196:199], v[68:71]
    ds_read_b128 v[196:199], v187 offset:14336
    s_mov_b32 m0, s71
    s_nop 0
    buffer_load_dwordx4 v171, s[24:27], s32 offen offset:0 sc1 lds
    v_mfma_f32_16x16x32_bf16 v[68:71], v[208:211], a[204:207], v[68:71]
    v_mfma_f32_16x16x32_bf16 v[64:67], v[208:211], a[200:203], v[64:67]
    ds_read_b128 v[200:203], v187 offset:18432
    buffer_load_dwordx4 v171, s[24:27], s39 offen offset:1024 sc1 lds
    v_mfma_f32_16x16x32_bf16 v[64:67], v[204:207], a[192:195], v[64:67]
    s_waitcnt vmcnt(29) lgkmcnt(4)
    v_mfma_f32_16x16x32_bf16 v[40:43], v[212:215], a[208:211], v[40:43]
    ds_read_b128 v[204:207], v187 offset:15360
    buffer_load_dwordx4 v171, s[24:27], s33 offen offset:2048 sc1 lds
    v_mfma_f32_16x16x32_bf16 v[40:43], v[216:219], a[216:219], v[40:43]
    v_mfma_f32_16x16x32_bf16 v[44:47], v[216:219], a[220:223], v[44:47]
    ds_read_b128 v[208:211], v187 offset:19456
    s_add_u32 m0, s40, 73728
    v_mfma_f32_16x16x32_bf16 v[44:47], v[212:215], a[212:215], v[44:47]
    s_add_u32 s75, s49, 221184
    s_waitcnt lgkmcnt(4)
    v_mfma_f32_16x16x32_bf16 v[52:55], v[220:223], a[212:215], v[52:55]
    ds_read_b128 v[212:215], v187 offset:20480
    v_mfma_f32_16x16x32_bf16 v[52:55], v[224:227], a[220:223], v[52:55]
    v_mfma_f32_16x16x32_bf16 v[48:51], v[224:227], a[216:219], v[48:51]
    s_barrier
    ds_read_b128 v[216:219], v187 offset:22528
    v_mfma_f32_16x16x32_bf16 v[48:51], v[220:223], a[208:211], v[48:51]
    buffer_load_dwordx4 v3, s[24:27], s75 offen offset:0 sc1 lds
    s_waitcnt lgkmcnt(4)
    v_mfma_f32_16x16x32_bf16 v[56:59], v[196:199], a[208:211], v[56:59]
    ds_read_b128 v[220:223], v187 offset:21504
    v_mfma_f32_16x16x32_bf16 v[56:59], v[200:203], a[216:219], v[56:59]
    v_mfma_f32_16x16x32_bf16 v[60:63], v[200:203], a[220:223], v[60:63]
    ds_read_b128 v[224:227], v187 offset:23552
    v_mfma_f32_16x16x32_bf16 v[60:63], v[196:199], a[212:215], v[60:63]
    s_waitcnt lgkmcnt(4)
    v_mfma_f32_16x16x32_bf16 v[68:71], v[204:207], a[212:215], v[68:71]
    ds_read_b128 v[196:199], v188 offset:0
    v_mfma_f32_16x16x32_bf16 v[68:71], v[208:211], a[220:223], v[68:71]
    buffer_load_dwordx4 v3, s[24:27], s75 offen offset:1024 sc1 lds
    v_mfma_f32_16x16x32_bf16 v[64:67], v[208:211], a[216:219], v[64:67]
    ds_read_b128 v[200:203], v188 offset:2048
    v_mfma_f32_16x16x32_bf16 v[64:67], v[204:207], a[208:211], v[64:67]
    s_waitcnt vmcnt(23) lgkmcnt(4)
    v_mfma_f32_16x16x32_bf16 v[40:43], v[212:215], a[224:227], v[40:43]
    ds_read_b128 v[204:207], v188 offset:1024
    v_mfma_f32_16x16x32_bf16 v[40:43], v[216:219], a[232:235], v[40:43]
    v_mfma_f32_16x16x32_bf16 v[44:47], v[216:219], a[236:239], v[44:47]
    ds_read_b128 v[208:211], v188 offset:3072
    v_mfma_f32_16x16x32_bf16 v[44:47], v[212:215], a[228:231], v[44:47]
    s_waitcnt lgkmcnt(4)
    v_mfma_f32_16x16x32_bf16 v[52:55], v[220:223], a[228:231], v[52:55]
    ds_read_b128 v[212:215], v188 offset:4096
    buffer_load_dwordx4 v3, s[24:27], s75 offen offset:2048 sc1 lds
    v_mfma_f32_16x16x32_bf16 v[52:55], v[224:227], a[236:239], v[52:55]
    v_mfma_f32_16x16x32_bf16 v[48:51], v[224:227], a[232:235], v[48:51]
    ds_read_b128 v[216:219], v188 offset:6144
    v_mfma_f32_16x16x32_bf16 v[48:51], v[220:223], a[224:227], v[48:51]
    s_add_u32 m0, s40, 76800
    s_waitcnt vmcnt(19) lgkmcnt(4)
    v_mfma_f32_16x16x32_bf16 v[40:43], v[196:199], a[240:243], v[40:43]
    ds_read_b128 v[220:223], v188 offset:5120
    s_add_u32 s75, s49, 224256
    v_mfma_f32_16x16x32_bf16 v[40:43], v[200:203], a[248:251], v[40:43]
    v_mfma_f32_16x16x32_bf16 v[44:47], v[200:203], a[252:255], v[44:47]
    ds_read_b128 v[224:227], v188 offset:7168
    v_mfma_f32_16x16x32_bf16 v[44:47], v[196:199], a[244:247], v[44:47]
    buffer_load_dwordx4 v3, s[24:27], s75 offen offset:0 sc1 lds
    s_waitcnt lgkmcnt(4)
    v_mfma_f32_16x16x32_bf16 v[52:55], v[204:207], a[244:247], v[52:55]
    ds_read_b128 v[196:199], v188 offset:8192
    v_mfma_f32_16x16x32_bf16 v[52:55], v[208:211], a[252:255], v[52:55]
    v_mfma_f32_16x16x32_bf16 v[48:51], v[208:211], a[248:251], v[48:51]
    ds_read_b128 v[200:203], v188 offset:10240
    v_mfma_f32_16x16x32_bf16 v[48:51], v[204:207], a[240:243], v[48:51]
    s_waitcnt vmcnt(14) lgkmcnt(4)
    v_mfma_f32_16x16x32_bf16 v[40:43], v[212:215], v[136:139], v[40:43]
    ds_read_b128 v[204:207], v188 offset:9216
    v_mfma_f32_16x16x32_bf16 v[40:43], v[216:219], v[144:147], v[40:43]
    v_mfma_f32_16x16x32_bf16 v[44:47], v[216:219], v[148:151], v[44:47]
    ds_read_b128 v[208:211], v188 offset:11264
    buffer_load_dwordx4 v3, s[24:27], s75 offen offset:1024 sc1 lds
    v_mfma_f32_16x16x32_bf16 v[44:47], v[212:215], v[140:143], v[44:47]
    s_waitcnt lgkmcnt(4)
    v_mfma_f32_16x16x32_bf16 v[52:55], v[220:223], v[140:143], v[52:55]
    ds_read_b128 v[212:215], v188 offset:12288
    v_mfma_f32_16x16x32_bf16 v[52:55], v[224:227], v[148:151], v[52:55]
    v_mfma_f32_16x16x32_bf16 v[48:51], v[224:227], v[144:147], v[48:51]
    ds_read_b128 v[216:219], v188 offset:14336
    v_mfma_f32_16x16x32_bf16 v[48:51], v[220:223], v[136:139], v[48:51]
    s_waitcnt vmcnt(8) lgkmcnt(4)
    v_mfma_f32_16x16x32_bf16 v[40:43], v[196:199], v[152:155], v[40:43]
    ds_read_b128 v[220:223], v188 offset:13312
    v_mfma_f32_16x16x32_bf16 v[40:43], v[200:203], v[160:163], v[40:43]
    buffer_load_dwordx4 v3, s[24:27], s75 offen offset:2048 sc1 lds
    v_mfma_f32_16x16x32_bf16 v[44:47], v[200:203], v[164:167], v[44:47]
    ds_read_b128 v[224:227], v188 offset:15360
    v_mfma_f32_16x16x32_bf16 v[44:47], v[196:199], v[156:159], v[44:47]
    s_waitcnt lgkmcnt(4)
    v_mfma_f32_16x16x32_bf16 v[52:55], v[204:207], v[156:159], v[52:55]
    ds_read_b128 v[196:199], v188 offset:16384
    v_mfma_f32_16x16x32_bf16 v[52:55], v[208:211], v[164:167], v[52:55]
    v_mfma_f32_16x16x32_bf16 v[48:51], v[208:211], v[160:163], v[48:51]
    ds_read_b128 v[200:203], v188 offset:18432
    v_mfma_f32_16x16x32_bf16 v[48:51], v[204:207], v[152:155], v[48:51]
    s_waitcnt lgkmcnt(4)
    v_mfma_f32_16x16x32_bf16 v[56:59], v[212:215], a[224:227], v[56:59]
    ds_read_b128 v[204:207], v188 offset:17408
    v_mfma_f32_16x16x32_bf16 v[56:59], v[216:219], a[232:235], v[56:59]
    v_mfma_f32_16x16x32_bf16 v[60:63], v[216:219], a[236:239], v[60:63]
    ds_read_b128 v[208:211], v188 offset:19456
    s_add_u32 m0, s40, 24576
    v_mfma_f32_16x16x32_bf16 v[60:63], v[212:215], a[228:231], v[60:63]
    s_add_u32 s75, s49, 245760
    s_waitcnt lgkmcnt(4)
    v_mfma_f32_16x16x32_bf16 v[68:71], v[220:223], a[228:231], v[68:71]
    ds_read_b128 v[212:215], v188 offset:20480
    v_mfma_f32_16x16x32_bf16 v[68:71], v[224:227], a[236:239], v[68:71]
    v_cvt_pk_bf16_f32 v40, v40, v41
    v_mfma_f32_16x16x32_bf16 v[64:67], v[224:227], a[232:235], v[64:67]
    s_barrier
    ds_read_b128 v[216:219], v188 offset:22528
    v_cvt_pk_bf16_f32 v41, v42, v43
    v_mfma_f32_16x16x32_bf16 v[64:67], v[220:223], a[224:227], v[64:67]
    v_cvt_pk_bf16_f32 v42, v48, v49
    s_waitcnt lgkmcnt(4)
    v_mfma_f32_16x16x32_bf16 v[56:59], v[196:199], a[240:243], v[56:59]
    ds_read_b128 v[220:223], v188 offset:21504
    v_cvt_pk_bf16_f32 v43, v50, v51
    v_mfma_f32_16x16x32_bf16 v[56:59], v[200:203], a[248:251], v[56:59]
    buffer_store_dwordx4 v[40:43], v3, s[24:27], s16 offen offset:0 sc1
    buffer_load_dwordx4 v3, s[24:27], s75 offen offset:0 sc1 lds
    v_mfma_f32_16x16x32_bf16 v[60:63], v[200:203], a[252:255], v[60:63]
    ds_read_b128 v[224:227], v188 offset:23552
    v_cvt_pk_bf16_f32 v44, v44, v45
    v_mfma_f32_16x16x32_bf16 v[60:63], v[196:199], a[244:247], v[60:63]
    v_cvt_pk_bf16_f32 v45, v46, v47
    s_waitcnt lgkmcnt(4)
    v_mfma_f32_16x16x32_bf16 v[68:71], v[204:207], a[244:247], v[68:71]
    ds_read_b128 v[196:199], v186 offset:0
    v_cvt_pk_bf16_f32 v46, v52, v53
    v_mfma_f32_16x16x32_bf16 v[68:71], v[208:211], a[252:255], v[68:71]
    v_cvt_pk_bf16_f32 v47, v54, v55
    buffer_load_dwordx4 v3, s[24:27], s75 offen offset:1024 sc1 lds
    v_mfma_f32_16x16x32_bf16 v[64:67], v[208:211], a[248:251], v[64:67]
    ds_read_b128 v[200:203], v186 offset:2048
    buffer_store_dwordx4 v[44:47], v3, s[24:27], s16 offen offset:1024 sc1
    v_mfma_f32_16x16x32_bf16 v[64:67], v[204:207], a[240:243], v[64:67]
    s_waitcnt lgkmcnt(4)
    v_mfma_f32_16x16x32_bf16 v[56:59], v[212:215], v[136:139], v[56:59]
    ds_read_b128 v[204:207], v186 offset:1024
    v_mfma_f32_16x16x32_bf16 v[56:59], v[216:219], v[144:147], v[56:59]
    v_mfma_f32_16x16x32_bf16 v[60:63], v[216:219], v[148:151], v[60:63]
    ds_read_b128 v[208:211], v186 offset:3072
    v_mfma_f32_16x16x32_bf16 v[60:63], v[212:215], v[140:143], v[60:63]
    s_waitcnt lgkmcnt(4)
    v_mfma_f32_16x16x32_bf16 v[68:71], v[220:223], v[140:143], v[68:71]
    ds_read_b128 v[212:215], v186 offset:4096
    buffer_load_dwordx4 v3, s[24:27], s75 offen offset:2048 sc1 lds
    v_mfma_f32_16x16x32_bf16 v[68:71], v[224:227], v[148:151], v[68:71]
    v_mfma_f32_16x16x32_bf16 v[64:67], v[224:227], v[144:147], v[64:67]
    ds_read_b128 v[216:219], v186 offset:6144
    v_mfma_f32_16x16x32_bf16 v[64:67], v[220:223], v[136:139], v[64:67]
    s_add_u32 m0, s40, 27648
    s_waitcnt lgkmcnt(4)
    v_mfma_f32_16x16x32_bf16 v[56:59], v[196:199], v[152:155], v[56:59]
    ds_read_b128 v[220:223], v186 offset:5120
    s_add_u32 s75, s49, 248832
    v_mfma_f32_16x16x32_bf16 v[56:59], v[200:203], v[160:163], v[56:59]
    v_mfma_f32_16x16x32_bf16 v[60:63], v[200:203], v[164:167], v[60:63]
    ds_read_b128 v[224:227], v186 offset:7168
    v_mfma_f32_16x16x32_bf16 v[60:63], v[196:199], v[156:159], v[60:63]
    buffer_load_dwordx4 v3, s[24:27], s75 offen offset:0 sc1 lds
    s_waitcnt lgkmcnt(4)
    v_mfma_f32_16x16x32_bf16 v[68:71], v[204:207], v[156:159], v[68:71]
    ds_read_b128 v[196:199], v186 offset:8192
    s_waitcnt vmcnt(12)
    ds_read_b64_tr_b16 v[240:241], v172 offset:0
    v_mfma_f32_16x16x32_bf16 v[68:71], v[208:211], v[164:167], v[68:71]
    v_mfma_f32_16x16x32_bf16 v[64:67], v[208:211], v[160:163], v[64:67]
    ds_read_b128 v[200:203], v186 offset:10240
    ds_read_b64_tr_b16 v[242:243], v172 offset:256
    v_mfma_f32_16x16x32_bf16 v[64:67], v[204:207], v[152:155], v[64:67]
    s_waitcnt lgkmcnt(6)
    v_mfma_f32_16x16x32_bf16 v[80:83], v[212:215], a[96:99], v[80:83]
    ds_read_b128 v[204:207], v186 offset:9216
    ds_read_b64_tr_b16 v[244:245], v172 offset:32
    v_mfma_f32_16x16x32_bf16 v[80:83], v[216:219], a[104:107], v[80:83]
    v_mfma_f32_16x16x32_bf16 v[84:87], v[216:219], a[108:111], v[84:87]
    ds_read_b128 v[208:211], v186 offset:11264
    ds_read_b64_tr_b16 v[246:247], v172 offset:288
    v_mfma_f32_16x16x32_bf16 v[84:87], v[212:215], a[100:103], v[84:87]
    buffer_load_dwordx4 v3, s[24:27], s75 offen offset:1024 sc1 lds
    s_waitcnt lgkmcnt(8)
    v_mfma_f32_16x16x32_bf16 v[92:95], v[220:223], a[100:103], v[92:95]
    ds_read_b128 v[212:215], v186 offset:12288
    ds_read_b64_tr_b16 v[248:249], v7 offset:2048
    v_mfma_f32_16x16x32_bf16 v[92:95], v[224:227], a[108:111], v[92:95]
    v_cvt_pk_bf16_f32 v56, v56, v57
    v_mfma_f32_16x16x32_bf16 v[88:91], v[224:227], a[104:107], v[88:91]
    ds_read_b128 v[216:219], v186 offset:14336
    ds_read_b64_tr_b16 v[250:251], v7 offset:2080
    v_cvt_pk_bf16_f32 v57, v58, v59
    v_mfma_f32_16x16x32_bf16 v[88:91], v[220:223], a[96:99], v[88:91]
    v_cvt_pk_bf16_f32 v58, v64, v65
    s_waitcnt lgkmcnt(9)
    v_mfma_f32_16x16x32_bf16 v[80:83], v[196:199], a[112:115], v[80:83]
    ds_read_b128 v[220:223], v186 offset:13312
    v_cvt_pk_bf16_f32 v59, v66, v67
    v_mfma_f32_16x16x32_bf16 v[80:83], v[200:203], a[120:123], v[80:83]
    buffer_store_dwordx4 v[56:59], v3, s[24:27], s17 offen offset:0 sc1
    buffer_load_dwordx4 v3, s[24:27], s75 offen offset:2048 sc1 lds
    v_mfma_f32_16x16x32_bf16 v[84:87], v[200:203], a[124:127], v[84:87]
    ds_read_b128 v[224:227], v186 offset:15360
    v_cvt_pk_bf16_f32 v60, v60, v61
    v_mfma_f32_16x16x32_bf16 v[84:87], v[196:199], a[116:119], v[84:87]
    v_cvt_pk_bf16_f32 v61, v62, v63
    s_waitcnt lgkmcnt(7)
    v_mfma_f32_16x16x32_bf16 v[92:95], v[204:207], a[116:119], v[92:95]
    ds_read_b128 v[196:199], v186 offset:16384
    v_cvt_pk_bf16_f32 v62, v68, v69
    v_mfma_f32_16x16x32_bf16 v[92:95], v[208:211], a[124:127], v[92:95]
    v_cvt_pk_bf16_f32 v63, v70, v71
    v_mfma_f32_16x16x32_bf16 v[88:91], v[208:211], a[120:123], v[88:91]
    ds_read_b128 v[200:203], v186 offset:18432
    buffer_store_dwordx4 v[60:63], v3, s[24:27], s17 offen offset:1024 sc1
    v_mfma_f32_16x16x32_bf16 v[88:91], v[204:207], a[112:115], v[88:91]
    s_waitcnt lgkmcnt(5)
    v_mfma_f32_16x16x32_bf16 v[80:83], v[212:215], a[128:131], v[80:83]
    ds_read_b128 v[204:207], v186 offset:17408
    s_waitcnt lgkmcnt(5)
    v_lshlrev_b32 v228, 16, v240
    v_mfma_f32_16x16x32_bf16 v[80:83], v[216:219], a[136:139], v[80:83]
    v_and_b32 v229, 0xffff0000, v240
    v_mfma_f32_16x16x32_bf16 v[84:87], v[216:219], a[140:143], v[84:87]
    ds_read_b128 v[208:211], v186 offset:19456
    v_lshlrev_b32 v230, 16, v241
    v_mfma_f32_16x16x32_bf16 v[84:87], v[212:215], a[132:135], v[84:87]
    v_and_b32 v231, 0xffff0000, v241
    s_waitcnt lgkmcnt(4)
    v_mfma_f32_16x16x32_bf16 v[92:95], v[220:223], a[132:135], v[92:95]
    ds_read_b128 v[212:215], v186 offset:20480
    v_lshlrev_b32 v232, 16, v242
    v_mfma_f32_16x16x32_bf16 v[92:95], v[224:227], a[140:143], v[92:95]
    v_and_b32 v233, 0xffff0000, v242
    s_add_u32 m0, s40, 49152
    v_mfma_f32_16x16x32_bf16 v[88:91], v[224:227], a[136:139], v[88:91]
    s_barrier
    ds_read_b128 v[216:219], v186 offset:22528
    v_lshlrev_b32 v234, 16, v243
    v_mfma_f32_16x16x32_bf16 v[88:91], v[220:223], a[128:131], v[88:91]
    v_and_b32 v235, 0xffff0000, v243
    s_waitcnt lgkmcnt(4)
    v_mfma_f32_16x16x32_bf16 v[80:83], v[196:199], a[144:147], v[80:83]
    ds_read_b128 v[220:223], v186 offset:21504
    v_lshlrev_b32 v236, 16, v244
    v_mfma_f32_16x16x32_bf16 v[80:83], v[200:203], a[152:155], v[80:83]
    v_and_b32 v237, 0xffff0000, v244
    s_add_u32 s75, s49, 270336
    v_mfma_f32_16x16x32_bf16 v[84:87], v[200:203], a[156:159], v[84:87]
    ds_read_b128 v[224:227], v186 offset:23552
    v_lshlrev_b32 v238, 16, v245
    buffer_load_dwordx4 v3, s[24:27], s75 offen offset:0 sc1 lds
    v_mfma_f32_16x16x32_bf16 v[84:87], v[196:199], a[148:151], v[84:87]
    v_and_b32 v239, 0xffff0000, v245
    s_waitcnt lgkmcnt(4)
    v_mfma_f32_16x16x32_bf16 v[92:95], v[204:207], a[148:151], v[92:95]
    ds_read_b128 v[196:199], v188 offset:24576
    v_lshlrev_b32 v240, 16, v246
    v_mfma_f32_16x16x32_bf16 v[92:95], v[208:211], a[156:159], v[92:95]
    v_and_b32 v241, 0xffff0000, v246
    buffer_load_dwordx4 v3, s[24:27], s75 offen offset:1024 sc1 lds
    v_mfma_f32_16x16x32_bf16 v[88:91], v[208:211], a[152:155], v[88:91]
    ds_read_b128 v[200:203], v188 offset:26624
    v_lshlrev_b32 v242, 16, v247
    v_mfma_f32_16x16x32_bf16 v[88:91], v[204:207], a[144:147], v[88:91]
    v_and_b32 v243, 0xffff0000, v247
    s_waitcnt lgkmcnt(4)
    v_mfma_f32_16x16x32_bf16 v[80:83], v[212:215], a[160:163], v[80:83]
    ds_read_b128 v[204:207], v188 offset:25600
    v_lshlrev_b32 v244, 16, v248
    v_mfma_f32_16x16x32_bf16 v[80:83], v[216:219], a[168:171], v[80:83]
    v_and_b32 v245, 0xffff0000, v248
    v_mfma_f32_16x16x32_bf16 v[84:87], v[216:219], a[172:175], v[84:87]
    ds_read_b128 v[208:211], v188 offset:27648
    v_lshlrev_b32 v246, 16, v249
    v_mfma_f32_16x16x32_bf16 v[84:87], v[212:215], a[164:167], v[84:87]
    v_and_b32 v247, 0xffff0000, v249
    s_waitcnt lgkmcnt(4)
    v_mfma_f32_16x16x32_bf16 v[92:95], v[220:223], a[164:167], v[92:95]
    ds_read_b128 v[212:215], v188 offset:28672
    v_lshlrev_b32 v248, 16, v250
    v_mfma_f32_16x16x32_bf16 v[92:95], v[224:227], a[172:175], v[92:95]
    v_and_b32 v249, 0xffff0000, v250
    buffer_load_dwordx4 v3, s[24:27], s75 offen offset:2048 sc1 lds
    v_mfma_f32_16x16x32_bf16 v[88:91], v[224:227], a[168:171], v[88:91]
    ds_read_b128 v[216:219], v188 offset:30720
    v_lshlrev_b32 v250, 16, v251
    v_mfma_f32_16x16x32_bf16 v[88:91], v[220:223], a[160:163], v[88:91]
    v_and_b32 v251, 0xffff0000, v251
    s_waitcnt lgkmcnt(4)
    v_mfma_f32_16x16x32_bf16 v[80:83], v[196:199], a[176:179], v[80:83]
    ds_read_b128 v[220:223], v188 offset:29696
    s_add_u32 m0, s40, 52224
    v_mfma_f32_16x16x32_bf16 v[80:83], v[200:203], a[184:187], v[80:83]
    s_add_u32 s75, s49, 273408
    v_mfma_f32_16x16x32_bf16 v[84:87], v[200:203], a[188:191], v[84:87]
    ds_read_b128 v[224:227], v188 offset:31744
    v_mfma_f32_16x16x32_bf16 v[84:87], v[196:199], a[180:183], v[84:87]
    buffer_load_dwordx4 v3, s[24:27], s75 offen offset:0 sc1 lds
    s_waitcnt lgkmcnt(4)
    v_mfma_f32_16x16x32_bf16 v[92:95], v[204:207], a[180:183], v[92:95]
    ds_read_b128 v[196:199], v188 offset:32768
    v_mfma_f32_16x16x32_bf16 v[92:95], v[208:211], a[188:191], v[92:95]
    v_mfma_f32_16x16x32_bf16 v[88:91], v[208:211], a[184:187], v[88:91]
    ds_read_b128 v[200:203], v188 offset:34816
    v_mfma_f32_16x16x32_bf16 v[88:91], v[204:207], a[176:179], v[88:91]
    s_waitcnt lgkmcnt(4)
    v_mfma_f32_16x16x32_bf16 v[80:83], v[212:215], a[192:195], v[80:83]
    ds_read_b128 v[204:207], v188 offset:33792
    v_mfma_f32_16x16x32_bf16 v[80:83], v[216:219], a[200:203], v[80:83]
    v_mfma_f32_16x16x32_bf16 v[84:87], v[216:219], a[204:207], v[84:87]
    ds_read_b128 v[208:211], v188 offset:35840
    buffer_load_dwordx4 v3, s[24:27], s75 offen offset:1024 sc1 lds
    v_mfma_f32_16x16x32_bf16 v[84:87], v[212:215], a[196:199], v[84:87]
    s_waitcnt lgkmcnt(4)
    v_mfma_f32_16x16x32_bf16 v[92:95], v[220:223], a[196:199], v[92:95]
    ds_read_b128 v[212:215], v188 offset:36864
    v_mfma_f32_16x16x32_bf16 v[92:95], v[224:227], a[204:207], v[92:95]
    v_mfma_f32_16x16x32_bf16 v[88:91], v[224:227], a[200:203], v[88:91]
    ds_read_b128 v[216:219], v188 offset:38912
    v_mfma_f32_16x16x32_bf16 v[88:91], v[220:223], a[192:195], v[88:91]
    s_waitcnt lgkmcnt(4)
    v_mfma_f32_16x16x32_bf16 v[80:83], v[196:199], a[208:211], v[80:83]
    ds_read_b128 v[220:223], v188 offset:37888
    v_mfma_f32_16x16x32_bf16 v[80:83], v[200:203], a[216:219], v[80:83]
    buffer_load_dwordx4 v3, s[24:27], s75 offen offset:2048 sc1 lds
    v_mfma_f32_16x16x32_bf16 v[84:87], v[200:203], a[220:223], v[84:87]
    ds_read_b128 v[224:227], v188 offset:39936
    v_mfma_f32_16x16x32_bf16 v[84:87], v[196:199], a[212:215], v[84:87]
    s_waitcnt lgkmcnt(4)
    v_mfma_f32_16x16x32_bf16 v[92:95], v[204:207], a[212:215], v[92:95]
    ds_read_b128 v[196:199], v188 offset:40960
    v_mfma_f32_16x16x32_bf16 v[92:95], v[208:211], a[220:223], v[92:95]
    v_mfma_f32_16x16x32_bf16 v[88:91], v[208:211], a[216:219], v[88:91]
    ds_read_b128 v[200:203], v188 offset:43008
    v_mfma_f32_16x16x32_bf16 v[88:91], v[204:207], a[208:211], v[88:91]
    s_waitcnt lgkmcnt(4)
    v_mfma_f32_16x16x32_bf16 v[80:83], v[212:215], a[224:227], v[80:83]
    ds_read_b128 v[204:207], v188 offset:41984
    v_mfma_f32_16x16x32_bf16 v[80:83], v[216:219], a[232:235], v[80:83]
    v_mfma_f32_16x16x32_bf16 v[84:87], v[216:219], a[236:239], v[84:87]
    ds_read_b128 v[208:211], v188 offset:44032
    s_add_u32 m0, s40, 98304
    v_mfma_f32_16x16x32_bf16 v[84:87], v[212:215], a[228:231], v[84:87]
    s_add_u32 s75, s49, 294912
    s_waitcnt lgkmcnt(4)
    v_mfma_f32_16x16x32_bf16 v[92:95], v[220:223], a[228:231], v[92:95]
    ds_read_b128 v[212:215], v188 offset:45056
    v_mfma_f32_16x16x32_bf16 v[92:95], v[224:227], a[236:239], v[92:95]
    v_mfma_f32_16x16x32_bf16 v[88:91], v[224:227], a[232:235], v[88:91]
    s_waitcnt vmcnt(16)
    s_barrier
    ds_read_b128 v[216:219], v188 offset:47104
    s_waitcnt vmcnt(6)
    s_mov_b64 exec, 6
    v_mov_b32 v192, s3
    buffer_store_dword v192, v169, s[24:27], s35 offen sc1
    s_mov_b64 exec, -1
    v_mfma_f32_16x16x32_bf16 v[88:91], v[220:223], a[224:227], v[88:91]
    buffer_load_dwordx4 v3, s[24:27], s75 offen offset:0 sc1 lds
    s_waitcnt lgkmcnt(4)
    v_mfma_f32_16x16x32_bf16 v[80:83], v[196:199], a[240:243], v[80:83]
    ds_read_b128 v[220:223], v188 offset:46080
    v_mfma_f32_16x16x32_bf16 v[80:83], v[200:203], a[248:251], v[80:83]
    v_mfma_f32_16x16x32_bf16 v[84:87], v[200:203], a[252:255], v[84:87]
    ds_read_b128 v[224:227], v188 offset:48128
    v_mfma_f32_16x16x32_bf16 v[84:87], v[196:199], a[244:247], v[84:87]
    s_waitcnt lgkmcnt(4)
    v_mfma_f32_16x16x32_bf16 v[92:95], v[204:207], a[244:247], v[92:95]
    ds_read_b128 v[196:199], v187 offset:24576
    v_mfma_f32_16x16x32_bf16 v[92:95], v[208:211], a[252:255], v[92:95]
    buffer_load_dwordx4 v3, s[24:27], s75 offen offset:1024 sc1 lds
    v_mfma_f32_16x16x32_bf16 v[88:91], v[208:211], a[248:251], v[88:91]
    ds_read_b128 v[200:203], v187 offset:26624
    v_mfma_f32_16x16x32_bf16 v[88:91], v[204:207], a[240:243], v[88:91]
    s_waitcnt lgkmcnt(4)
    v_mfma_f32_16x16x32_bf16 v[80:83], v[212:215], v[136:139], v[80:83]
    ds_read_b128 v[204:207], v187 offset:25600
    v_mfma_f32_16x16x32_bf16 v[80:83], v[216:219], v[144:147], v[80:83]
    v_mfma_f32_16x16x32_bf16 v[84:87], v[216:219], v[148:151], v[84:87]
    ds_read_b128 v[208:211], v187 offset:27648
    v_mfma_f32_16x16x32_bf16 v[84:87], v[212:215], v[140:143], v[84:87]
    s_waitcnt lgkmcnt(4)
    v_mfma_f32_16x16x32_bf16 v[92:95], v[220:223], v[140:143], v[92:95]
    ds_read_b128 v[212:215], v187 offset:28672
    buffer_load_dwordx4 v3, s[24:27], s75 offen offset:2048 sc1 lds
    v_mfma_f32_16x16x32_bf16 v[92:95], v[224:227], v[148:151], v[92:95]
    v_mfma_f32_16x16x32_bf16 v[88:91], v[224:227], v[144:147], v[88:91]
    ds_read_b128 v[216:219], v187 offset:29696
    v_mfma_f32_16x16x32_bf16 v[88:91], v[220:223], v[136:139], v[88:91]
    s_add_u32 m0, s40, 101376
    s_waitcnt lgkmcnt(4)
    v_mfma_f32_16x16x32_bf16 v[80:83], v[196:199], v[152:155], v[80:83]
    ds_read_b128 v[220:223], v187 offset:30720
    s_add_u32 s75, s49, 297984
    v_mfma_f32_16x16x32_bf16 v[80:83], v[200:203], v[160:163], v[80:83]
    v_mfma_f32_16x16x32_bf16 v[84:87], v[200:203], v[164:167], v[84:87]
    ds_read_b128 v[224:227], v187 offset:31744
    v_mfma_f32_16x16x32_bf16 v[84:87], v[196:199], v[156:159], v[84:87]
    buffer_load_dwordx4 v3, s[24:27], s75 offen offset:0 sc1 lds
    s_waitcnt lgkmcnt(4)
    v_mfma_f32_16x16x32_bf16 v[92:95], v[204:207], v[156:159], v[92:95]
    ds_read_b128 v[196:199], v187 offset:32768
    v_mfma_f32_16x16x32_bf16 v[92:95], v[208:211], v[164:167], v[92:95]
    v_mfma_f32_16x16x32_bf16 v[88:91], v[208:211], v[160:163], v[88:91]
    ds_read_b128 v[200:203], v187 offset:33792
    v_mfma_f32_16x16x32_bf16 v[88:91], v[204:207], v[152:155], v[88:91]
    s_waitcnt lgkmcnt(4)
    v_mfma_f32_16x16x32_bf16 v[72:75], v[212:215], a[32:35], v[72:75]
    ds_read_b128 v[204:207], v187 offset:34816
    v_mfma_f32_16x16x32_bf16 v[72:75], v[216:219], a[40:43], v[72:75]
    v_mfma_f32_16x16x32_bf16 v[76:79], v[216:219], a[44:47], v[76:79]
    ds_read_b128 v[208:211], v187 offset:35840
    buffer_load_dwordx4 v3, s[24:27], s75 offen offset:1024 sc1 lds
    v_mfma_f32_16x16x32_bf16 v[76:79], v[212:215], a[36:39], v[76:79]
    s_waitcnt lgkmcnt(4)
    v_mfma_f32_16x16x32_bf16 v[76:79], v[220:223], a[52:55], v[76:79]
    ds_read_b128 v[212:215], v187 offset:36864
    v_mfma_f32_16x16x32_bf16 v[76:79], v[224:227], a[60:63], v[76:79]
    v_cvt_pk_bf16_f32 v80, v80, v81
    v_mfma_f32_16x16x32_bf16 v[72:75], v[224:227], a[56:59], v[72:75]
    ds_read_b128 v[216:219], v187 offset:37888
    v_cvt_pk_bf16_f32 v81, v82, v83
    v_mfma_f32_16x16x32_bf16 v[72:75], v[220:223], a[48:51], v[72:75]
    v_cvt_pk_bf16_f32 v82, v88, v89
    s_waitcnt lgkmcnt(4)
    v_mfma_f32_16x16x32_bf16 v[72:75], v[196:199], a[64:67], v[72:75]
    ds_read_b128 v[220:223], v187 offset:38912
    v_cvt_pk_bf16_f32 v83, v90, v91
    v_mfma_f32_16x16x32_bf16 v[72:75], v[200:203], a[72:75], v[72:75]
    buffer_store_dwordx4 v[80:83], v3, s[24:27], s18 offen offset:0 sc1
    buffer_load_dwordx4 v3, s[24:27], s75 offen offset:2048 sc1 lds
    v_mfma_f32_16x16x32_bf16 v[76:79], v[200:203], a[76:79], v[76:79]
    ds_read_b128 v[224:227], v187 offset:39936
    v_cvt_pk_bf16_f32 v84, v84, v85
    v_mfma_f32_16x16x32_bf16 v[76:79], v[196:199], a[68:71], v[76:79]
    v_cvt_pk_bf16_f32 v85, v86, v87
    s_waitcnt lgkmcnt(4)
    v_mfma_f32_16x16x32_bf16 v[76:79], v[204:207], a[84:87], v[76:79]
    ds_read_b128 v[196:199], v187 offset:40960
    v_cvt_pk_bf16_f32 v86, v92, v93
    v_mfma_f32_16x16x32_bf16 v[76:79], v[208:211], a[92:95], v[76:79]
    v_cvt_pk_bf16_f32 v87, v94, v95
    v_mfma_f32_16x16x32_bf16 v[72:75], v[208:211], a[88:91], v[72:75]
    ds_read_b128 v[200:203], v187 offset:41984
    buffer_load_dword v193, v170, s[24:27], s70 offen offset:4 sc1
    buffer_store_dwordx4 v[84:87], v3, s[24:27], s18 offen offset:1024 sc1
    v_mfma_f32_16x16x32_bf16 v[72:75], v[204:207], a[80:83], v[72:75]
    s_waitcnt lgkmcnt(4)
    v_mfma_f32_16x16x32_bf16 v[72:75], v[212:215], a[96:99], v[72:75]
    ds_read_b128 v[204:207], v187 offset:43008
    v_mfma_f32_16x16x32_bf16 v[72:75], v[216:219], a[104:107], v[72:75]
    v_mfma_f32_16x16x32_bf16 v[76:79], v[216:219], a[108:111], v[76:79]
    ds_read_b128 v[208:211], v187 offset:44032
    s_mul_i32 s75, s36, 3072
    v_mfma_f32_16x16x32_bf16 v[76:79], v[212:215], a[100:103], v[76:79]
    s_add_u32 m0, s75, 16384
    s_waitcnt lgkmcnt(4)
    v_mfma_f32_16x16x32_bf16 v[76:79], v[220:223], a[116:119], v[76:79]
    ds_read_b128 v[212:215], v187 offset:45056
    s_sub_u32 s75, s49, s75
    v_mfma_f32_16x16x32_bf16 v[76:79], v[224:227], a[124:127], v[76:79]
    s_add_u32 s75, s75, 319488
    v_mfma_f32_16x16x32_bf16 v[72:75], v[224:227], a[120:123], v[72:75]
    s_barrier
    ds_read_b128 v[216:219], v187 offset:46080
    v_mfma_f32_16x16x32_bf16 v[72:75], v[220:223], a[112:115], v[72:75]
    buffer_load_dwordx4 v3, s[24:27], s75 offen offset:0 sc1 lds
    s_waitcnt lgkmcnt(4)
    v_mfma_f32_16x16x32_bf16 v[72:75], v[196:199], a[128:131], v[72:75]
    ds_read_b128 v[220:223], v187 offset:47104
    v_mfma_f32_16x16x32_bf16 v[72:75], v[200:203], a[136:139], v[72:75]
    v_mfma_f32_16x16x32_bf16 v[76:79], v[200:203], a[140:143], v[76:79]
    ds_read_b128 v[224:227], v187 offset:48128
    v_mfma_f32_16x16x32_bf16 v[76:79], v[196:199], a[132:135], v[76:79]
    s_waitcnt lgkmcnt(4)
    v_mfma_f32_16x16x32_bf16 v[76:79], v[204:207], a[148:151], v[76:79]
    ds_read_b128 v[196:199], v186 offset:24576
    v_mfma_f32_16x16x32_bf16 v[76:79], v[208:211], a[156:159], v[76:79]
    v_mfma_f32_16x16x32_bf16 v[72:75], v[208:211], a[152:155], v[72:75]
    ds_read_b128 v[200:203], v186 offset:25600
    v_mfma_f32_16x16x32_bf16 v[72:75], v[204:207], a[144:147], v[72:75]
    s_waitcnt lgkmcnt(4)
    v_mfma_f32_16x16x32_bf16 v[72:75], v[212:215], a[160:163], v[72:75]
    ds_read_b128 v[204:207], v186 offset:26624
    v_mfma_f32_16x16x32_bf16 v[72:75], v[216:219], a[168:171], v[72:75]
    v_mfma_f32_16x16x32_bf16 v[76:79], v[216:219], a[172:175], v[76:79]
    ds_read_b128 v[208:211], v186 offset:27648
    v_mfma_f32_16x16x32_bf16 v[76:79], v[212:215], a[164:167], v[76:79]
    s_waitcnt lgkmcnt(4)
    v_mfma_f32_16x16x32_bf16 v[76:79], v[220:223], a[180:183], v[76:79]
    ds_read_b128 v[212:215], v186 offset:28672
    buffer_load_dwordx4 v3, s[24:27], s75 offen offset:1024 sc1 lds
    v_mfma_f32_16x16x32_bf16 v[76:79], v[224:227], a[188:191], v[76:79]
    v_mfma_f32_16x16x32_bf16 v[72:75], v[224:227], a[184:187], v[72:75]
    ds_read_b128 v[216:219], v186 offset:29696
    v_mfma_f32_16x16x32_bf16 v[72:75], v[220:223], a[176:179], v[72:75]
    s_waitcnt lgkmcnt(4)
    v_mfma_f32_16x16x32_bf16 v[72:75], v[196:199], a[192:195], v[72:75]
    ds_read_b128 v[220:223], v186 offset:30720
    v_mfma_f32_16x16x32_bf16 v[72:75], v[200:203], a[200:203], v[72:75]
    v_mfma_f32_16x16x32_bf16 v[76:79], v[200:203], a[204:207], v[76:79]
    ds_read_b128 v[224:227], v186 offset:31744
    v_mfma_f32_16x16x32_bf16 v[76:79], v[196:199], a[196:199], v[76:79]
    s_waitcnt lgkmcnt(4)
    v_mfma_f32_16x16x32_bf16 v[76:79], v[204:207], a[212:215], v[76:79]
    ds_read_b128 v[196:199], v186 offset:32768
    v_mfma_f32_16x16x32_bf16 v[76:79], v[208:211], a[220:223], v[76:79]
    v_mfma_f32_16x16x32_bf16 v[72:75], v[208:211], a[216:219], v[72:75]
    ds_read_b128 v[200:203], v186 offset:33792
    v_mfma_f32_16x16x32_bf16 v[72:75], v[204:207], a[208:211], v[72:75]
    s_waitcnt lgkmcnt(4)
    v_mfma_f32_16x16x32_bf16 v[72:75], v[212:215], a[224:227], v[72:75]
    ds_read_b128 v[204:207], v186 offset:34816
    v_mfma_f32_16x16x32_bf16 v[72:75], v[216:219], a[232:235], v[72:75]
    v_mfma_f32_16x16x32_bf16 v[76:79], v[216:219], a[236:239], v[76:79]
    ds_read_b128 v[208:211], v186 offset:35840
    buffer_load_dwordx4 v3, s[24:27], s75 offen offset:2048 sc1 lds
    v_mfma_f32_16x16x32_bf16 v[76:79], v[212:215], a[228:231], v[76:79]
    s_waitcnt lgkmcnt(4)
    v_mfma_f32_16x16x32_bf16 v[76:79], v[220:223], a[244:247], v[76:79]
    ds_read_b128 v[212:215], v186 offset:36864
    v_mfma_f32_16x16x32_bf16 v[76:79], v[224:227], a[252:255], v[76:79]
    v_mfma_f32_16x16x32_bf16 v[72:75], v[224:227], a[248:251], v[72:75]
    ds_read_b128 v[216:219], v186 offset:38912
    s_waitcnt vmcnt(4)
    v_cmp_ne_u32 vcc, s3, v193
    s_cbranch_vccnz SLOW_52
BACK_53:
    v_mfma_f32_16x16x32_bf16 v[72:75], v[220:223], a[240:243], v[72:75]
    buffer_load_dwordx4 v[8:11], v3, s[24:27], s20 offen offset:0 sc1
    s_waitcnt lgkmcnt(4)
    v_mfma_f32_16x16x32_bf16 v[72:75], v[196:199], v[136:139], v[72:75]
    ds_read_b128 v[220:223], v186 offset:37888
    v_mfma_f32_16x16x32_bf16 v[72:75], v[200:203], v[144:147], v[72:75]
    buffer_load_dwordx4 v[12:15], v3, s[24:27], s20 offen offset:1024 sc1
    v_mfma_f32_16x16x32_bf16 v[76:79], v[200:203], v[148:151], v[76:79]
    ds_read_b128 v[224:227], v186 offset:39936
    v_mfma_f32_16x16x32_bf16 v[76:79], v[196:199], v[140:143], v[76:79]
    buffer_load_dwordx4 v[16:19], v3, s[24:27], s21 offen offset:0 sc1
    s_waitcnt lgkmcnt(4)
    v_mfma_f32_16x16x32_bf16 v[76:79], v[204:207], v[156:159], v[76:79]
    ds_read_b128 v[196:199], v186 offset:40960
    v_mfma_f32_16x16x32_bf16 v[76:79], v[208:211], v[164:167], v[76:79]
    buffer_load_dwordx4 v[20:23], v3, s[24:27], s21 offen offset:1024 sc1
    v_mfma_f32_16x16x32_bf16 v[72:75], v[208:211], v[160:163], v[72:75]
    ds_read_b128 v[200:203], v186 offset:43008
    v_mfma_f32_16x16x32_bf16 v[72:75], v[204:207], v[152:155], v[72:75]
    s_waitcnt lgkmcnt(4)
    v_mfma_f32_16x16x32_bf16 v[104:107], v[212:215], a[0:3], 0
    ds_read_b128 v[204:207], v186 offset:41984
    v_mfma_f32_16x16x32_bf16 v[104:107], v[216:219], a[8:11], v[104:107]
    v_mfma_f32_16x16x32_bf16 v[112:115], v[216:219], a[12:15], 0
    ds_read_b128 v[208:211], v186 offset:44032
    v_mfma_f32_16x16x32_bf16 v[112:115], v[212:215], a[4:7], v[112:115]
    s_waitcnt lgkmcnt(4)
    v_mfma_f32_16x16x32_bf16 v[116:119], v[220:223], a[4:7], 0
    ds_read_b128 v[212:215], v186 offset:45056
    v_mfma_f32_16x16x32_bf16 v[116:119], v[224:227], a[12:15], v[116:119]
    v_bfi_b32 v72, v177, s3, v72
    v_mfma_f32_16x16x32_bf16 v[108:111], v[224:227], a[8:11], 0
    s_barrier
    ds_read_b128 v[216:219], v186 offset:47104
    s_waitcnt vmcnt(7)
    s_mov_b64 exec, 8
    v_mov_b32 v192, s3
    buffer_store_dword v192, v169, s[24:27], s35 offen sc1
    s_mov_b64 exec, -1
    v_bfi_b32 v74, v177, s3, v74
    v_mfma_f32_16x16x32_bf16 v[108:111], v[220:223], a[0:3], v[108:111]
    buffer_store_dwordx4 v[72:75], v168, s[24:27], s19 offen offset:0 sc1
    s_waitcnt lgkmcnt(4)
    v_mfma_f32_16x16x32_bf16 v[104:107], v[196:199], a[16:19], v[104:107]
    ds_read_b128 v[220:223], v186 offset:46080
    v_bfi_b32 v76, v177, s3, v76
    v_mfma_f32_16x16x32_bf16 v[104:107], v[200:203], a[24:27], v[104:107]
    v_bfi_b32 v78, v177, s3, v78
    v_mfma_f32_16x16x32_bf16 v[112:115], v[200:203], a[28:31], v[112:115]
    ds_read_b128 v[224:227], v186 offset:48128
    buffer_store_dwordx4 v[76:79], v168, s[24:27], s19 offen offset:1024 sc1
    v_mfma_f32_16x16x32_bf16 v[112:115], v[196:199], a[20:23], v[112:115]
    s_waitcnt lgkmcnt(4)
    v_mfma_f32_16x16x32_bf16 v[116:119], v[204:207], a[20:23], v[116:119]
    ds_read_b128 v[196:199], v187 offset:0
    v_mfma_f32_16x16x32_bf16 v[116:119], v[208:211], a[28:31], v[116:119]
    v_mfma_f32_16x16x32_bf16 v[108:111], v[208:211], a[24:27], v[108:111]
    ds_read_b128 v[200:203], v187 offset:2048
    v_mfma_f32_16x16x32_bf16 v[108:111], v[204:207], a[16:19], v[108:111]
    s_waitcnt lgkmcnt(4)
    v_mfma_f32_16x16x32_bf16 v[104:107], v[212:215], a[32:35], v[104:107]
    ds_read_b128 v[204:207], v187 offset:1024
    v_mfma_f32_16x16x32_bf16 v[104:107], v[216:219], a[40:43], v[104:107]
    v_mfma_f32_16x16x32_bf16 v[112:115], v[216:219], a[44:47], v[112:115]
    ds_read_b128 v[208:211], v187 offset:3072
    v_mfma_f32_16x16x32_bf16 v[112:115], v[212:215], a[36:39], v[112:115]
    s_waitcnt lgkmcnt(4)
    v_mfma_f32_16x16x32_bf16 v[116:119], v[220:223], a[36:39], v[116:119]
    ds_read_b128 v[212:215], v187 offset:4096
    v_mfma_f32_16x16x32_bf16 v[116:119], v[224:227], a[44:47], v[116:119]
    v_mfma_f32_16x16x32_bf16 v[108:111], v[224:227], a[40:43], v[108:111]
    ds_read_b128 v[216:219], v187 offset:6144
    v_mfma_f32_16x16x32_bf16 v[108:111], v[220:223], a[32:35], v[108:111]
    s_waitcnt lgkmcnt(4)
    v_mfma_f32_16x16x32_bf16 v[104:107], v[196:199], a[48:51], v[104:107]
    ds_read_b128 v[220:223], v187 offset:5120
    v_mfma_f32_16x16x32_bf16 v[104:107], v[200:203], a[56:59], v[104:107]
    v_mfma_f32_16x16x32_bf16 v[112:115], v[200:203], a[60:63], v[112:115]
    ds_read_b128 v[224:227], v187 offset:7168
    v_mfma_f32_16x16x32_bf16 v[112:115], v[196:199], a[52:55], v[112:115]
    s_waitcnt lgkmcnt(4)
    v_mfma_f32_16x16x32_bf16 v[116:119], v[204:207], a[52:55], v[116:119]
    ds_read_b128 v[196:199], v187 offset:8192
    v_mfma_f32_16x16x32_bf16 v[116:119], v[208:211], a[60:63], v[116:119]
    v_mfma_f32_16x16x32_bf16 v[108:111], v[208:211], a[56:59], v[108:111]
    ds_read_b128 v[200:203], v187 offset:10240
    v_mfma_f32_16x16x32_bf16 v[108:111], v[204:207], a[48:51], v[108:111]
    s_waitcnt lgkmcnt(4)
    v_mfma_f32_16x16x32_bf16 v[104:107], v[212:215], a[64:67], v[104:107]
    ds_read_b128 v[204:207], v187 offset:9216
    v_mfma_f32_16x16x32_bf16 v[104:107], v[216:219], a[72:75], v[104:107]
    v_mfma_f32_16x16x32_bf16 v[112:115], v[216:219], a[76:79], v[112:115]
    ds_read_b128 v[208:211], v187 offset:11264
    v_mfma_f32_16x16x32_bf16 v[112:115], v[212:215], a[68:71], v[112:115]
    s_waitcnt lgkmcnt(4)
    v_mfma_f32_16x16x32_bf16 v[116:119], v[220:223], a[68:71], v[116:119]
    ds_read_b128 v[212:215], v187 offset:12288
    v_mfma_f32_16x16x32_bf16 v[116:119], v[224:227], a[76:79], v[116:119]
    v_mfma_f32_16x16x32_bf16 v[108:111], v[224:227], a[72:75], v[108:111]
    ds_read_b128 v[216:219], v187 offset:14336
    v_mfma_f32_16x16x32_bf16 v[108:111], v[220:223], a[64:67], v[108:111]
    s_waitcnt lgkmcnt(4)
    v_mfma_f32_16x16x32_bf16 v[104:107], v[196:199], a[80:83], v[104:107]
    ds_read_b128 v[220:223], v187 offset:13312
    s_waitcnt vmcnt(5)
    v_lshlrev_b32 v120, 16, v8
    v_mfma_f32_16x16x32_bf16 v[104:107], v[200:203], a[88:91], v[104:107]
    buffer_load_dword v193, v4, s[24:27], s70 offen offset:12 sc1
    v_and_b32 v121, 0xffff0000, v8
    v_mfma_f32_16x16x32_bf16 v[112:115], v[200:203], a[92:95], v[112:115]
    ds_read_b128 v[224:227], v187 offset:15360
    v_lshlrev_b32 v122, 16, v9
    v_mfma_f32_16x16x32_bf16 v[112:115], v[196:199], a[84:87], v[112:115]
    v_and_b32 v123, 0xffff0000, v9
    s_waitcnt lgkmcnt(4)
    v_mfma_f32_16x16x32_bf16 v[116:119], v[204:207], a[84:87], v[116:119]
    ds_read_b128 v[196:199], v187 offset:16384
    v_lshlrev_b32 v124, 16, v10
    v_mfma_f32_16x16x32_bf16 v[116:119], v[208:211], a[92:95], v[116:119]
    v_and_b32 v125, 0xffff0000, v10
    v_lshlrev_b32 v126, 16, v11
    v_mfma_f32_16x16x32_bf16 v[108:111], v[208:211], a[88:91], v[108:111]
    ds_read_b128 v[200:203], v187 offset:18432
    v_and_b32 v127, 0xffff0000, v11
    v_mfma_f32_16x16x32_bf16 v[108:111], v[204:207], a[80:83], v[108:111]
    v_lshlrev_b32 v128, 16, v12
    s_waitcnt lgkmcnt(4)
    v_mfma_f32_16x16x32_bf16 v[104:107], v[212:215], a[96:99], v[104:107]
    ds_read_b128 v[204:207], v187 offset:17408
    v_and_b32 v129, 0xffff0000, v12
    v_mfma_f32_16x16x32_bf16 v[104:107], v[216:219], a[104:107], v[104:107]
    v_lshlrev_b32 v130, 16, v13
    v_and_b32 v131, 0xffff0000, v13
    v_mfma_f32_16x16x32_bf16 v[112:115], v[216:219], a[108:111], v[112:115]
    ds_read_b128 v[208:211], v187 offset:19456
    v_lshlrev_b32 v132, 16, v14
    v_mfma_f32_16x16x32_bf16 v[112:115], v[212:215], a[100:103], v[112:115]
    v_and_b32 v133, 0xffff0000, v14
    s_waitcnt lgkmcnt(4)
    v_mfma_f32_16x16x32_bf16 v[116:119], v[220:223], a[100:103], v[116:119]
    ds_read_b128 v[212:215], v187 offset:20480
    v_lshlrev_b32 v134, 16, v15
    v_mfma_f32_16x16x32_bf16 v[116:119], v[224:227], a[108:111], v[116:119]
    v_and_b32 v135, 0xffff0000, v15
    s_waitcnt vmcnt(4)
    v_dot2c_f32_bf16 v120, s4, v16
    v_mfma_f32_16x16x32_bf16 v[108:111], v[224:227], a[104:107], v[108:111]
    s_barrier
    ds_read_b128 v[216:219], v187 offset:22528
    v_mfma_f32_16x16x32_bf16 v[108:111], v[220:223], a[96:99], v[108:111]
    v_dot2c_f32_bf16 v121, s5, v16
    s_waitcnt lgkmcnt(4)
    v_mfma_f32_16x16x32_bf16 v[104:107], v[196:199], a[112:115], v[104:107]
    ds_read_b128 v[220:223], v187 offset:21504
    v_dot2c_f32_bf16 v122, s4, v17
    v_mfma_f32_16x16x32_bf16 v[104:107], v[200:203], a[120:123], v[104:107]
    v_dot2c_f32_bf16 v123, s5, v17
    v_dot2c_f32_bf16 v124, s4, v18
    v_mfma_f32_16x16x32_bf16 v[112:115], v[200:203], a[124:127], v[112:115]
    ds_read_b128 v[224:227], v187 offset:23552
    v_dot2c_f32_bf16 v125, s5, v18
    v_mfma_f32_16x16x32_bf16 v[112:115], v[196:199], a[116:119], v[112:115]
    v_dot2c_f32_bf16 v126, s4, v19
    s_waitcnt lgkmcnt(4)
    v_mfma_f32_16x16x32_bf16 v[116:119], v[204:207], a[116:119], v[116:119]
    ds_read_b128 v[196:199], v188 offset:0
    v_dot2c_f32_bf16 v127, s5, v19
    v_mfma_f32_16x16x32_bf16 v[116:119], v[208:211], a[124:127], v[116:119]
    v_dot2c_f32_bf16 v128, s4, v20
    v_dot2c_f32_bf16 v129, s5, v20
    v_mfma_f32_16x16x32_bf16 v[108:111], v[208:211], a[120:123], v[108:111]
    ds_read_b128 v[200:203], v188 offset:2048
    v_dot2c_f32_bf16 v130, s4, v21
    v_mfma_f32_16x16x32_bf16 v[108:111], v[204:207], a[112:115], v[108:111]
    v_dot2c_f32_bf16 v131, s5, v21
    s_waitcnt lgkmcnt(4)
    v_mfma_f32_16x16x32_bf16 v[104:107], v[212:215], a[128:131], v[104:107]
    ds_read_b128 v[204:207], v188 offset:1024
    v_dot2c_f32_bf16 v132, s4, v22
    v_mfma_f32_16x16x32_bf16 v[104:107], v[216:219], a[136:139], v[104:107]
    v_dot2c_f32_bf16 v133, s5, v22
    v_dot2c_f32_bf16 v134, s4, v23
    v_mfma_f32_16x16x32_bf16 v[112:115], v[216:219], a[140:143], v[112:115]
    ds_read_b128 v[208:211], v188 offset:3072
    v_dot2c_f32_bf16 v135, s5, v23
    v_mfma_f32_16x16x32_bf16 v[112:115], v[212:215], a[132:135], v[112:115]
    s_waitcnt lgkmcnt(4)
    v_mfma_f32_16x16x32_bf16 v[116:119], v[220:223], a[132:135], v[116:119]
    ds_read_b128 v[212:215], v188 offset:4096
    v_mfma_f32_16x16x32_bf16 v[116:119], v[224:227], a[140:143], v[116:119]
    v_mfma_f32_16x16x32_bf16 v[108:111], v[224:227], a[136:139], v[108:111]
    ds_read_b128 v[216:219], v188 offset:6144
    v_mfma_f32_16x16x32_bf16 v[108:111], v[220:223], a[128:131], v[108:111]
    s_waitcnt lgkmcnt(4)
    v_mfma_f32_16x16x32_bf16 v[104:107], v[196:199], a[144:147], v[104:107]
    ds_read_b128 v[220:223], v188 offset:5120
    v_mfma_f32_16x16x32_bf16 v[104:107], v[200:203], a[152:155], v[104:107]
    v_mfma_f32_16x16x32_bf16 v[112:115], v[200:203], a[156:159], v[112:115]
    ds_read_b128 v[224:227], v188 offset:7168
    v_mfma_f32_16x16x32_bf16 v[112:115], v[196:199], a[148:151], v[112:115]
    s_waitcnt lgkmcnt(4)
    v_mfma_f32_16x16x32_bf16 v[116:119], v[204:207], a[148:151], v[116:119]
    ds_read_b128 v[196:199], v188 offset:8192
    v_mfma_f32_16x16x32_bf16 v[116:119], v[208:211], a[156:159], v[116:119]
    v_mfma_f32_16x16x32_bf16 v[108:111], v[208:211], a[152:155], v[108:111]
    ds_read_b128 v[200:203], v188 offset:10240
    v_mfma_f32_16x16x32_bf16 v[108:111], v[204:207], a[144:147], v[108:111]
    s_waitcnt lgkmcnt(4)
    v_mfma_f32_16x16x32_bf16 v[104:107], v[212:215], a[160:163], v[104:107]
    ds_read_b128 v[204:207], v188 offset:9216
    v_mfma_f32_16x16x32_bf16 v[104:107], v[216:219], a[168:171], v[104:107]
    s_waitcnt vmcnt(0)
    v_cmp_ne_u32 vcc, s3, v193
    s_cbranch_vccnz SLOW_56
BACK_57:
    v_mfma_f32_16x16x32_bf16 v[112:115], v[216:219], a[172:175], v[112:115]
    ds_read_b128 v[208:211], v188 offset:11264
    buffer_load_dwordx4 v[24:27], v3, s[24:27], s22 offen offset:0 sc1
    v_mfma_f32_16x16x32_bf16 v[112:115], v[212:215], a[164:167], v[112:115]
    s_waitcnt lgkmcnt(4)
    v_mfma_f32_16x16x32_bf16 v[116:119], v[220:223], a[164:167], v[116:119]
    ds_read_b128 v[212:215], v188 offset:12288
    buffer_load_dwordx4 v[28:31], v3, s[24:27], s22 offen offset:1024 sc1
    v_mfma_f32_16x16x32_bf16 v[116:119], v[224:227], a[172:175], v[116:119]
    v_mfma_f32_16x16x32_bf16 v[108:111], v[224:227], a[168:171], v[108:111]
    ds_read_b128 v[216:219], v188 offset:14336
    v_mfma_f32_16x16x32_bf16 v[108:111], v[220:223], a[160:163], v[108:111]
    s_waitcnt lgkmcnt(4)
    v_mfma_f32_16x16x32_bf16 v[104:107], v[196:199], a[176:179], v[104:107]
    ds_read_b128 v[220:223], v188 offset:13312
    v_mfma_f32_16x16x32_bf16 v[104:107], v[200:203], a[184:187], v[104:107]
    v_mfma_f32_16x16x32_bf16 v[112:115], v[200:203], a[188:191], v[112:115]
    ds_read_b128 v[224:227], v188 offset:15360
    v_mfma_f32_16x16x32_bf16 v[112:115], v[196:199], a[180:183], v[112:115]
    s_waitcnt lgkmcnt(4)
    v_mfma_f32_16x16x32_bf16 v[116:119], v[204:207], a[180:183], v[116:119]
    ds_read_b128 v[196:199], v188 offset:16384
    v_mfma_f32_16x16x32_bf16 v[116:119], v[208:211], a[188:191], v[116:119]
    v_mfma_f32_16x16x32_bf16 v[108:111], v[208:211], a[184:187], v[108:111]
    ds_read_b128 v[200:203], v188 offset:18432
    v_mfma_f32_16x16x32_bf16 v[108:111], v[204:207], a[176:179], v[108:111]
    s_waitcnt lgkmcnt(4)
    v_mfma_f32_16x16x32_bf16 v[104:107], v[212:215], a[192:195], v[104:107]
    ds_read_b128 v[204:207], v188 offset:17408
    v_mfma_f32_16x16x32_bf16 v[104:107], v[216:219], a[200:203], v[104:107]
    v_mfma_f32_16x16x32_bf16 v[112:115], v[216:219], a[204:207], v[112:115]
    ds_read_b128 v[208:211], v188 offset:19456
    v_mfma_f32_16x16x32_bf16 v[112:115], v[212:215], a[196:199], v[112:115]
    s_waitcnt lgkmcnt(4)
    v_mfma_f32_16x16x32_bf16 v[116:119], v[220:223], a[196:199], v[116:119]
    ds_read_b128 v[212:215], v188 offset:20480
    v_mfma_f32_16x16x32_bf16 v[116:119], v[224:227], a[204:207], v[116:119]
    v_mfma_f32_16x16x32_bf16 v[108:111], v[224:227], a[200:203], v[108:111]
    s_barrier
    ds_read_b128 v[216:219], v188 offset:22528
    v_mfma_f32_16x16x32_bf16 v[108:111], v[220:223], a[192:195], v[108:111]
    s_waitcnt lgkmcnt(4)
    v_mfma_f32_16x16x32_bf16 v[104:107], v[196:199], a[208:211], v[104:107]
    ds_read_b128 v[220:223], v188 offset:21504
    v_mfma_f32_16x16x32_bf16 v[104:107], v[200:203], a[216:219], v[104:107]
    v_mfma_f32_16x16x32_bf16 v[112:115], v[200:203], a[220:223], v[112:115]
    ds_read_b128 v[224:227], v188 offset:23552
    v_mfma_f32_16x16x32_bf16 v[112:115], v[196:199], a[212:215], v[112:115]
    s_waitcnt lgkmcnt(4)
    v_mfma_f32_16x16x32_bf16 v[116:119], v[204:207], a[212:215], v[116:119]
    ds_read_b128 v[196:199], v186 offset:0
    v_mfma_f32_16x16x32_bf16 v[116:119], v[208:211], a[220:223], v[116:119]
    v_mfma_f32_16x16x32_bf16 v[108:111], v[208:211], a[216:219], v[108:111]
    ds_read_b128 v[200:203], v186 offset:2048
    v_mfma_f32_16x16x32_bf16 v[108:111], v[204:207], a[208:211], v[108:111]
    s_waitcnt lgkmcnt(4)
    v_mfma_f32_16x16x32_bf16 v[104:107], v[212:215], a[224:227], v[104:107]
    ds_read_b128 v[204:207], v186 offset:1024
    v_mfma_f32_16x16x32_bf16 v[104:107], v[216:219], a[232:235], v[104:107]
    v_mfma_f32_16x16x32_bf16 v[112:115], v[216:219], a[236:239], v[112:115]
    ds_read_b128 v[208:211], v186 offset:3072
    buffer_load_dwordx4 v[40:43], v179, s[24:27], s69 offen offset:2048 sc1
    v_mfma_f32_16x16x32_bf16 v[112:115], v[212:215], a[228:231], v[112:115]
    s_waitcnt lgkmcnt(4)
    v_mfma_f32_16x16x32_bf16 v[116:119], v[220:223], a[228:231], v[116:119]
    ds_read_b128 v[212:215], v186 offset:4096
    buffer_load_dwordx4 v[44:47], v179, s[24:27], s69 offen offset:3072 sc1
    v_mfma_f32_16x16x32_bf16 v[116:119], v[224:227], a[236:239], v[116:119]
    v_mfma_f32_16x16x32_bf16 v[108:111], v[224:227], a[232:235], v[108:111]
    ds_read_b128 v[216:219], v186 offset:6144
    buffer_load_dwordx4 v[48:51], v179, s[24:27], s23 offen offset:0 sc1
    v_mfma_f32_16x16x32_bf16 v[108:111], v[220:223], a[224:227], v[108:111]
    s_waitcnt lgkmcnt(4)
    v_mfma_f32_16x16x32_bf16 v[104:107], v[196:199], a[240:243], v[104:107]
    ds_read_b128 v[220:223], v186 offset:5120
    buffer_load_dwordx4 v[52:55], v179, s[24:27], s23 offen offset:1024 sc1
    v_mfma_f32_16x16x32_bf16 v[104:107], v[200:203], a[248:251], v[104:107]
    v_mfma_f32_16x16x32_bf16 v[112:115], v[200:203], a[252:255], v[112:115]
    ds_read_b128 v[224:227], v186 offset:7168
    buffer_load_dwordx4 v[56:59], v179, s[24:27], s23 offen offset:2048 sc1
    v_mfma_f32_16x16x32_bf16 v[112:115], v[196:199], a[244:247], v[112:115]
    s_waitcnt lgkmcnt(4)
    v_mfma_f32_16x16x32_bf16 v[116:119], v[204:207], a[244:247], v[116:119]
    ds_read_b128 v[196:199], v186 offset:8192
    buffer_load_dwordx4 v[60:63], v179, s[24:27], s23 offen offset:3072 sc1
    v_mfma_f32_16x16x32_bf16 v[116:119], v[208:211], a[252:255], v[116:119]
    v_mfma_f32_16x16x32_bf16 v[108:111], v[208:211], a[248:251], v[108:111]
    ds_read_b128 v[200:203], v186 offset:10240
    v_mfma_f32_16x16x32_bf16 v[108:111], v[204:207], a[240:243], v[108:111]
    s_waitcnt lgkmcnt(4)
    v_mfma_f32_16x16x32_bf16 v[104:107], v[212:215], v[136:139], v[104:107]
    ds_read_b128 v[204:207], v186 offset:9216
    v_mfma_f32_16x16x32_bf16 v[104:107], v[216:219], v[144:147], v[104:107]
    v_mfma_f32_16x16x32_bf16 v[112:115], v[216:219], v[148:151], v[112:115]
    ds_read_b128 v[208:211], v186 offset:11264
    v_mfma_f32_16x16x32_bf16 v[112:115], v[212:215], v[140:143], v[112:115]
    s_waitcnt vmcnt(6)
    v_dot2c_f32_bf16 v120, s4, v24
    s_waitcnt lgkmcnt(4)
    v_mfma_f32_16x16x32_bf16 v[116:119], v[220:223], v[140:143], v[116:119]
    v_dot2c_f32_bf16 v121, s5, v24
    v_dot2c_f32_bf16 v122, s4, v25
    v_mfma_f32_16x16x32_bf16 v[116:119], v[224:227], v[148:151], v[116:119]
    v_dot2c_f32_bf16 v123, s5, v25
    v_dot2c_f32_bf16 v124, s4, v26
    v_mfma_f32_16x16x32_bf16 v[108:111], v[224:227], v[144:147], v[108:111]
    v_dot2c_f32_bf16 v125, s5, v26
    v_dot2c_f32_bf16 v126, s4, v27
    v_mfma_f32_16x16x32_bf16 v[108:111], v[220:223], v[136:139], v[108:111]
    v_dot2c_f32_bf16 v127, s5, v27
    s_waitcnt lgkmcnt(2)
    v_mfma_f32_16x16x32_bf16 v[104:107], v[196:199], v[152:155], v[104:107]
    v_dot2c_f32_bf16 v128, s4, v28
    v_dot2c_f32_bf16 v129, s5, v28
    v_mfma_f32_16x16x32_bf16 v[104:107], v[200:203], v[160:163], v[104:107]
    v_dot2c_f32_bf16 v130, s4, v29
    v_dot2c_f32_bf16 v131, s5, v29
    v_mfma_f32_16x16x32_bf16 v[112:115], v[200:203], v[164:167], v[112:115]
    v_dot2c_f32_bf16 v132, s4, v30
    v_dot2c_f32_bf16 v133, s5, v30
    v_mfma_f32_16x16x32_bf16 v[112:115], v[196:199], v[156:159], v[112:115]
    v_dot2c_f32_bf16 v134, s4, v31
    s_waitcnt lgkmcnt(0)
    v_mfma_f32_16x16x32_bf16 v[116:119], v[204:207], v[156:159], v[116:119]
    v_dot2c_f32_bf16 v135, s5, v31
    v_fmac_f32 v228, v120, v173
    v_mfma_f32_16x16x32_bf16 v[116:119], v[208:211], v[164:167], v[116:119]
    v_fmac_f32 v229, v121, v173
    v_fmac_f32 v230, v122, v173
    v_mfma_f32_16x16x32_bf16 v[108:111], v[208:211], v[160:163], v[108:111]
    v_fmac_f32 v231, v123, v173
    v_fmac_f32 v232, v124, v173
    v_mfma_f32_16x16x32_bf16 v[108:111], v[204:207], v[152:155], v[108:111]
    v_fmac_f32 v233, v125, v173
    v_fmac_f32 v234, v126, v173
    v_fmac_f32 v235, v127, v173
    v_fmac_f32 v236, v128, v174
    v_fmac_f32 v237, v129, v174
    v_fmac_f32 v238, v130, v174
    v_fmac_f32 v239, v131, v174
    v_fmac_f32 v240, v132, v174
    v_fmac_f32 v241, v133, v174
    v_fmac_f32 v242, v134, v174
    v_fmac_f32 v243, v135, v174
    v_fmac_f32 v228, v104, v173
    v_fmac_f32 v229, v105, v173
    v_fmac_f32 v230, v106, v173
    v_fmac_f32 v231, v107, v173
    v_fmac_f32 v232, v108, v173
    v_fmac_f32 v233, v109, v173
    v_fmac_f32 v234, v110, v173
    v_fmac_f32 v235, v111, v173
    v_cvt_pk_bf16_f32 v32, v228, v229
    v_cvt_pk_bf16_f32 v33, v230, v231
    v_cvt_pk_bf16_f32 v34, v232, v233
    v_cvt_pk_bf16_f32 v35, v234, v235
    buffer_store_dwordx4 v[32:35], v175, s[12:15], 0 offen nt
    v_fmac_f32 v236, v112, v174
    v_fmac_f32 v237, v113, v174
    v_fmac_f32 v238, v114, v174
    v_fmac_f32 v239, v115, v174
    v_fmac_f32 v240, v116, v174
    v_fmac_f32 v241, v117, v174
    v_fmac_f32 v242, v118, v174
    v_fmac_f32 v243, v119, v174
    v_cvt_pk_bf16_f32 v36, v236, v237
    v_cvt_pk_bf16_f32 v37, v238, v239
    v_cvt_pk_bf16_f32 v38, v240, v241
    v_cvt_pk_bf16_f32 v39, v242, v243
    buffer_store_dwordx4 v[36:39], v175, s[12:15], s34 offen nt
    s_waitcnt vmcnt(2)
    v_xor_b32 v178, s3, v40
    v_bitop3_b32 v178, v178, v42, s3 bitop3:0xf6
    v_bitop3_b32 v178, v178, v44, s3 bitop3:0xf6
    v_bitop3_b32 v178, v178, v46, s3 bitop3:0xf6
    v_bitop3_b32 v178, v178, v48, s3 bitop3:0xf6
    v_bitop3_b32 v178, v178, v50, s3 bitop3:0xf6
    v_bitop3_b32 v178, v178, v52, s3 bitop3:0xf6
    v_bitop3_b32 v178, v178, v54, s3 bitop3:0xf6
    v_bitop3_b32 v178, v178, v56, s3 bitop3:0xf6
    v_bitop3_b32 v178, v178, v58, s3 bitop3:0xf6
    v_bitop3_b32 v178, v178, v60, s3 bitop3:0xf6
    v_bitop3_b32 v178, v178, v62, s3 bitop3:0xf6
    v_and_b32 v178, s6, v178
    v_cmp_ne_u32 vcc, 0, v178
    s_cbranch_vccnz XS_60
XB_61:
    v_add_f32 v40, v40, v48
    v_add_f32 v56, v56, v72
    v_add_f32 v41, v41, v49
    v_add_f32 v57, v57, v73
    v_add_f32 v42, v42, v50
    v_add_f32 v58, v58, v74
    v_add_f32 v43, v43, v51
    v_add_f32 v59, v59, v75
    v_add_f32 v44, v44, v52
    v_add_f32 v60, v60, v76
    v_add_f32 v45, v45, v53
    v_add_f32 v61, v61, v77
    v_add_f32 v46, v46, v54
    v_add_f32 v62, v62, v78
    v_add_f32 v47, v47, v55
    v_add_f32 v63, v63, v79
    v_add_f32 v40, v40, v56
    v_add_f32 v41, v41, v57
    v_add_f32 v42, v42, v58
    v_add_f32 v43, v43, v59
    v_add_f32 v44, v44, v60
    v_add_f32 v45, v45, v61
    v_add_f32 v46, v46, v62
    v_add_f32 v47, v47, v63
    v_fmac_f32 v244, v40, v173
    v_fmac_f32 v245, v41, v173
    v_fmac_f32 v246, v42, v173
    v_fmac_f32 v247, v43, v173
    v_fmac_f32 v248, v44, v174
    v_fmac_f32 v249, v45, v174
    v_fmac_f32 v250, v46, v174
    v_fmac_f32 v251, v47, v174
    v_cvt_pk_bf16_f32 v40, v244, v245
    v_cvt_pk_bf16_f32 v41, v246, v247
    v_cvt_pk_bf16_f32 v42, v248, v249
    v_cvt_pk_bf16_f32 v43, v250, v251
    buffer_store_dwordx2 v[40:41], v176, s[12:15], 0 offen
    buffer_store_dwordx2 v[42:43], v176, s[12:15], s34 offen
END:
    s_endpgm
RPs_7:
    s_mov_b32 s72, s62
    s_mov_b32 s73, s63
    s_mov_b32 s74, 256
    s_mov_b32 s75, 0x00020000
    s_mov_b32 s5, 7
RPl_8:
    s_add_u32 s4, s4, 1
    s_and_b32 s4, s4, 7
    s_lshl_b32 s6, s4, 5
    s_mov_b64 exec, 1
    v_mov_b32 v58, 1
    buffer_atomic_add v58, v4, s[72:75], s6 offen sc0 sc1
    s_mov_b64 exec, -1
    s_waitcnt vmcnt(0)
    v_readfirstlane_b32 s6, v58
    s_cmp_lt_u32 s6, 32
    s_cbranch_scc1 RPok_6
    s_sub_u32 s5, s5, 1
    s_cmp_lg_u32 s5, 0
    s_cbranch_scc1 RPl_8
    s_and_b32 s4, s2, 7
    s_lshr_b32 s6, s2, 3
    s_branch RPok_6
CV_again:
    s_sub_u32 s97, s97, 1
    s_cbranch_scc1 CV_g2
    buffer_load_dword v12, v11, s[24:27], 0 offen sc1
    s_waitcnt vmcnt(0)
    s_branch CV_chk
CV_fs250:
    s_mov_b32 s97, 40000
POLL_9:
    buffer_load_dword v12, v250, s[24:27], 0 offen offset:0 sc1
    s_waitcnt vmcnt(0)
    v_xor_b32 v12, s3, v12
    v_cmp_ne_u32 vcc, 0, v12
    s_cbranch_vccz PDONE_10
    s_sub_u32 s97, s97, 1
    s_cbranch_scc0 POLL_9
PDONE_10:
    s_branch CV_fb250
RPs_15:
    s_mov_b32 s72, s62
    s_mov_b32 s73, s63
    s_mov_b32 s74, 256
    s_mov_b32 s75, 0x00020000
    s_mov_b32 s5, 7
RPl_16:
    s_add_u32 s4, s4, 1
    s_and_b32 s4, s4, 7
    s_lshl_b32 s6, s4, 5
    s_mov_b64 exec, 1
    v_mov_b32 v58, 1
    buffer_atomic_add v58, v4, s[72:75], s6 offen sc0 sc1
    s_mov_b64 exec, -1
    s_waitcnt vmcnt(0)
    v_readfirstlane_b32 s6, v58
    s_cmp_lt_u32 s6, 32
    s_cbranch_scc1 RPok_14
    s_sub_u32 s5, s5, 1
    s_cmp_lg_u32 s5, 0
    s_cbranch_scc1 RPl_16
    s_and_b32 s4, s2, 7
    s_lshr_b32 s6, s2, 3
    s_branch RPok_14
RPs_19:
    s_mov_b32 s72, s62
    s_mov_b32 s73, s63
    s_mov_b32 s74, 256
    s_mov_b32 s75, 0x00020000
    s_mov_b32 s5, 7
RPl_20:
    s_add_u32 s4, s4, 1
    s_and_b32 s4, s4, 7
    s_lshl_b32 s6, s4, 5
    s_mov_b64 exec, 1
    v_mov_b32 v58, 1
    buffer_atomic_add v58, v4, s[72:75], s6 offen sc0 sc1
    s_mov_b64 exec, -1
    s_waitcnt vmcnt(0)
    v_readfirstlane_b32 s6, v58
    s_cmp_lt_u32 s6, 32
    s_cbranch_scc1 RPok_18
    s_sub_u32 s5, s5, 1
    s_cmp_lg_u32 s5, 0
    s_cbranch_scc1 RPl_20
    s_and_b32 s4, s2, 7
    s_lshr_b32 s6, s2, 3
    s_branch RPok_18
SLOW_21:
    s_mov_b32 s97, 40000
POLL_23:
    buffer_load_dword v116, v114, s[24:27], s68 offen offset:0 sc1
    s_waitcnt vmcnt(0)
    v_xor_b32 v116, s3, v116
    v_cmp_ne_u32 vcc, 0, v116
    s_cbranch_vccz PDONE_24
    s_sub_u32 s97, s97, 1
    s_cbranch_scc0 POLL_23
PDONE_24:
    s_branch BACK_22
SLOW_25:
    s_mov_b32 s97, 40000
POLL_27:
    buffer_load_dword v116, v114, s[24:27], s68 offen offset:0 sc1
    s_waitcnt vmcnt(0)
    v_xor_b32 v116, s3, v116
    v_cmp_ne_u32 vcc, 0, v116
    s_cbranch_vccz PDONE_28
    s_sub_u32 s97, s97, 1
    s_cbranch_scc0 POLL_27
PDONE_28:
    s_branch BACK_26
SLOW_29:
    s_mov_b32 s97, 40000
POLL_31:
    buffer_load_dword v116, v115, s[24:27], s68 offen offset:0 sc1
    buffer_load_dword v117, v115, s[24:27], s69 offen offset:0 sc1
    s_waitcnt vmcnt(0)
    v_xor_b32 v116, s3, v116
    v_xor_b32 v117, s3, v117
    v_or_b32 v116, v116, v117
    v_cmp_ne_u32 vcc, 0, v116
    s_cbranch_vccz PDONE_32
    s_sub_u32 s97, s97, 1
    s_cbranch_scc0 POLL_31
PDONE_32:
    s_branch BACK_30
SLOW_35:
    s_mov_b32 s97, 40000
POLL_37:
    buffer_load_dword v193, v190, s[24:27], s65 offen offset:0 sc1
    s_waitcnt vmcnt(0)
    v_xor_b32 v193, s3, v193
    v_cmp_ne_u32 vcc, 0, v193
    s_cbranch_vccz PDONE_38
    s_sub_u32 s97, s97, 1
    s_cbranch_scc0 POLL_37
PDONE_38:
    s_branch BACK_36
SLOW_39:
    s_mov_b32 s97, 40000
POLL_41:
    buffer_load_dword v193, v194, s[24:27], s18 offen offset:0 sc1
    s_waitcnt vmcnt(0)
    v_xor_b32 v193, s3, v193
    v_cmp_ne_u32 vcc, 0, v193
    s_cbranch_vccz PDONE_42
    s_sub_u32 s97, s97, 1
    s_cbranch_scc0 POLL_41
PDONE_42:
    s_branch BACK_40
SLOW_44:
    s_mov_b32 s97, 40000
POLL_46:
    buffer_load_dword v193, v190, s[24:27], s65 offen offset:64 sc1
    s_waitcnt vmcnt(0)
    v_xor_b32 v193, s3, v193
    v_cmp_ne_u32 vcc, 0, v193
    s_cbranch_vccz PDONE_47
    s_sub_u32 s97, s97, 1
    s_cbranch_scc0 POLL_46
PDONE_47:
    s_branch BACK_45
SLOW_48:
    s_mov_b32 s97, 40000
POLL_50:
    buffer_load_dword v193, v191, s[24:27], s65 offen offset:128 sc1
    s_waitcnt vmcnt(0)
    v_xor_b32 v193, s3, v193
    v_cmp_ne_u32 vcc, 0, v193
    s_cbranch_vccz PDONE_51
    s_sub_u32 s97, s97, 1
    s_cbranch_scc0 POLL_50
PDONE_51:
    s_branch BACK_49
SLOW_52:
    s_mov_b32 s97, 40000
POLL_54:
    buffer_load_dword v193, v170, s[24:27], s70 offen offset:4 sc1
    s_waitcnt vmcnt(0)
    v_xor_b32 v193, s3, v193
    v_cmp_ne_u32 vcc, 0, v193
    s_cbranch_vccz PDONE_55
    s_sub_u32 s97, s97, 1
    s_cbranch_scc0 POLL_54
PDONE_55:
    s_branch BACK_53
SLOW_56:
    s_mov_b32 s97, 40000
POLL_58:
    buffer_load_dword v193, v4, s[24:27], s70 offen offset:12 sc1
    s_waitcnt vmcnt(0)
    v_xor_b32 v193, s3, v193
    v_cmp_ne_u32 vcc, 0, v193
    s_cbranch_vccz PDONE_59
    s_sub_u32 s97, s97, 1
    s_cbranch_scc0 POLL_58
PDONE_59:
    s_branch BACK_57
XS_60:
    s_mov_b32 s97, 40000
XL_62:
    buffer_load_dwordx4 v[40:43], v179, s[24:27], s69 offen offset:2048 sc1
    buffer_load_dwordx4 v[44:47], v179, s[24:27], s69 offen offset:3072 sc1
    buffer_load_dwordx4 v[48:51], v179, s[24:27], s23 offen offset:0 sc1
    buffer_load_dwordx4 v[52:55], v179, s[24:27], s23 offen offset:1024 sc1
    buffer_load_dwordx4 v[56:59], v179, s[24:27], s23 offen offset:2048 sc1
    buffer_load_dwordx4 v[60:63], v179, s[24:27], s23 offen offset:3072 sc1
    s_waitcnt vmcnt(0)
    v_xor_b32 v178, s3, v40
    v_bitop3_b32 v178, v178, v42, s3 bitop3:0xf6
    v_bitop3_b32 v178, v178, v44, s3 bitop3:0xf6
    v_bitop3_b32 v178, v178, v46, s3 bitop3:0xf6
    v_bitop3_b32 v178, v178, v48, s3 bitop3:0xf6
    v_bitop3_b32 v178, v178, v50, s3 bitop3:0xf6
    v_bitop3_b32 v178, v178, v52, s3 bitop3:0xf6
    v_bitop3_b32 v178, v178, v54, s3 bitop3:0xf6
    v_bitop3_b32 v178, v178, v56, s3 bitop3:0xf6
    v_bitop3_b32 v178, v178, v58, s3 bitop3:0xf6
    v_bitop3_b32 v178, v178, v60, s3 bitop3:0xf6
    v_bitop3_b32 v178, v178, v62, s3 bitop3:0xf6
    v_and_b32 v178, s6, v178
    v_cmp_ne_u32 vcc, 0, v178
    s_cbranch_vccz XB_61
    s_sub_u32 s97, s97, 1
    s_cbranch_scc0 XL_62
    s_branch XB_61
CODE_END:

.section .rodata,"a"
.p2align 6
.amdhsa_kernel sequential_preLN__ssm_conv_h3__glu_gated_reglu__prompt_kernel
  .amdhsa_next_free_vgpr 512
  .amdhsa_next_free_sgpr 102
  .amdhsa_accum_offset 256
  .amdhsa_group_segment_fixed_size 0
  .amdhsa_kernarg_size 104
  .amdhsa_user_sgpr_count 2
  .amdhsa_user_sgpr_kernarg_segment_ptr 1
  .amdhsa_system_sgpr_workgroup_id_x 1
.end_amdhsa_kernel
```
